```python
import torch

def _softmax(x, axis=-1):
    return torch.softmax(x, dim=axis)
def _gelu(x):
    return torch.nn.functional.gelu(x, approximate="tanh")
def _silu(x):
    return torch.nn.functional.silu(x)
def _sigmoid(x):
    return torch.sigmoid(x)
def _layernorm(x, axis=-1, eps=1e-5):
    m = x.mean(dim=axis, keepdim=True)
    v = x.var(dim=axis, keepdim=True, unbiased=False)
    return (x - m) / torch.sqrt(v + eps)
def _scatter_add(tgt, idx, src, axis=0):
    return tgt.clone().index_add_(axis, idx, src)
def _segment_sum(src, seg, n):
    out = torch.zeros((n,) + src.shape[1:], dtype=src.dtype)
    return out.index_add_(0, seg, src)
def _pad(x, pw):
    flat = tuple(v for pair in reversed(pw) for v in pair)
    return torch.nn.functional.pad(x, flat)

kernel_name = 'recurrent_scan__mha_block__mixer_channel_mlp__prompt'

def setup_inputs():

    _w = (lambda a: (lambda t: t.to(torch.bfloat16) if t.is_floating_point() else t)(torch.as_tensor(a)))
    def _A_setup():
        B, S, D, H = 1, 2048, 512, 32
        return {
            "x": _w((lambda *s: torch.randn(*s, dtype=torch.bfloat16) * 0.05)(B, S, D)),
            "wqkv": _w((lambda *s: torch.randn(*s, dtype=torch.bfloat16) * 0.1)(D, 3 * D)),
            "wo": _w((lambda *s: torch.randn(*s, dtype=torch.bfloat16) * 0.05)(D, D)),
        }
    _A_in = _A_setup()

    def _B_setup():
        B, S, D, F = 1, 2048, 512, 1792
        return {
            "x": _w((lambda *s: torch.randn(*s, dtype=torch.bfloat16) * 0.05)(B, S, D)),
            "w1": _w((lambda *s: torch.randn(*s, dtype=torch.bfloat16) * 3.2)(D, F) * (D ** -0.5)),
            "b1": _w((lambda *s: torch.randn(*s, dtype=torch.bfloat16) * 1.6)(F)),
            "w2": _w((lambda *s: torch.randn(*s, dtype=torch.bfloat16) * 0.8)(F, D) * (F ** -0.5)),
            "b2": _w((lambda *s: torch.randn(*s, dtype=torch.bfloat16) * 0.8)(D)),
        }
    _B_in = _B_setup()

    return {
        "A_x": _A_in["x"],
        "A_wqkv": _A_in["wqkv"],
        "A_wo": _A_in["wo"],
        "B_x": _B_in["x"],
        "B_w1": _B_in["w1"],
        "B_b1": _B_in["b1"],
        "B_w2": _B_in["w2"],
        "B_b2": _B_in["b2"],
    }

def reference(A_x, A_wqkv, A_wo, B_x, B_w1, B_b1, B_w2, B_b2):
    def _A_ref(x, wqkv, wo):
        B, S, D = x.shape
        H = 32
        Dh = D // H
        qkv = (lambda x, *d: x.permute(*d))((x @ wqkv).reshape(B, S, 3, H, Dh), 2, 0, 3, 1, 4)
        q, k, v = qkv[0], qkv[1], qkv[2]
        scores = torch.einsum("bhqd,bhkd->bhqk", q, k) * (Dh ** -0.5)
        p = _softmax(scores, axis=-1)
        o = torch.einsum("bhqk,bhkd->bhqd", p, v)
        return (lambda x, *d: x.permute(*d))(o, 0, 2, 1, 3).reshape(B, S, D) @ wo

    def _B_ref(x, w1, b1, w2, b2):
        y = _layernorm(x, axis=-1)
        h = _gelu(torch.einsum("bsd,df->bsf", y, w1) + b1)
        return torch.einsum("bsf,fd->bsd", h, w2) + b2

    x = A_x
    xn = _layernorm(x, axis=-1)
    s = _A_ref(xn, A_wqkv, A_wo)
    g = _silu(_B_ref(xn, B_w1, B_b1, B_w2, B_b2))
    return x + s * g
```

```asm
; @launch grid=(256,1,1) block=(512,1,1) lds=163840
.amdgcn_target "amdgcn-amd-amdhsa--gfx950"
.text
.globl recurrent_scan__mha_block__mixer_channel_mlp__prompt_kernel
.p2align 8
.type recurrent_scan__mha_block__mixer_channel_mlp__prompt_kernel,@function
recurrent_scan__mha_block__mixer_channel_mlp__prompt_kernel:
    s_load_dwordx4 s[4:7], s[0:1], 0
    s_cmp_ge_u32 s2, 256
    s_cbranch_scc1 L_end
    s_getpc_b64 s[50:51]
L_pf:
    s_lshr_b32 s52, s2, 3
    s_lshl_b32 s52, s52, 11
    v_and_b32 v4, 0x1c0, v0
    v_and_b32 v5, 1, v0
    v_lshlrev_b32 v5, 5, v5
    v_or_b32 v4, v4, v5
    v_lshl_add_u32 v4, v4, 2, s52
    v_min_u32 v4, L_end-L_pf, v4
    v_mov_b32 v5, s51
    v_add_co_u32 v4, vcc, s50, v4
    s_nop 1
    v_addc_co_u32 v5, vcc, 0, v5, vcc
    global_load_dword v3, v[4:5], off
    v_lshrrev_b32 v2, 6, v0
    v_and_b32 v1, 63, v0
    v_readfirstlane_b32 s3, v2
    s_lshr_b32 s51, s2, 3
    s_lshr_b32 s52, s2, 6
    s_and_b32 s58, s51, 7
    s_and_b32 s44, s3, 3
    s_lshl_b32 s49, s44, 12
    s_xor_b32 s56, s51, s52
    s_and_b32 s56, s56, 1
    s_lshl_b32 s56, s56, 2
    s_cmp_ge_u32 s3, 4
    s_cbranch_scc1 L_pro1
    s_and_b32 s42, s2, 1
    s_lshl_b32 s42, s42, 3
    s_add_u32 s42, s42, s58
    s_lshl_b32 s46, s42, 2
    s_add_u32 s46, s46, s44
    s_lshl_b32 s46, s46, 15
    v_lshrrev_b32 v116, 3, v1
    v_lshlrev_b32 v116, 10, v116
    v_lshrrev_b32 v117, 4, v1
    v_and_b32 v118, 7, v1
    v_xor_b32 v118, v117, v118
    v_lshl_add_u32 v72, v118, 4, v116
    v_xor_b32 v73, 64, v72
    v_add_u32 v73, 7168, v73
    v_add_u32 v74, 14336, v72
    v_add_u32 v75, 14336, v73
    s_mov_b32 s10, 2097152
    s_mov_b32 s11, 0x20000
    s_waitcnt lgkmcnt(0)
    s_mov_b32 s8, s4
    s_and_b32 s9, s5, 0xffff
    s_xor_b32 s51, s56, 0
    s_lshl_b32 s51, s51, 7
    s_add_u32 m0, s49, 8192
    s_add_u32 s51, s46, s51
    buffer_load_dwordx4 v72, s[8:11], s51 offen offset:0 lds
    buffer_load_dwordx4 v73, s[8:11], s51 offen offset:1024 lds
    buffer_load_dwordx4 v74, s[8:11], s51 offen offset:2048 lds
    buffer_load_dwordx4 v75, s[8:11], s51 offen offset:3072 lds
    s_xor_b32 s51, s56, 1
    s_lshl_b32 s51, s51, 7
    s_add_u32 m0, s49, 40960
    s_add_u32 s51, s46, s51
    buffer_load_dwordx4 v72, s[8:11], s51 offen offset:0 lds
    buffer_load_dwordx4 v73, s[8:11], s51 offen offset:1024 lds
    buffer_load_dwordx4 v74, s[8:11], s51 offen offset:2048 lds
    buffer_load_dwordx4 v75, s[8:11], s51 offen offset:3072 lds
    s_branch L_pro
L_pro1:
    s_bfe_u32 s43, s2, 0x20001
    s_lshl_b32 s43, s43, 2
    s_add_u32 s43, s43, s52
    s_mul_i32 s47, s43, 192
    s_mul_i32 s59, s44, 192
    v_add_u32 v116, s59, v1
    v_mul_u32_u24 v118, 43691, v116
    v_lshrrev_b32 v118, 19, v118
    v_mul_u32_u24 v118, 2880, v118
    v_lshl_add_u32 v72, v116, 4, v118
    v_add_u32 v116, 64, v116
    v_mul_u32_u24 v118, 43691, v116
    v_lshrrev_b32 v118, 19, v118
    v_mul_u32_u24 v118, 2880, v118
    v_lshl_add_u32 v73, v116, 4, v118
    v_subrev_u32 v73, 1024, v73
    v_add_u32 v116, 64, v116
    v_mul_u32_u24 v118, 43691, v116
    v_lshrrev_b32 v118, 19, v118
    v_mul_u32_u24 v118, 2880, v118
    v_lshl_add_u32 v74, v116, 4, v118
    v_subrev_u32 v74, 2048, v74
    s_lshl_b32 s59, s59, 4
    s_mov_b32 s14, 1572864
    s_mov_b32 s15, 0x20000
    s_waitcnt lgkmcnt(0)
    s_mov_b32 s12, s6
    s_and_b32 s13, s7, 0xffff
    s_xor_b32 s51, s56, 0
    s_mul_i32 s51, s51, 196608
    s_add_u32 m0, s59, 24576
    s_add_u32 s51, s47, s51
    buffer_load_dwordx4 v72, s[12:15], s51 offen offset:0 lds
    buffer_load_dwordx4 v73, s[12:15], s51 offen offset:1024 lds
    buffer_load_dwordx4 v74, s[12:15], s51 offen offset:2048 lds
    s_xor_b32 s51, s56, 1
    s_mul_i32 s51, s51, 196608
    s_add_u32 m0, s59, 57344
    s_add_u32 s51, s47, s51
    buffer_load_dwordx4 v72, s[12:15], s51 offen offset:0 lds
    buffer_load_dwordx4 v73, s[12:15], s51 offen offset:1024 lds
    buffer_load_dwordx4 v74, s[12:15], s51 offen offset:2048 lds
    v_mov_b32 v75, 0
L_pro:
    s_load_dwordx2 s[16:17], s[0:1], 32
    s_load_dwordx2 s[20:21], s[0:1], 80
    s_load_dwordx2 s[36:37], s[0:1], 40
    s_load_dwordx2 s[24:25], s[0:1], 48
    s_load_dwordx2 s[38:39], s[0:1], 56
    s_load_dwordx2 s[28:29], s[0:1], 16
    s_load_dwordx2 s[32:33], s[0:1], 64
    s_load_dwordx2 s[40:41], s[0:1], 72
    s_mov_b32 s8, s4
    s_and_b32 s9, s5, 0xffff
    s_mov_b32 s12, s6
    s_and_b32 s13, s7, 0xffff
    s_mov_b32 s10, 2097152
    s_mov_b32 s11, 0x20000
    s_mov_b32 s14, 1572864
    s_mov_b32 s15, 0x20000
    s_and_b32 s42, s2, 1
    s_lshl_b32 s42, s42, 3
    s_add_u32 s42, s42, s58
    s_bfe_u32 s43, s2, 0x20001
    s_lshl_b32 s43, s43, 2
    s_add_u32 s43, s43, s52
    s_and_b32 s57, s2, 7
    s_lshl_b32 s57, s57, 2
    s_add_u32 s57, s57, s52
    s_lshr_b32 s45, s3, 2
    v_lshlrev_b32 v2, 4, v1
    v_and_b32 v0, 31, v1
    s_mov_b32 s6, -1
    s_mov_b32 s7, 0
    s_lshr_b32 s50, s43, 2
    s_and_b32 s51, s42, 1
    s_cmp_eq_u32 s51, 0
    s_cselect_b32 s48, 0xB840, 0
    s_cselect_b32 s53, 0, 0xA630
    s_or_b32 s48, s48, s53
    s_lshl_b32 s53, s50, 2
    s_lshr_b32 s48, s48, s53
    s_and_b32 s48, s48, 15
    s_add_u32 s48, s48, s52
    s_min_u32 s48, s48, 13
    s_lshl_b32 s48, s48, 8
    s_lshr_b32 s50, s50, 1
    s_xor_b32 s50, s50, s51
    s_sub_u32 s50, 4, s50
    s_cmp_lt_u32 s52, s50
    s_cselect_b32 s53, 1, 0
    v_lshrrev_b32 v119, 4, v1
    v_lshlrev_b32 v120, 2, v119
    v_and_b32 v121, 15, v1
    v_xor_b32 v120, v120, v121
    v_lshlrev_b32 v120, 4, v120
    v_mul_u32_u24 v76, 3584, v119
    v_add_u32 v76, v76, v120
    s_lshl_b32 s100, s3, 12
    s_mul_i32 s101, s3, 57344
    s_add_u32 s101, s101, s48
    v_add_u32 v77, 13312, v76
    v_add_u32 v78, 26624, v76
    v_add_u32 v79, 39936, v76
    s_waitcnt lgkmcnt(0)
    s_and_b32 s21, s21, 0xffff
    s_mov_b32 s22, 20971520
    s_mov_b32 s23, 0x20000
    s_and_b32 s17, s17, 0xffff
    s_mov_b32 s18, 1835008
    s_mov_b32 s19, 0x20000
    s_and_b32 s25, s25, 0xffff
    s_mov_b32 s26, 1835008
    s_mov_b32 s27, 0x20000
    s_and_b32 s29, s29, 0xffff
    s_mov_b32 s30, 524288
    s_mov_b32 s31, 0x20000
    s_and_b32 s33, s33, 0xffff
    s_mov_b32 s34, 2097152
    s_mov_b32 s35, 0x20000
    s_cmp_lg_u32 s53, 0
    s_cselect_b32 s18, 1835008, 0
    s_lshl_b32 s50, s45, 7
    s_add_u32 s50, s50, s48
    v_lshl_add_u32 v109, v0, 1, s50
    s_lshl_b32 s50, s2, 3
    s_add_u32 s50, s50, s3
    s_cmp_eq_u32 s50, 1568
    s_cselect_b32 s61, 1, 0
    v_mov_b32 v110, 0
    s_mul_i32 s50, s50, 896
    v_min_u32 v116, 6, v1
    v_lshl_add_u32 v116, v116, 7, s50
    v_lshrrev_b32 v119, 5, v1
    v_bfe_u32 v120, v1, 1, 3
    v_xor_b32 v120, v119, v120
    s_lshl_b32 s50, s44, 1
    v_xor_b32 v120, s50, v120
    v_lshlrev_b32 v120, 4, v120
    v_lshl_add_u32 v64, v0, 7, v120
    v_add_u32 v64, s49, v64
    v_xor_b32 v65, 32, v64
    v_xor_b32 v66, 64, v64
    v_xor_b32 v67, 96, v64
    v_bfe_u32 v120, v1, 2, 2
    v_lshl_add_u32 v121, v119, 3, v120
    v_bfe_u32 v118, v1, 4, 1
    v_lshlrev_b32 v118, 5, v118
    v_and_b32 v122, 3, v1
    v_lshl_add_u32 v118, v122, 3, v118
    v_mul_u32_u24 v122, 192, v121
    v_add_u32 v122, v122, v118
    v_lshl_add_u32 v121, v121, 8, v118
    s_lshl_b32 s50, s45, 1
    v_xor_b32 v120, s50, v120
    v_lshl_add_u32 v121, v120, 6, v121
    s_add_u32 s50, s49, 0x10000
    v_add_u32 v32, s50, v121
    s_xor_b32 s50, s44, 0
    s_mul_i32 s50, s50, 3072
    s_lshl_b32 s51, s45, 7
    s_add_u32 s50, s50, s51
    v_add_u32 v68, s50, v122
    s_xor_b32 s50, s44, 1
    s_mul_i32 s50, s50, 3072
    s_lshl_b32 s51, s45, 7
    s_add_u32 s50, s50, s51
    v_add_u32 v69, s50, v122
    s_xor_b32 s50, s44, 2
    s_mul_i32 s50, s50, 3072
    s_lshl_b32 s51, s45, 7
    s_add_u32 s50, s50, s51
    v_add_u32 v70, s50, v122
    s_xor_b32 s50, s44, 3
    s_mul_i32 s50, s50, 3072
    s_lshl_b32 s51, s45, 7
    s_add_u32 s50, s50, s51
    v_add_u32 v71, s50, v122
    v_lshrrev_b32 v118, 2, v1
    v_lshrrev_b32 v120, 4, v1
    v_xor_b32 v118, v118, v120
    v_and_b32 v118, 1, v118
    v_and_b32 v120, 3, v1
    v_or_b32 v118, v118, v120
    v_cmp_eq_u32 vcc, 0, v118
    v_mov_b32 v120, 0x3f803f80
    v_mov_b32 v102, 0
    v_mov_b32 v103, 0
    v_mov_b32 v106, 0
    v_mov_b32 v107, 0
    v_cndmask_b32 v96, 0, v120, vcc
    v_cndmask_b32 v97, 0, v120, vcc
    v_cndmask_b32 v98, 0, v120, vcc
    v_cndmask_b32 v99, 0, v120, vcc
    v_lshrrev_b32 v118, 4, v0
    v_lshlrev_b32 v118, 16, v118
    v_lshl_add_u32 v118, v119, 8, v118
    v_and_b32 v120, 15, v1
    v_lshl_add_u32 v33, v120, 4, v118
    s_cmp_ge_u32 s44, 2
    s_cselect_b32 s54, 131072, 0
    s_sub_u32 s52, s54, 0x10000
    s_cmp_eq_u32 s45, 1
    s_cbranch_scc1 L_r1
    v_mov_b32 v85, v33
    v_mov_b32 v4, v32
    v_xor_b32 v5, 4096, v4
    v_xor_b32 v6, 8192, v4
    v_xor_b32 v7, 12288, v4
    v_and_b32 v80, 0x33, v1
    v_and_b32 v118, 4, v1
    v_lshl_or_b32 v80, v118, 1, v80
    v_and_b32 v118, 8, v1
    v_lshrrev_b32 v118, 1, v118
    v_or_b32 v80, v118, v80
    v_lshlrev_b32 v80, 4, v80
    v_lshlrev_b32 v118, 4, v120
    v_lshl_add_u32 v121, v119, 8, v118
    v_add_u32 v121, 143360, v121
    v_add_u32 v118, 4, v120
    v_and_b32 v118, 8, v118
    v_lshrrev_b32 v118, 1, v118
    v_cmp_ne_u32 vcc, v118, v120
    s_nop 1
    v_addc_co_u32 v118, vcc, 0, v118, vcc
    v_lshlrev_b32 v118, 4, v118
    v_add_u32 v118, 155648, v118
    v_cmp_gt_u32 vcc, 16, v0
    v_mov_b32 v120, 4096
    s_lshr_b32 s50, s57, 1
    v_min_u32 v83, 2, v1
    v_lshlrev_b32 v83, 4, v83
    v_add_u32 v83, s50, v83
    v_cndmask_b32 v81, v118, v121, vcc
    v_cndmask_b32 v84, 0, v120, vcc
    v_mul_u32_u24 v83, 21846, v83
    v_lshrrev_b32 v83, 16, v83
    v_lshlrev_b32 v83, 7, v83
    v_add_u32 v83, 17825792, v83
    s_xor_b32 s51, s56, 2
    s_lshl_b32 s51, s51, 7
    s_add_u32 m0, s49, 73728
    s_add_u32 s51, s46, s51
    buffer_load_dwordx4 v72, s[8:11], s51 offen offset:0 lds
    buffer_load_dwordx4 v73, s[8:11], s51 offen offset:1024 lds
    buffer_load_dwordx4 v74, s[8:11], s51 offen offset:2048 lds
    buffer_load_dwordx4 v75, s[8:11], s51 offen offset:3072 lds
    s_waitcnt vmcnt(8)
    s_barrier
    s_cmp_eq_u32 s61, 0
    s_cbranch_scc1 L_noz
    v_lshlrev_b32 v118, 7, v1
    s_mov_b32 s50, 17825792
    buffer_store_dword v110, v118, s[20:23], s50 offen sc1
L_noz:
    ds_read_b128 v[128:131], v64 offset:8192
    ds_read_b64_tr_b16 v[48:49], v68 offset:24576
    ds_read_b64_tr_b16 v[50:51], v68 offset:25344
    ds_read_b64_tr_b16 v[52:53], v68 offset:24640
    ds_read_b64_tr_b16 v[54:55], v68 offset:25408
    ds_read_b128 v[132:135], v65 offset:8192
    ds_read_b64_tr_b16 v[56:57], v69 offset:24576
    ds_read_b64_tr_b16 v[58:59], v69 offset:25344
    ds_read_b64_tr_b16 v[60:61], v69 offset:24640
    ds_read_b64_tr_b16 v[62:63], v69 offset:25408
    s_cmp_ge_u32 s43, 11
    s_cbranch_scc1 L_p1n0
    s_waitcnt lgkmcnt(5)
    v_mfma_f32_32x32x16_bf16 v[16:31], v[48:51], v[128:131], 0
    ds_read_b128 v[136:139], v66 offset:8192
    ds_read_b64_tr_b16 v[8:9], v70 offset:24576
    ds_read_b64_tr_b16 v[10:11], v70 offset:25344
    v_mfma_f32_32x32x16_bf16 v[32:47], v[52:55], v[128:131], 0
    ds_read_b64_tr_b16 v[12:13], v70 offset:24640
    ds_read_b64_tr_b16 v[14:15], v70 offset:25408
    s_xor_b32 s51, s56, 3
    s_lshl_b32 s51, s51, 7
    s_add_u32 m0, s49, 106496
    s_add_u32 s51, s46, s51
    buffer_load_dwordx4 v72, s[8:11], s51 offen offset:0 lds
    buffer_load_dwordx4 v73, s[8:11], s51 offen offset:1024 lds
    s_waitcnt lgkmcnt(5)
    v_mfma_f32_32x32x16_bf16 v[16:31], v[56:59], v[132:135], v[16:31]
    ds_read_b128 v[140:143], v67 offset:8192
    ds_read_b64_tr_b16 v[48:49], v71 offset:24576
    ds_read_b64_tr_b16 v[50:51], v71 offset:25344
    v_mfma_f32_32x32x16_bf16 v[32:47], v[60:63], v[132:135], v[32:47]
    ds_read_b64_tr_b16 v[52:53], v71 offset:24640
    ds_read_b64_tr_b16 v[54:55], v71 offset:25408
    buffer_load_dwordx4 v74, s[8:11], s51 offen offset:2048 lds
    s_waitcnt vmcnt(7)
    s_barrier
    s_waitcnt lgkmcnt(5)
    v_mfma_f32_32x32x16_bf16 v[16:31], v[8:11], v[136:139], v[16:31]
    ds_read_b128 v[144:147], v64 offset:40960
    ds_read_b64_tr_b16 v[56:57], v68 offset:57344
    ds_read_b64_tr_b16 v[58:59], v68 offset:58112
    v_mfma_f32_32x32x16_bf16 v[32:47], v[12:15], v[136:139], v[32:47]
    ds_read_b64_tr_b16 v[60:61], v68 offset:57408
    ds_read_b64_tr_b16 v[62:63], v68 offset:58176
    buffer_load_dwordx4 v75, s[8:11], s51 offen offset:3072 lds
    s_waitcnt lgkmcnt(5)
    v_mfma_f32_32x32x16_bf16 v[16:31], v[48:51], v[140:143], v[16:31]
    ds_read_b128 v[148:151], v65 offset:40960
    ds_read_b64_tr_b16 v[8:9], v69 offset:57344
    ds_read_b64_tr_b16 v[10:11], v69 offset:58112
    v_mfma_f32_32x32x16_bf16 v[32:47], v[52:55], v[140:143], v[32:47]
    ds_read_b64_tr_b16 v[12:13], v69 offset:57408
    ds_read_b64_tr_b16 v[14:15], v69 offset:58176
    global_load_dword v117, v116, s[16:17]
    v_mfma_f32_16x16x32_bf16 v[88:91], v[96:99], v[48:51], 0
    v_mfma_f32_16x16x32_bf16 v[92:95], v[96:99], v[52:55], 0
    s_waitcnt lgkmcnt(5)
    v_mfma_f32_32x32x16_bf16 v[16:31], v[56:59], v[144:147], v[16:31]
    ds_read_b128 v[152:155], v66 offset:40960
    ds_read_b64_tr_b16 v[48:49], v70 offset:57344
    ds_read_b64_tr_b16 v[50:51], v70 offset:58112
    v_mfma_f32_32x32x16_bf16 v[32:47], v[60:63], v[144:147], v[32:47]
    ds_read_b64_tr_b16 v[52:53], v70 offset:57408
    ds_read_b64_tr_b16 v[54:55], v70 offset:58176
    global_load_ushort v108, v109, s[36:37]
    global_load_ushort v109, v109, s[36:37] offset:64
    s_waitcnt lgkmcnt(5)
    v_mfma_f32_32x32x16_bf16 v[16:31], v[8:11], v[148:151], v[16:31]
    ds_read_b128 v[156:159], v67 offset:40960
    ds_read_b64_tr_b16 v[56:57], v71 offset:57344
    ds_read_b64_tr_b16 v[58:59], v71 offset:58112
    v_mfma_f32_32x32x16_bf16 v[32:47], v[12:15], v[148:151], v[32:47]
    ds_read_b64_tr_b16 v[60:61], v71 offset:57408
    ds_read_b64_tr_b16 v[62:63], v71 offset:58176
    v_xor_b32 v64, 0x10000, v64
    v_xor_b32 v68, 0x10000, v68
    s_waitcnt vmcnt(7)
    s_barrier
    s_waitcnt lgkmcnt(5)
    v_mfma_f32_32x32x16_bf16 v[16:31], v[48:51], v[152:155], v[16:31]
    ds_read_b128 v[160:163], v64 offset:8192
    ds_read_b64_tr_b16 v[8:9], v68 offset:24576
    ds_read_b64_tr_b16 v[10:11], v68 offset:25344
    v_mfma_f32_32x32x16_bf16 v[32:47], v[52:55], v[152:155], v[32:47]
    ds_read_b64_tr_b16 v[12:13], v68 offset:24640
    ds_read_b64_tr_b16 v[14:15], v68 offset:25408
    s_xor_b32 s51, s56, 4
    s_lshl_b32 s51, s51, 7
    s_add_u32 m0, s49, 8192
    s_add_u32 s51, s46, s51
    buffer_load_dwordx4 v72, s[8:11], s51 offen offset:0 lds
    v_xor_b32 v65, 0x10000, v65
    v_xor_b32 v69, 0x10000, v69
    s_waitcnt lgkmcnt(5)
    v_mfma_f32_32x32x16_bf16 v[16:31], v[56:59], v[156:159], v[16:31]
    ds_read_b128 v[164:167], v65 offset:8192
    ds_read_b64_tr_b16 v[48:49], v69 offset:24576
    ds_read_b64_tr_b16 v[50:51], v69 offset:25344
    v_mfma_f32_32x32x16_bf16 v[32:47], v[60:63], v[156:159], v[32:47]
    ds_read_b64_tr_b16 v[52:53], v69 offset:24640
    ds_read_b64_tr_b16 v[54:55], v69 offset:25408
    buffer_load_dwordx4 v73, s[8:11], s51 offen offset:1024 lds
    v_mfma_f32_16x16x32_bf16 v[88:91], v[96:99], v[56:59], v[88:91]
    v_mfma_f32_16x16x32_bf16 v[92:95], v[96:99], v[60:63], v[92:95]
    v_xor_b32 v66, 0x10000, v66
    v_xor_b32 v70, 0x10000, v70
    s_waitcnt lgkmcnt(5)
    v_mfma_f32_32x32x16_bf16 v[16:31], v[8:11], v[160:163], v[16:31]
    ds_read_b128 v[168:171], v66 offset:8192
    ds_read_b64_tr_b16 v[56:57], v70 offset:24576
    ds_read_b64_tr_b16 v[58:59], v70 offset:25344
    v_mfma_f32_32x32x16_bf16 v[32:47], v[12:15], v[160:163], v[32:47]
    ds_read_b64_tr_b16 v[60:61], v70 offset:24640
    ds_read_b64_tr_b16 v[62:63], v70 offset:25408
    buffer_load_dwordx4 v74, s[8:11], s51 offen offset:2048 lds
    v_xor_b32 v67, 0x10000, v67
    v_xor_b32 v71, 0x10000, v71
    s_waitcnt lgkmcnt(5)
    v_mfma_f32_32x32x16_bf16 v[16:31], v[48:51], v[164:167], v[16:31]
    ds_read_b128 v[172:175], v67 offset:8192
    ds_read_b64_tr_b16 v[8:9], v71 offset:24576
    ds_read_b64_tr_b16 v[10:11], v71 offset:25344
    v_mfma_f32_32x32x16_bf16 v[32:47], v[52:55], v[164:167], v[32:47]
    ds_read_b64_tr_b16 v[12:13], v71 offset:24640
    ds_read_b64_tr_b16 v[14:15], v71 offset:25408
    buffer_load_dwordx4 v75, s[8:11], s51 offen offset:3072 lds
    s_waitcnt vmcnt(7)
    s_barrier
    s_waitcnt lgkmcnt(5)
    v_mfma_f32_32x32x16_bf16 v[16:31], v[56:59], v[168:171], v[16:31]
    ds_read_b128 v[176:179], v64 offset:40960
    ds_read_b64_tr_b16 v[48:49], v68 offset:57344
    ds_read_b64_tr_b16 v[50:51], v68 offset:58112
    v_mfma_f32_32x32x16_bf16 v[32:47], v[60:63], v[168:171], v[32:47]
    ds_read_b64_tr_b16 v[52:53], v68 offset:57408
    ds_read_b64_tr_b16 v[54:55], v68 offset:58176
    s_xor_b32 s51, s56, 5
    s_lshl_b32 s51, s51, 7
    s_add_u32 m0, s49, 40960
    s_add_u32 s51, s46, s51
    buffer_load_dwordx4 v72, s[8:11], s51 offen offset:0 lds
    s_waitcnt lgkmcnt(5)
    v_mfma_f32_32x32x16_bf16 v[16:31], v[8:11], v[172:175], v[16:31]
    ds_read_b128 v[180:183], v65 offset:40960
    ds_read_b64_tr_b16 v[56:57], v69 offset:57344
    ds_read_b64_tr_b16 v[58:59], v69 offset:58112
    v_mfma_f32_32x32x16_bf16 v[32:47], v[12:15], v[172:175], v[32:47]
    ds_read_b64_tr_b16 v[60:61], v69 offset:57408
    ds_read_b64_tr_b16 v[62:63], v69 offset:58176
    buffer_load_dwordx4 v73, s[8:11], s51 offen offset:1024 lds
    v_mfma_f32_16x16x32_bf16 v[88:91], v[96:99], v[8:11], v[88:91]
    v_mfma_f32_16x16x32_bf16 v[92:95], v[96:99], v[12:15], v[92:95]
    s_waitcnt lgkmcnt(5)
    v_mfma_f32_32x32x16_bf16 v[16:31], v[48:51], v[176:179], v[16:31]
    ds_read_b128 v[184:187], v66 offset:40960
    ds_read_b64_tr_b16 v[8:9], v70 offset:57344
    ds_read_b64_tr_b16 v[10:11], v70 offset:58112
    v_mfma_f32_32x32x16_bf16 v[32:47], v[52:55], v[176:179], v[32:47]
    ds_read_b64_tr_b16 v[12:13], v70 offset:57408
    ds_read_b64_tr_b16 v[14:15], v70 offset:58176
    buffer_load_dwordx4 v74, s[8:11], s51 offen offset:2048 lds
    s_waitcnt lgkmcnt(5)
    v_mfma_f32_32x32x16_bf16 v[16:31], v[56:59], v[180:183], v[16:31]
    ds_read_b128 v[188:191], v67 offset:40960
    ds_read_b64_tr_b16 v[48:49], v71 offset:57344
    ds_read_b64_tr_b16 v[50:51], v71 offset:58112
    v_mfma_f32_32x32x16_bf16 v[32:47], v[60:63], v[180:183], v[32:47]
    ds_read_b64_tr_b16 v[52:53], v71 offset:57408
    ds_read_b64_tr_b16 v[54:55], v71 offset:58176
    buffer_load_dwordx4 v75, s[8:11], s51 offen offset:3072 lds
    v_xor_b32 v64, 0x10000, v64
    v_xor_b32 v68, 0x10000, v68
    s_waitcnt vmcnt(4)
    s_cmp_eq_u32 s61, 0
    s_cbranch_scc1 Lz1
    v_mov_b32 v118, 1
    s_mov_b64 exec, 1
    global_store_dword v110, v118, s[40:41] sc1
    s_mov_b64 exec, -1
Lz1:
    s_barrier
    s_waitcnt lgkmcnt(5)
    v_mfma_f32_32x32x16_bf16 v[16:31], v[8:11], v[184:187], v[16:31]
    ds_read_b128 v[192:195], v64 offset:8192
    ds_read_b64_tr_b16 v[56:57], v68 offset:24576
    ds_read_b64_tr_b16 v[58:59], v68 offset:25344
    v_mfma_f32_32x32x16_bf16 v[32:47], v[12:15], v[184:187], v[32:47]
    ds_read_b64_tr_b16 v[60:61], v68 offset:24640
    ds_read_b64_tr_b16 v[62:63], v68 offset:25408
    s_xor_b32 s51, s56, 6
    s_lshl_b32 s51, s51, 7
    s_add_u32 m0, s49, 73728
    s_add_u32 s51, s46, s51
    buffer_load_dwordx4 v72, s[8:11], s51 offen offset:0 lds
    v_xor_b32 v65, 0x10000, v65
    v_xor_b32 v69, 0x10000, v69
    s_waitcnt lgkmcnt(5)
    v_mfma_f32_32x32x16_bf16 v[16:31], v[48:51], v[188:191], v[16:31]
    ds_read_b128 v[196:199], v65 offset:8192
    ds_read_b64_tr_b16 v[8:9], v69 offset:24576
    ds_read_b64_tr_b16 v[10:11], v69 offset:25344
    v_mfma_f32_32x32x16_bf16 v[32:47], v[52:55], v[188:191], v[32:47]
    ds_read_b64_tr_b16 v[12:13], v69 offset:24640
    ds_read_b64_tr_b16 v[14:15], v69 offset:25408
    buffer_load_dwordx4 v73, s[8:11], s51 offen offset:1024 lds
    v_mfma_f32_16x16x32_bf16 v[88:91], v[96:99], v[48:51], v[88:91]
    v_mfma_f32_16x16x32_bf16 v[92:95], v[96:99], v[52:55], v[92:95]
    v_xor_b32 v66, 0x10000, v66
    v_xor_b32 v70, 0x10000, v70
    s_waitcnt lgkmcnt(5)
    v_mfma_f32_32x32x16_bf16 v[16:31], v[56:59], v[192:195], v[16:31]
    ds_read_b128 v[200:203], v66 offset:8192
    ds_read_b64_tr_b16 v[48:49], v70 offset:24576
    ds_read_b64_tr_b16 v[50:51], v70 offset:25344
    v_mfma_f32_32x32x16_bf16 v[32:47], v[60:63], v[192:195], v[32:47]
    ds_read_b64_tr_b16 v[52:53], v70 offset:24640
    ds_read_b64_tr_b16 v[54:55], v70 offset:25408
    buffer_load_dwordx4 v74, s[8:11], s51 offen offset:2048 lds
    v_xor_b32 v67, 0x10000, v67
    v_xor_b32 v71, 0x10000, v71
    s_waitcnt lgkmcnt(5)
    v_mfma_f32_32x32x16_bf16 v[16:31], v[8:11], v[196:199], v[16:31]
    ds_read_b128 v[204:207], v67 offset:8192
    ds_read_b64_tr_b16 v[56:57], v71 offset:24576
    ds_read_b64_tr_b16 v[58:59], v71 offset:25344
    v_mfma_f32_32x32x16_bf16 v[32:47], v[12:15], v[196:199], v[32:47]
    ds_read_b64_tr_b16 v[60:61], v71 offset:24640
    ds_read_b64_tr_b16 v[62:63], v71 offset:25408
    buffer_load_dwordx4 v75, s[8:11], s51 offen offset:3072 lds
    s_waitcnt vmcnt(4)
    s_barrier
    s_waitcnt lgkmcnt(5)
    v_mfma_f32_32x32x16_bf16 v[16:31], v[48:51], v[200:203], v[16:31]
    ds_read_b128 v[208:211], v64 offset:40960
    ds_read_b64_tr_b16 v[8:9], v68 offset:57344
    ds_read_b64_tr_b16 v[10:11], v68 offset:58112
    v_mfma_f32_32x32x16_bf16 v[32:47], v[52:55], v[200:203], v[32:47]
    ds_read_b64_tr_b16 v[12:13], v68 offset:57408
    ds_read_b64_tr_b16 v[14:15], v68 offset:58176
    s_xor_b32 s51, s56, 7
    s_lshl_b32 s51, s51, 7
    s_add_u32 m0, s49, s54
    s_add_u32 s51, s46, s51
    buffer_load_dwordx4 v72, s[8:11], s51 offen offset:0 lds
    buffer_load_dwordx4 v73, s[8:11], s51 offen offset:1024 lds
    s_waitcnt lgkmcnt(5)
    v_mfma_f32_32x32x16_bf16 v[16:31], v[56:59], v[204:207], v[16:31]
    ds_read_b128 v[212:215], v65 offset:40960
    ds_read_b64_tr_b16 v[48:49], v69 offset:57344
    ds_read_b64_tr_b16 v[50:51], v69 offset:58112
    v_mfma_f32_32x32x16_bf16 v[32:47], v[60:63], v[204:207], v[32:47]
    ds_read_b64_tr_b16 v[52:53], v69 offset:57408
    ds_read_b64_tr_b16 v[54:55], v69 offset:58176
    buffer_load_dwordx4 v74, s[8:11], s51 offen offset:2048 lds
    buffer_load_dwordx4 v75, s[8:11], s51 offen offset:3072 lds
    v_mfma_f32_16x16x32_bf16 v[88:91], v[96:99], v[56:59], v[88:91]
    v_mfma_f32_16x16x32_bf16 v[92:95], v[96:99], v[60:63], v[92:95]
    s_waitcnt lgkmcnt(5)
    v_mfma_f32_32x32x16_bf16 v[16:31], v[8:11], v[208:211], v[16:31]
    ds_read_b128 v[216:219], v66 offset:40960
    ds_read_b64_tr_b16 v[56:57], v70 offset:57344
    ds_read_b64_tr_b16 v[58:59], v70 offset:58112
    v_mfma_f32_32x32x16_bf16 v[32:47], v[12:15], v[208:211], v[32:47]
    ds_read_b64_tr_b16 v[60:61], v70 offset:57408
    ds_read_b64_tr_b16 v[62:63], v70 offset:58176
    s_xor_b32 s51, s56, 0
    s_mul_i32 s51, s51, 229376
    s_add_u32 m0, s100, 106496
    s_add_u32 s51, s101, s51
    buffer_load_dwordx4 v76, s[16:19], s51 offen offset:0 lds
    s_waitcnt lgkmcnt(5)
    v_mfma_f32_32x32x16_bf16 v[16:31], v[48:51], v[212:215], v[16:31]
    ds_read_b128 v[220:223], v67 offset:40960
    ds_read_b64_tr_b16 v[8:9], v71 offset:57344
    ds_read_b64_tr_b16 v[10:11], v71 offset:58112
    v_mfma_f32_32x32x16_bf16 v[32:47], v[52:55], v[212:215], v[32:47]
    ds_read_b64_tr_b16 v[12:13], v71 offset:57408
    ds_read_b64_tr_b16 v[14:15], v71 offset:58176
    buffer_load_dwordx4 v77, s[16:19], s51 offen offset:1024 lds
    v_xor_b32 v64, 0x10000, v64
    v_xor_b32 v68, 0x10000, v68
    s_waitcnt vmcnt(6)
    s_barrier
    s_waitcnt lgkmcnt(5)
    v_mfma_f32_32x32x16_bf16 v[16:31], v[56:59], v[216:219], v[16:31]
    ds_read_b128 v[224:227], v64 offset:8192
    ds_read_b64_tr_b16 v[48:49], v68 offset:24576
    ds_read_b64_tr_b16 v[50:51], v68 offset:25344
    v_mfma_f32_32x32x16_bf16 v[32:47], v[60:63], v[216:219], v[32:47]
    ds_read_b64_tr_b16 v[52:53], v68 offset:24640
    ds_read_b64_tr_b16 v[54:55], v68 offset:25408
    buffer_load_dwordx4 v78, s[16:19], s51 offen offset:2048 lds
    buffer_load_dwordx4 v79, s[16:19], s51 offen offset:3072 lds
    v_xor_b32 v65, 0x10000, v65
    v_xor_b32 v69, 0x10000, v69
    s_waitcnt lgkmcnt(5)
    v_mfma_f32_32x32x16_bf16 v[16:31], v[8:11], v[220:223], v[16:31]
    ds_read_b128 v[228:231], v65 offset:8192
    ds_read_b64_tr_b16 v[56:57], v69 offset:24576
    ds_read_b64_tr_b16 v[58:59], v69 offset:25344
    v_mfma_f32_32x32x16_bf16 v[32:47], v[12:15], v[220:223], v[32:47]
    ds_read_b64_tr_b16 v[60:61], v69 offset:24640
    ds_read_b64_tr_b16 v[62:63], v69 offset:25408
    s_xor_b32 s51, s56, 2
    s_mul_i32 s51, s51, 229376
    s_add_u32 m0, s100, 8192
    s_add_u32 s51, s101, s51
    buffer_load_dwordx4 v76, s[16:19], s51 offen offset:0 lds
    v_mfma_f32_16x16x32_bf16 v[88:91], v[96:99], v[8:11], v[88:91]
    v_mfma_f32_16x16x32_bf16 v[92:95], v[96:99], v[12:15], v[92:95]
    v_xor_b32 v66, 0x10000, v66
    v_xor_b32 v70, 0x10000, v70
    s_waitcnt lgkmcnt(5)
    v_mfma_f32_32x32x16_bf16 v[16:31], v[48:51], v[224:227], v[16:31]
    ds_read_b128 v[232:235], v66 offset:8192
    ds_read_b64_tr_b16 v[8:9], v70 offset:24576
    ds_read_b64_tr_b16 v[10:11], v70 offset:25344
    v_mfma_f32_32x32x16_bf16 v[32:47], v[52:55], v[224:227], v[32:47]
    ds_read_b64_tr_b16 v[12:13], v70 offset:24640
    ds_read_b64_tr_b16 v[14:15], v70 offset:25408
    buffer_load_dwordx4 v77, s[16:19], s51 offen offset:1024 lds
    v_xor_b32 v67, 0x10000, v67
    v_xor_b32 v71, 0x10000, v71
    s_waitcnt lgkmcnt(5)
    v_mfma_f32_32x32x16_bf16 v[16:31], v[56:59], v[228:231], v[16:31]
    ds_read_b128 v[236:239], v67 offset:8192
    ds_read_b64_tr_b16 v[48:49], v71 offset:24576
    ds_read_b64_tr_b16 v[50:51], v71 offset:25344
    v_mfma_f32_32x32x16_bf16 v[32:47], v[60:63], v[228:231], v[32:47]
    ds_read_b64_tr_b16 v[52:53], v71 offset:24640
    ds_read_b64_tr_b16 v[54:55], v71 offset:25408
    buffer_load_dwordx4 v78, s[16:19], s51 offen offset:2048 lds
    v_add_u32 v64, s52, v64
    v_add_u32 v68, 81920, v68
    s_waitcnt vmcnt(7)
    s_barrier
    s_waitcnt lgkmcnt(5)
    v_mfma_f32_32x32x16_bf16 v[16:31], v[8:11], v[232:235], v[16:31]
    ds_read_b128 v[240:243], v64 offset:0
    ds_read_b64_tr_b16 v[56:57], v68 offset:0
    ds_read_b64_tr_b16 v[58:59], v68 offset:768
    v_mfma_f32_32x32x16_bf16 v[32:47], v[12:15], v[232:235], v[32:47]
    ds_read_b64_tr_b16 v[60:61], v68 offset:64
    ds_read_b64_tr_b16 v[62:63], v68 offset:832
    buffer_load_dwordx4 v79, s[16:19], s51 offen offset:3072 lds
    v_add_u32 v65, s52, v65
    v_add_u32 v69, 81920, v69
    s_waitcnt lgkmcnt(5)
    v_mfma_f32_32x32x16_bf16 v[16:31], v[48:51], v[236:239], v[16:31]
    ds_read_b128 v[244:247], v65 offset:0
    ds_read_b64_tr_b16 v[8:9], v69 offset:0
    ds_read_b64_tr_b16 v[10:11], v69 offset:768
    v_mfma_f32_32x32x16_bf16 v[32:47], v[52:55], v[236:239], v[32:47]
    ds_read_b64_tr_b16 v[12:13], v69 offset:64
    ds_read_b64_tr_b16 v[14:15], v69 offset:832
    s_xor_b32 s51, s56, 4
    s_mul_i32 s51, s51, 229376
    s_add_u32 m0, s100, 40960
    s_add_u32 s51, s101, s51
    buffer_load_dwordx4 v76, s[16:19], s51 offen offset:0 lds
    v_mfma_f32_16x16x32_bf16 v[88:91], v[96:99], v[48:51], v[88:91]
    v_mfma_f32_16x16x32_bf16 v[92:95], v[96:99], v[52:55], v[92:95]
    v_add_u32 v66, s52, v66
    v_add_u32 v70, 81920, v70
    s_waitcnt lgkmcnt(5)
    v_mfma_f32_32x32x16_bf16 v[16:31], v[56:59], v[240:243], v[16:31]
    ds_read_b128 v[248:251], v66 offset:0
    ds_read_b64_tr_b16 v[48:49], v70 offset:0
    ds_read_b64_tr_b16 v[50:51], v70 offset:768
    v_mfma_f32_32x32x16_bf16 v[32:47], v[60:63], v[240:243], v[32:47]
    ds_read_b64_tr_b16 v[52:53], v70 offset:64
    ds_read_b64_tr_b16 v[54:55], v70 offset:832
    buffer_load_dwordx4 v77, s[16:19], s51 offen offset:1024 lds
    v_add_u32 v67, s52, v67
    v_add_u32 v71, 81920, v71
    s_waitcnt lgkmcnt(5)
    v_mfma_f32_32x32x16_bf16 v[16:31], v[8:11], v[244:247], v[16:31]
    ds_read_b128 v[252:255], v67 offset:0
    ds_read_b64_tr_b16 v[56:57], v71 offset:0
    ds_read_b64_tr_b16 v[58:59], v71 offset:768
    v_mfma_f32_32x32x16_bf16 v[32:47], v[12:15], v[244:247], v[32:47]
    ds_read_b64_tr_b16 v[60:61], v71 offset:64
    ds_read_b64_tr_b16 v[62:63], v71 offset:832
    buffer_load_dwordx4 v78, s[16:19], s51 offen offset:2048 lds
    s_barrier
    s_waitcnt lgkmcnt(5)
    v_mfma_f32_32x32x16_bf16 v[16:31], v[48:51], v[248:251], v[16:31]
    v_mfma_f32_32x32x16_bf16 v[32:47], v[52:55], v[248:251], v[32:47]
    buffer_load_dwordx4 v79, s[16:19], s51 offen offset:3072 lds
    s_xor_b32 s51, s56, 6
    s_mul_i32 s51, s51, 229376
    s_add_u32 m0, s100, 73728
    s_add_u32 s51, s101, s51
    buffer_load_dwordx4 v76, s[16:19], s51 offen offset:0 lds
    s_waitcnt lgkmcnt(0)
    v_mfma_f32_32x32x16_bf16 v[16:31], v[56:59], v[252:255], v[16:31]
    v_mfma_f32_32x32x16_bf16 v[32:47], v[60:63], v[252:255], v[32:47]
    buffer_load_dwordx4 v77, s[16:19], s51 offen offset:1024 lds
    buffer_load_dwordx4 v78, s[16:19], s51 offen offset:2048 lds
    v_mfma_f32_16x16x32_bf16 v[88:91], v[96:99], v[56:59], v[88:91]
    v_mfma_f32_16x16x32_bf16 v[92:95], v[96:99], v[60:63], v[92:95]
    buffer_load_dwordx4 v79, s[16:19], s51 offen offset:3072 lds
    s_lshl_b32 s50, s44, 8
    s_add_u32 s51, s50, 159744
    v_lshl_add_u32 v116, v0, 3, s51
    v_lshlrev_b32 v117, 4, v0
    v_add_u32 v117, 160768, v117
    s_lshl_b32 s50, s44, 2
    v_add_u32 v118, s50, v117
    s_mul_i32 s52, s43, 3
    s_add_u32 s52, s52, 0
    s_lshl_b32 s55, s52, 17
    s_lshl_b32 s50, s42, 2
    s_add_u32 s50, s50, s44
    s_mul_i32 s54, s50, 114688
    s_lshl_b32 s50, s50, 10
    s_add_u32 s55, s55, s50
    ds_write_b32 v118, v88
    ds_write_b32 v118, v92 offset:512
    s_lshl_b32 s50, s48, 5
    s_add_u32 s54, s54, s50
    s_add_u32 s54, s54, 10485760
    s_waitcnt vmcnt(8) lgkmcnt(0)
    s_barrier
    ds_read_b64 v[8:9], v116
    ds_read_b128 v[88:91], v117
    ds_read_b128 v[92:95], v117 offset:512
    s_setprio 2
    ds_read_b64_tr_b16 v[48:49], v4 offset:40960
    ds_read_b64_tr_b16 v[50:51], v4 offset:41984
    ds_read_b64_tr_b16 v[52:53], v5 offset:40960
    ds_read_b64_tr_b16 v[54:55], v5 offset:41984
    ds_read_b64_tr_b16 v[56:57], v6 offset:40960
    ds_read_b64_tr_b16 v[58:59], v6 offset:41984
    ds_read_b64_tr_b16 v[60:61], v7 offset:40960
    ds_read_b64_tr_b16 v[62:63], v7 offset:41984
    s_waitcnt lgkmcnt(6)
    v_mfma_f32_32x32x16_bf16 v[64:79], v[48:51], v[128:131], 0
    ds_read_b64_tr_b16 v[48:49], v4 offset:57344
    ds_read_b64_tr_b16 v[50:51], v4 offset:58368
    v_mul_f32 v8, 0xbb000000, v8
    v_mul_f32 v9, 0x3b000000, v9
    v_add_f32 v88, v88, v89
    v_fma_f32 v9, -v8, v8, v9
    s_waitcnt lgkmcnt(6)
    v_mfma_f32_32x32x16_bf16 v[64:79], v[52:55], v[132:135], v[64:79]
    ds_read_b64_tr_b16 v[52:53], v5 offset:57344
    ds_read_b64_tr_b16 v[54:55], v5 offset:58368
    v_add_f32 v90, v90, v91
    v_max_f32 v82, 0, v9
    v_add_f32 v13, v88, v90
    v_add_f32 v9, 0x3727c5ac, v82
    s_waitcnt lgkmcnt(6)
    v_mfma_f32_32x32x16_bf16 v[64:79], v[56:59], v[136:139], v[64:79]
    ds_read_b64_tr_b16 v[56:57], v6 offset:57344
    ds_read_b64_tr_b16 v[58:59], v6 offset:58368
    v_rsq_f32 v111, v9
    v_cvt_pk_bf16_f32 v10, v8, v8
    v_and_b32 v10, 0xffff0000, v10
    v_sub_f32 v11, v8, v10
    s_waitcnt lgkmcnt(6)
    v_mfma_f32_32x32x16_bf16 v[64:79], v[60:63], v[140:143], v[64:79]
    ds_read_b64_tr_b16 v[60:61], v7 offset:57344
    ds_read_b64_tr_b16 v[62:63], v7 offset:58368
    v_cvt_pk_bf16_f32 v12, v10, v11
    v_add_f32 v92, v92, v93
    v_add_f32 v94, v94, v95
    v_add_f32 v14, v92, v94
    s_waitcnt lgkmcnt(6)
    v_mfma_f32_32x32x16_bf16 v[64:79], v[48:51], v[144:147], v[64:79]
    v_xor_b32 v4, 0x10000, v4
    ds_read_b64_tr_b16 v[48:49], v4 offset:8192
    ds_read_b64_tr_b16 v[50:51], v4 offset:9216
    v_cndmask_b32 v100, 0, v12, s[6:7]
    v_cndmask_b32 v101, 0, v12, s[6:7]
    v_cvt_pk_bf16_f32 v104, v13, v13
    v_and_b32 v10, 0xffff0000, v104
    s_waitcnt lgkmcnt(6)
    v_mfma_f32_32x32x16_bf16 v[64:79], v[52:55], v[148:151], v[64:79]
    v_xor_b32 v5, 0x10000, v5
    ds_read_b64_tr_b16 v[52:53], v5 offset:8192
    ds_read_b64_tr_b16 v[54:55], v5 offset:9216
    v_sub_f32 v10, v13, v10
    v_cvt_pk_bf16_f32 v105, v10, v10
    s_cmp_lt_u32 s52, 16
    s_cselect_b32 s50, 0x3eb8aa3b, 1.0
    v_mfma_f32_32x32x16_bf16 v[16:31], v[104:107], v[100:103], v[16:31]
    v_mul_f32 v13, s50, v111
    s_waitcnt lgkmcnt(6)
    v_mfma_f32_32x32x16_bf16 v[64:79], v[56:59], v[152:155], v[64:79]
    v_xor_b32 v6, 0x10000, v6
    ds_read_b64_tr_b16 v[56:57], v6 offset:8192
    ds_read_b64_tr_b16 v[58:59], v6 offset:9216
    v_cvt_pk_bf16_f32 v104, v14, v14
    v_and_b32 v10, 0xffff0000, v104
    v_sub_f32 v10, v14, v10
    v_cvt_pk_bf16_f32 v105, v10, v10
    s_waitcnt lgkmcnt(6)
    v_mfma_f32_32x32x16_bf16 v[64:79], v[60:63], v[156:159], v[64:79]
    v_xor_b32 v7, 0x10000, v7
    ds_read_b64_tr_b16 v[60:61], v7 offset:8192
    ds_read_b64_tr_b16 v[62:63], v7 offset:9216
    s_cmp_lt_u32 s52, 15
    s_cselect_b32 s50, 0x3eb8aa3b, 1.0
    v_mfma_f32_32x32x16_bf16 v[32:47], v[104:107], v[100:103], v[32:47]
    v_mul_f32 v14, s50, v111
    s_waitcnt lgkmcnt(6)
    v_mfma_f32_32x32x16_bf16 v[64:79], v[48:51], v[160:163], v[64:79]
    ds_read_b64_tr_b16 v[48:49], v4 offset:24576
    ds_read_b64_tr_b16 v[50:51], v4 offset:25600
    s_waitcnt lgkmcnt(6)
    v_mfma_f32_32x32x16_bf16 v[64:79], v[52:55], v[164:167], v[64:79]
    ds_read_b64_tr_b16 v[52:53], v5 offset:24576
    ds_read_b64_tr_b16 v[54:55], v5 offset:25600
    v_mul_f32 v16, v16, v13
    v_mul_f32 v17, v17, v13
    v_mul_f32 v18, v18, v13
    v_mul_f32 v19, v19, v13
    s_waitcnt lgkmcnt(6)
    v_mfma_f32_32x32x16_bf16 v[64:79], v[56:59], v[168:171], v[64:79]
    ds_read_b64_tr_b16 v[56:57], v6 offset:24576
    ds_read_b64_tr_b16 v[58:59], v6 offset:25600
    v_mul_f32 v20, v20, v13
    v_mul_f32 v21, v21, v13
    v_mul_f32 v22, v22, v13
    v_mul_f32 v23, v23, v13
    s_waitcnt lgkmcnt(6)
    v_mfma_f32_32x32x16_bf16 v[64:79], v[60:63], v[172:175], v[64:79]
    ds_read_b64_tr_b16 v[60:61], v7 offset:24576
    ds_read_b64_tr_b16 v[62:63], v7 offset:25600
    v_mul_f32 v24, v24, v13
    v_mul_f32 v25, v25, v13
    v_mul_f32 v26, v26, v13
    v_mul_f32 v27, v27, v13
    s_waitcnt lgkmcnt(6)
    v_mfma_f32_32x32x16_bf16 v[64:79], v[48:51], v[176:179], v[64:79]
    s_waitcnt vmcnt(0)
    s_barrier
    ds_read_b64_tr_b16 v[48:49], v4 offset:40960
    ds_read_b64_tr_b16 v[50:51], v4 offset:41984
    v_mul_f32 v28, v28, v13
    v_mul_f32 v29, v29, v13
    v_mul_f32 v30, v30, v13
    v_mul_f32 v31, v31, v13
    s_waitcnt lgkmcnt(6)
    v_mfma_f32_32x32x16_bf16 v[64:79], v[52:55], v[180:183], v[64:79]
    ds_read_b64_tr_b16 v[52:53], v5 offset:40960
    ds_read_b64_tr_b16 v[54:55], v5 offset:41984
    v_cvt_pk_bf16_f32 v16, v16, v17
    v_cvt_pk_bf16_f32 v17, v18, v19
    v_cvt_pk_bf16_f32 v18, v20, v21
    v_cvt_pk_bf16_f32 v19, v22, v23
    s_waitcnt lgkmcnt(6)
    v_mfma_f32_32x32x16_bf16 v[64:79], v[56:59], v[184:187], v[64:79]
    ds_read_b64_tr_b16 v[56:57], v6 offset:40960
    ds_read_b64_tr_b16 v[58:59], v6 offset:41984
    v_cvt_pk_bf16_f32 v20, v24, v25
    v_cvt_pk_bf16_f32 v21, v26, v27
    v_cvt_pk_bf16_f32 v22, v28, v29
    v_cvt_pk_bf16_f32 v23, v30, v31
    s_waitcnt lgkmcnt(6)
    v_mfma_f32_32x32x16_bf16 v[64:79], v[60:63], v[188:191], v[64:79]
    ds_read_b64_tr_b16 v[60:61], v7 offset:40960
    ds_read_b64_tr_b16 v[62:63], v7 offset:41984
    s_add_u32 s50, s55, 0
    buffer_store_dwordx4 v[16:19], v2, s[20:23], s50 offen sc1
    s_add_u32 s50, s55, 65536
    buffer_store_dwordx4 v[20:23], v2, s[20:23], s50 offen sc1
    v_mul_f32 v32, v32, v14
    v_mul_f32 v33, v33, v14
    s_waitcnt lgkmcnt(6)
    v_mfma_f32_32x32x16_bf16 v[64:79], v[48:51], v[192:195], v[64:79]
    ds_read_b64_tr_b16 v[48:49], v4 offset:57344
    ds_read_b64_tr_b16 v[50:51], v4 offset:58368
    v_mul_f32 v34, v34, v14
    v_mul_f32 v35, v35, v14
    v_mul_f32 v36, v36, v14
    v_mul_f32 v37, v37, v14
    s_waitcnt lgkmcnt(6)
    v_mfma_f32_32x32x16_bf16 v[64:79], v[52:55], v[196:199], v[64:79]
    ds_read_b64_tr_b16 v[52:53], v5 offset:57344
    ds_read_b64_tr_b16 v[54:55], v5 offset:58368
    v_mul_f32 v38, v38, v14
    v_mul_f32 v39, v39, v14
    v_mul_f32 v40, v40, v14
    v_mul_f32 v41, v41, v14
    s_waitcnt lgkmcnt(6)
    v_mfma_f32_32x32x16_bf16 v[64:79], v[56:59], v[200:203], v[64:79]
    ds_read_b64_tr_b16 v[56:57], v6 offset:57344
    ds_read_b64_tr_b16 v[58:59], v6 offset:58368
    v_mul_f32 v42, v42, v14
    v_mul_f32 v43, v43, v14
    v_mul_f32 v44, v44, v14
    v_mul_f32 v45, v45, v14
    s_waitcnt lgkmcnt(6)
    v_mfma_f32_32x32x16_bf16 v[64:79], v[60:63], v[204:207], v[64:79]
    ds_read_b64_tr_b16 v[60:61], v7 offset:57344
    ds_read_b64_tr_b16 v[62:63], v7 offset:58368
    v_mul_f32 v46, v46, v14
    v_mul_f32 v47, v47, v14
    v_cvt_pk_bf16_f32 v32, v32, v33
    v_cvt_pk_bf16_f32 v33, v34, v35
    s_waitcnt lgkmcnt(6)
    v_mfma_f32_32x32x16_bf16 v[64:79], v[48:51], v[208:211], v[64:79]
    v_xor_b32 v4, 0x10000, v4
    ds_read_b64_tr_b16 v[48:49], v4 offset:8192
    ds_read_b64_tr_b16 v[50:51], v4 offset:9216
    v_cvt_pk_bf16_f32 v34, v36, v37
    v_cvt_pk_bf16_f32 v35, v38, v39
    v_cvt_pk_bf16_f32 v36, v40, v41
    v_cvt_pk_bf16_f32 v37, v42, v43
    s_waitcnt lgkmcnt(6)
    v_mfma_f32_32x32x16_bf16 v[64:79], v[52:55], v[212:215], v[64:79]
    v_xor_b32 v5, 0x10000, v5
    ds_read_b64_tr_b16 v[52:53], v5 offset:8192
    ds_read_b64_tr_b16 v[54:55], v5 offset:9216
    v_cvt_pk_bf16_f32 v38, v44, v45
    v_cvt_pk_bf16_f32 v39, v46, v47
    s_add_u32 s50, s55, 131072
    buffer_store_dwordx4 v[32:35], v2, s[20:23], s50 offen sc1
    s_add_u32 s50, s55, 196608
    buffer_store_dwordx4 v[36:39], v2, s[20:23], s50 offen sc1
    s_waitcnt lgkmcnt(6)
    v_mfma_f32_32x32x16_bf16 v[64:79], v[56:59], v[216:219], v[64:79]
    v_xor_b32 v6, 0x10000, v6
    ds_read_b64_tr_b16 v[56:57], v6 offset:8192
    ds_read_b64_tr_b16 v[58:59], v6 offset:9216
    v_add_f32 v8, 0x3727c5ac, v82
    v_fmamk_f32 v8, v8, 0x3727c5ac, v82
    v_rsq_f32 v9, v8
    s_nop 0
    v_mul_f32 v114, v8, v9
    s_waitcnt lgkmcnt(6)
    v_mfma_f32_32x32x16_bf16 v[64:79], v[60:63], v[220:223], v[64:79]
    v_xor_b32 v7, 0x10000, v7
    ds_read_b64_tr_b16 v[60:61], v7 offset:8192
    ds_read_b64_tr_b16 v[62:63], v7 offset:9216
    v_mul_f32 v112, 0xc0135761, v9
    v_mul_f32 v9, v9, v9
    v_mul_f32 v9, 0x3d372713, v9
    v_mul_f32 v113, v112, v9
    s_waitcnt lgkmcnt(6)
    v_mfma_f32_32x32x16_bf16 v[64:79], v[48:51], v[224:227], v[64:79]
    ds_read_b64_tr_b16 v[48:49], v4 offset:24576
    ds_read_b64_tr_b16 v[50:51], v4 offset:25600
    v_cvt_pk_bf16_f32 v8, v114, v114
    v_and_b32 v8, 0xffff0000, v8
    v_sub_f32 v9, v114, v8
    v_cvt_pk_bf16_f32 v8, v8, v9
    s_waitcnt lgkmcnt(6)
    v_mfma_f32_32x32x16_bf16 v[64:79], v[52:55], v[228:231], v[64:79]
    ds_read_b64_tr_b16 v[52:53], v5 offset:24576
    ds_read_b64_tr_b16 v[54:55], v5 offset:25600
    v_cndmask_b32 v102, 0, v8, s[6:7]
    s_waitcnt lgkmcnt(6)
    v_mfma_f32_32x32x16_bf16 v[64:79], v[56:59], v[232:235], v[64:79]
    ds_read_b64_tr_b16 v[56:57], v6 offset:24576
    ds_read_b64_tr_b16 v[58:59], v6 offset:25600
    s_waitcnt lgkmcnt(6)
    v_mfma_f32_32x32x16_bf16 v[64:79], v[60:63], v[236:239], v[64:79]
    ds_read_b64_tr_b16 v[60:61], v7 offset:24576
    ds_read_b64_tr_b16 v[62:63], v7 offset:25600
    s_waitcnt lgkmcnt(6)
    v_mfma_f32_32x32x16_bf16 v[64:79], v[48:51], v[240:243], v[64:79]
    s_waitcnt lgkmcnt(4)
    v_mfma_f32_32x32x16_bf16 v[64:79], v[52:55], v[244:247], v[64:79]
    s_waitcnt lgkmcnt(2)
    v_mfma_f32_32x32x16_bf16 v[64:79], v[56:59], v[248:251], v[64:79]
    s_waitcnt lgkmcnt(0)
    v_mfma_f32_32x32x16_bf16 v[64:79], v[60:63], v[252:255], v[64:79]
    s_waitcnt vmcnt(0)
    s_barrier
    s_branch L_f0
L_p1n0:
    s_waitcnt lgkmcnt(5)
    v_mfma_f32_32x32x16_bf16 v[16:31], v[128:131], v[48:51], 0
    ds_read_b128 v[136:139], v66 offset:8192
    ds_read_b64_tr_b16 v[8:9], v70 offset:24576
    ds_read_b64_tr_b16 v[10:11], v70 offset:25344
    v_mfma_f32_32x32x16_bf16 v[32:47], v[128:131], v[52:55], 0
    ds_read_b64_tr_b16 v[12:13], v70 offset:24640
    ds_read_b64_tr_b16 v[14:15], v70 offset:25408
    s_xor_b32 s51, s56, 3
    s_lshl_b32 s51, s51, 7
    s_add_u32 m0, s49, 106496
    s_add_u32 s51, s46, s51
    buffer_load_dwordx4 v72, s[8:11], s51 offen offset:0 lds
    buffer_load_dwordx4 v73, s[8:11], s51 offen offset:1024 lds
    s_waitcnt lgkmcnt(5)
    v_mfma_f32_32x32x16_bf16 v[16:31], v[132:135], v[56:59], v[16:31]
    ds_read_b128 v[140:143], v67 offset:8192
    ds_read_b64_tr_b16 v[48:49], v71 offset:24576
    ds_read_b64_tr_b16 v[50:51], v71 offset:25344
    v_mfma_f32_32x32x16_bf16 v[32:47], v[132:135], v[60:63], v[32:47]
    ds_read_b64_tr_b16 v[52:53], v71 offset:24640
    ds_read_b64_tr_b16 v[54:55], v71 offset:25408
    buffer_load_dwordx4 v74, s[8:11], s51 offen offset:2048 lds
    s_waitcnt vmcnt(7)
    s_barrier
    s_waitcnt lgkmcnt(5)
    v_mfma_f32_32x32x16_bf16 v[16:31], v[136:139], v[8:11], v[16:31]
    ds_read_b128 v[144:147], v64 offset:40960
    ds_read_b64_tr_b16 v[56:57], v68 offset:57344
    ds_read_b64_tr_b16 v[58:59], v68 offset:58112
    v_mfma_f32_32x32x16_bf16 v[32:47], v[136:139], v[12:15], v[32:47]
    ds_read_b64_tr_b16 v[60:61], v68 offset:57408
    ds_read_b64_tr_b16 v[62:63], v68 offset:58176
    buffer_load_dwordx4 v75, s[8:11], s51 offen offset:3072 lds
    s_waitcnt lgkmcnt(5)
    v_mfma_f32_32x32x16_bf16 v[16:31], v[140:143], v[48:51], v[16:31]
    ds_read_b128 v[148:151], v65 offset:40960
    ds_read_b64_tr_b16 v[8:9], v69 offset:57344
    ds_read_b64_tr_b16 v[10:11], v69 offset:58112
    v_mfma_f32_32x32x16_bf16 v[32:47], v[140:143], v[52:55], v[32:47]
    ds_read_b64_tr_b16 v[12:13], v69 offset:57408
    ds_read_b64_tr_b16 v[14:15], v69 offset:58176
    global_load_dword v117, v116, s[16:17]
    v_mfma_f32_16x16x32_bf16 v[88:91], v[96:99], v[48:51], 0
    v_mfma_f32_16x16x32_bf16 v[92:95], v[96:99], v[52:55], 0
    s_waitcnt lgkmcnt(5)
    v_mfma_f32_32x32x16_bf16 v[16:31], v[144:147], v[56:59], v[16:31]
    ds_read_b128 v[152:155], v66 offset:40960
    ds_read_b64_tr_b16 v[48:49], v70 offset:57344
    ds_read_b64_tr_b16 v[50:51], v70 offset:58112
    v_mfma_f32_32x32x16_bf16 v[32:47], v[144:147], v[60:63], v[32:47]
    ds_read_b64_tr_b16 v[52:53], v70 offset:57408
    ds_read_b64_tr_b16 v[54:55], v70 offset:58176
    global_load_ushort v108, v109, s[36:37]
    global_load_ushort v109, v109, s[36:37] offset:64
    s_waitcnt lgkmcnt(5)
    v_mfma_f32_32x32x16_bf16 v[16:31], v[148:151], v[8:11], v[16:31]
    ds_read_b128 v[156:159], v67 offset:40960
    ds_read_b64_tr_b16 v[56:57], v71 offset:57344
    ds_read_b64_tr_b16 v[58:59], v71 offset:58112
    v_mfma_f32_32x32x16_bf16 v[32:47], v[148:151], v[12:15], v[32:47]
    ds_read_b64_tr_b16 v[60:61], v71 offset:57408
    ds_read_b64_tr_b16 v[62:63], v71 offset:58176
    v_xor_b32 v64, 0x10000, v64
    v_xor_b32 v68, 0x10000, v68
    s_waitcnt vmcnt(7)
    s_barrier
    s_waitcnt lgkmcnt(5)
    v_mfma_f32_32x32x16_bf16 v[16:31], v[152:155], v[48:51], v[16:31]
    ds_read_b128 v[160:163], v64 offset:8192
    ds_read_b64_tr_b16 v[8:9], v68 offset:24576
    ds_read_b64_tr_b16 v[10:11], v68 offset:25344
    v_mfma_f32_32x32x16_bf16 v[32:47], v[152:155], v[52:55], v[32:47]
    ds_read_b64_tr_b16 v[12:13], v68 offset:24640
    ds_read_b64_tr_b16 v[14:15], v68 offset:25408
    s_xor_b32 s51, s56, 4
    s_lshl_b32 s51, s51, 7
    s_add_u32 m0, s49, 8192
    s_add_u32 s51, s46, s51
    buffer_load_dwordx4 v72, s[8:11], s51 offen offset:0 lds
    v_xor_b32 v65, 0x10000, v65
    v_xor_b32 v69, 0x10000, v69
    s_waitcnt lgkmcnt(5)
    v_mfma_f32_32x32x16_bf16 v[16:31], v[156:159], v[56:59], v[16:31]
    ds_read_b128 v[164:167], v65 offset:8192
    ds_read_b64_tr_b16 v[48:49], v69 offset:24576
    ds_read_b64_tr_b16 v[50:51], v69 offset:25344
    v_mfma_f32_32x32x16_bf16 v[32:47], v[156:159], v[60:63], v[32:47]
    ds_read_b64_tr_b16 v[52:53], v69 offset:24640
    ds_read_b64_tr_b16 v[54:55], v69 offset:25408
    buffer_load_dwordx4 v73, s[8:11], s51 offen offset:1024 lds
    v_mfma_f32_16x16x32_bf16 v[88:91], v[96:99], v[56:59], v[88:91]
    v_mfma_f32_16x16x32_bf16 v[92:95], v[96:99], v[60:63], v[92:95]
    v_xor_b32 v66, 0x10000, v66
    v_xor_b32 v70, 0x10000, v70
    s_waitcnt lgkmcnt(5)
    v_mfma_f32_32x32x16_bf16 v[16:31], v[160:163], v[8:11], v[16:31]
    ds_read_b128 v[168:171], v66 offset:8192
    ds_read_b64_tr_b16 v[56:57], v70 offset:24576
    ds_read_b64_tr_b16 v[58:59], v70 offset:25344
    v_mfma_f32_32x32x16_bf16 v[32:47], v[160:163], v[12:15], v[32:47]
    ds_read_b64_tr_b16 v[60:61], v70 offset:24640
    ds_read_b64_tr_b16 v[62:63], v70 offset:25408
    buffer_load_dwordx4 v74, s[8:11], s51 offen offset:2048 lds
    v_xor_b32 v67, 0x10000, v67
    v_xor_b32 v71, 0x10000, v71
    s_waitcnt lgkmcnt(5)
    v_mfma_f32_32x32x16_bf16 v[16:31], v[164:167], v[48:51], v[16:31]
    ds_read_b128 v[172:175], v67 offset:8192
    ds_read_b64_tr_b16 v[8:9], v71 offset:24576
    ds_read_b64_tr_b16 v[10:11], v71 offset:25344
    v_mfma_f32_32x32x16_bf16 v[32:47], v[164:167], v[52:55], v[32:47]
    ds_read_b64_tr_b16 v[12:13], v71 offset:24640
    ds_read_b64_tr_b16 v[14:15], v71 offset:25408
    buffer_load_dwordx4 v75, s[8:11], s51 offen offset:3072 lds
    s_waitcnt vmcnt(7)
    s_barrier
    s_waitcnt lgkmcnt(5)
    v_mfma_f32_32x32x16_bf16 v[16:31], v[168:171], v[56:59], v[16:31]
    ds_read_b128 v[176:179], v64 offset:40960
    ds_read_b64_tr_b16 v[48:49], v68 offset:57344
    ds_read_b64_tr_b16 v[50:51], v68 offset:58112
    v_mfma_f32_32x32x16_bf16 v[32:47], v[168:171], v[60:63], v[32:47]
    ds_read_b64_tr_b16 v[52:53], v68 offset:57408
    ds_read_b64_tr_b16 v[54:55], v68 offset:58176
    s_xor_b32 s51, s56, 5
    s_lshl_b32 s51, s51, 7
    s_add_u32 m0, s49, 40960
    s_add_u32 s51, s46, s51
    buffer_load_dwordx4 v72, s[8:11], s51 offen offset:0 lds
    s_waitcnt lgkmcnt(5)
    v_mfma_f32_32x32x16_bf16 v[16:31], v[172:175], v[8:11], v[16:31]
    ds_read_b128 v[180:183], v65 offset:40960
    ds_read_b64_tr_b16 v[56:57], v69 offset:57344
    ds_read_b64_tr_b16 v[58:59], v69 offset:58112
    v_mfma_f32_32x32x16_bf16 v[32:47], v[172:175], v[12:15], v[32:47]
    ds_read_b64_tr_b16 v[60:61], v69 offset:57408
    ds_read_b64_tr_b16 v[62:63], v69 offset:58176
    buffer_load_dwordx4 v73, s[8:11], s51 offen offset:1024 lds
    v_mfma_f32_16x16x32_bf16 v[88:91], v[96:99], v[8:11], v[88:91]
    v_mfma_f32_16x16x32_bf16 v[92:95], v[96:99], v[12:15], v[92:95]
    s_waitcnt lgkmcnt(5)
    v_mfma_f32_32x32x16_bf16 v[16:31], v[176:179], v[48:51], v[16:31]
    ds_read_b128 v[184:187], v66 offset:40960
    ds_read_b64_tr_b16 v[8:9], v70 offset:57344
    ds_read_b64_tr_b16 v[10:11], v70 offset:58112
    v_mfma_f32_32x32x16_bf16 v[32:47], v[176:179], v[52:55], v[32:47]
    ds_read_b64_tr_b16 v[12:13], v70 offset:57408
    ds_read_b64_tr_b16 v[14:15], v70 offset:58176
    buffer_load_dwordx4 v74, s[8:11], s51 offen offset:2048 lds
    s_waitcnt lgkmcnt(5)
    v_mfma_f32_32x32x16_bf16 v[16:31], v[180:183], v[56:59], v[16:31]
    ds_read_b128 v[188:191], v67 offset:40960
    ds_read_b64_tr_b16 v[48:49], v71 offset:57344
    ds_read_b64_tr_b16 v[50:51], v71 offset:58112
    v_mfma_f32_32x32x16_bf16 v[32:47], v[180:183], v[60:63], v[32:47]
    ds_read_b64_tr_b16 v[52:53], v71 offset:57408
    ds_read_b64_tr_b16 v[54:55], v71 offset:58176
    buffer_load_dwordx4 v75, s[8:11], s51 offen offset:3072 lds
    v_xor_b32 v64, 0x10000, v64
    v_xor_b32 v68, 0x10000, v68
    s_waitcnt vmcnt(4)
    s_cmp_eq_u32 s61, 0
    s_cbranch_scc1 Lz2
    v_mov_b32 v118, 1
    s_mov_b64 exec, 1
    global_store_dword v110, v118, s[40:41] sc1
    s_mov_b64 exec, -1
Lz2:
    s_barrier
    s_waitcnt lgkmcnt(5)
    v_mfma_f32_32x32x16_bf16 v[16:31], v[184:187], v[8:11], v[16:31]
    ds_read_b128 v[192:195], v64 offset:8192
    ds_read_b64_tr_b16 v[56:57], v68 offset:24576
    ds_read_b64_tr_b16 v[58:59], v68 offset:25344
    v_mfma_f32_32x32x16_bf16 v[32:47], v[184:187], v[12:15], v[32:47]
    ds_read_b64_tr_b16 v[60:61], v68 offset:24640
    ds_read_b64_tr_b16 v[62:63], v68 offset:25408
    s_xor_b32 s51, s56, 6
    s_lshl_b32 s51, s51, 7
    s_add_u32 m0, s49, 73728
    s_add_u32 s51, s46, s51
    buffer_load_dwordx4 v72, s[8:11], s51 offen offset:0 lds
    v_xor_b32 v65, 0x10000, v65
    v_xor_b32 v69, 0x10000, v69
    s_waitcnt lgkmcnt(5)
    v_mfma_f32_32x32x16_bf16 v[16:31], v[188:191], v[48:51], v[16:31]
    ds_read_b128 v[196:199], v65 offset:8192
    ds_read_b64_tr_b16 v[8:9], v69 offset:24576
    ds_read_b64_tr_b16 v[10:11], v69 offset:25344
    v_mfma_f32_32x32x16_bf16 v[32:47], v[188:191], v[52:55], v[32:47]
    ds_read_b64_tr_b16 v[12:13], v69 offset:24640
    ds_read_b64_tr_b16 v[14:15], v69 offset:25408
    buffer_load_dwordx4 v73, s[8:11], s51 offen offset:1024 lds
    v_mfma_f32_16x16x32_bf16 v[88:91], v[96:99], v[48:51], v[88:91]
    v_mfma_f32_16x16x32_bf16 v[92:95], v[96:99], v[52:55], v[92:95]
    v_xor_b32 v66, 0x10000, v66
    v_xor_b32 v70, 0x10000, v70
    s_waitcnt lgkmcnt(5)
    v_mfma_f32_32x32x16_bf16 v[16:31], v[192:195], v[56:59], v[16:31]
    ds_read_b128 v[200:203], v66 offset:8192
    ds_read_b64_tr_b16 v[48:49], v70 offset:24576
    ds_read_b64_tr_b16 v[50:51], v70 offset:25344
    v_mfma_f32_32x32x16_bf16 v[32:47], v[192:195], v[60:63], v[32:47]
    ds_read_b64_tr_b16 v[52:53], v70 offset:24640
    ds_read_b64_tr_b16 v[54:55], v70 offset:25408
    buffer_load_dwordx4 v74, s[8:11], s51 offen offset:2048 lds
    v_xor_b32 v67, 0x10000, v67
    v_xor_b32 v71, 0x10000, v71
    s_waitcnt lgkmcnt(5)
    v_mfma_f32_32x32x16_bf16 v[16:31], v[196:199], v[8:11], v[16:31]
    ds_read_b128 v[204:207], v67 offset:8192
    ds_read_b64_tr_b16 v[56:57], v71 offset:24576
    ds_read_b64_tr_b16 v[58:59], v71 offset:25344
    v_mfma_f32_32x32x16_bf16 v[32:47], v[196:199], v[12:15], v[32:47]
    ds_read_b64_tr_b16 v[60:61], v71 offset:24640
    ds_read_b64_tr_b16 v[62:63], v71 offset:25408
    buffer_load_dwordx4 v75, s[8:11], s51 offen offset:3072 lds
    s_waitcnt vmcnt(4)
    s_barrier
    s_waitcnt lgkmcnt(5)
    v_mfma_f32_32x32x16_bf16 v[16:31], v[200:203], v[48:51], v[16:31]
    ds_read_b128 v[208:211], v64 offset:40960
    ds_read_b64_tr_b16 v[8:9], v68 offset:57344
    ds_read_b64_tr_b16 v[10:11], v68 offset:58112
    v_mfma_f32_32x32x16_bf16 v[32:47], v[200:203], v[52:55], v[32:47]
    ds_read_b64_tr_b16 v[12:13], v68 offset:57408
    ds_read_b64_tr_b16 v[14:15], v68 offset:58176
    s_xor_b32 s51, s56, 7
    s_lshl_b32 s51, s51, 7
    s_add_u32 m0, s49, s54
    s_add_u32 s51, s46, s51
    buffer_load_dwordx4 v72, s[8:11], s51 offen offset:0 lds
    buffer_load_dwordx4 v73, s[8:11], s51 offen offset:1024 lds
    s_waitcnt lgkmcnt(5)
    v_mfma_f32_32x32x16_bf16 v[16:31], v[204:207], v[56:59], v[16:31]
    ds_read_b128 v[212:215], v65 offset:40960
    ds_read_b64_tr_b16 v[48:49], v69 offset:57344
    ds_read_b64_tr_b16 v[50:51], v69 offset:58112
    v_mfma_f32_32x32x16_bf16 v[32:47], v[204:207], v[60:63], v[32:47]
    ds_read_b64_tr_b16 v[52:53], v69 offset:57408
    ds_read_b64_tr_b16 v[54:55], v69 offset:58176
    buffer_load_dwordx4 v74, s[8:11], s51 offen offset:2048 lds
    buffer_load_dwordx4 v75, s[8:11], s51 offen offset:3072 lds
    v_mfma_f32_16x16x32_bf16 v[88:91], v[96:99], v[56:59], v[88:91]
    v_mfma_f32_16x16x32_bf16 v[92:95], v[96:99], v[60:63], v[92:95]
    s_waitcnt lgkmcnt(5)
    v_mfma_f32_32x32x16_bf16 v[16:31], v[208:211], v[8:11], v[16:31]
    ds_read_b128 v[216:219], v66 offset:40960
    ds_read_b64_tr_b16 v[56:57], v70 offset:57344
    ds_read_b64_tr_b16 v[58:59], v70 offset:58112
    v_mfma_f32_32x32x16_bf16 v[32:47], v[208:211], v[12:15], v[32:47]
    ds_read_b64_tr_b16 v[60:61], v70 offset:57408
    ds_read_b64_tr_b16 v[62:63], v70 offset:58176
    s_xor_b32 s51, s56, 0
    s_mul_i32 s51, s51, 229376
    s_add_u32 m0, s100, 106496
    s_add_u32 s51, s101, s51
    buffer_load_dwordx4 v76, s[16:19], s51 offen offset:0 lds
    s_waitcnt lgkmcnt(5)
    v_mfma_f32_32x32x16_bf16 v[16:31], v[212:215], v[48:51], v[16:31]
    ds_read_b128 v[220:223], v67 offset:40960
    ds_read_b64_tr_b16 v[8:9], v71 offset:57344
    ds_read_b64_tr_b16 v[10:11], v71 offset:58112
    v_mfma_f32_32x32x16_bf16 v[32:47], v[212:215], v[52:55], v[32:47]
    ds_read_b64_tr_b16 v[12:13], v71 offset:57408
    ds_read_b64_tr_b16 v[14:15], v71 offset:58176
    buffer_load_dwordx4 v77, s[16:19], s51 offen offset:1024 lds
    v_xor_b32 v64, 0x10000, v64
    v_xor_b32 v68, 0x10000, v68
    s_waitcnt vmcnt(6)
    s_barrier
    s_waitcnt lgkmcnt(5)
    v_mfma_f32_32x32x16_bf16 v[16:31], v[216:219], v[56:59], v[16:31]
    ds_read_b128 v[224:227], v64 offset:8192
    ds_read_b64_tr_b16 v[48:49], v68 offset:24576
    ds_read_b64_tr_b16 v[50:51], v68 offset:25344
    v_mfma_f32_32x32x16_bf16 v[32:47], v[216:219], v[60:63], v[32:47]
    ds_read_b64_tr_b16 v[52:53], v68 offset:24640
    ds_read_b64_tr_b16 v[54:55], v68 offset:25408
    buffer_load_dwordx4 v78, s[16:19], s51 offen offset:2048 lds
    buffer_load_dwordx4 v79, s[16:19], s51 offen offset:3072 lds
    v_xor_b32 v65, 0x10000, v65
    v_xor_b32 v69, 0x10000, v69
    s_waitcnt lgkmcnt(5)
    v_mfma_f32_32x32x16_bf16 v[16:31], v[220:223], v[8:11], v[16:31]
    ds_read_b128 v[228:231], v65 offset:8192
    ds_read_b64_tr_b16 v[56:57], v69 offset:24576
    ds_read_b64_tr_b16 v[58:59], v69 offset:25344
    v_mfma_f32_32x32x16_bf16 v[32:47], v[220:223], v[12:15], v[32:47]
    ds_read_b64_tr_b16 v[60:61], v69 offset:24640
    ds_read_b64_tr_b16 v[62:63], v69 offset:25408
    s_xor_b32 s51, s56, 2
    s_mul_i32 s51, s51, 229376
    s_add_u32 m0, s100, 8192
    s_add_u32 s51, s101, s51
    buffer_load_dwordx4 v76, s[16:19], s51 offen offset:0 lds
    v_mfma_f32_16x16x32_bf16 v[88:91], v[96:99], v[8:11], v[88:91]
    v_mfma_f32_16x16x32_bf16 v[92:95], v[96:99], v[12:15], v[92:95]
    v_xor_b32 v66, 0x10000, v66
    v_xor_b32 v70, 0x10000, v70
    s_waitcnt lgkmcnt(5)
    v_mfma_f32_32x32x16_bf16 v[16:31], v[224:227], v[48:51], v[16:31]
    ds_read_b128 v[232:235], v66 offset:8192
    ds_read_b64_tr_b16 v[8:9], v70 offset:24576
    ds_read_b64_tr_b16 v[10:11], v70 offset:25344
    v_mfma_f32_32x32x16_bf16 v[32:47], v[224:227], v[52:55], v[32:47]
    ds_read_b64_tr_b16 v[12:13], v70 offset:24640
    ds_read_b64_tr_b16 v[14:15], v70 offset:25408
    buffer_load_dwordx4 v77, s[16:19], s51 offen offset:1024 lds
    v_xor_b32 v67, 0x10000, v67
    v_xor_b32 v71, 0x10000, v71
    s_waitcnt lgkmcnt(5)
    v_mfma_f32_32x32x16_bf16 v[16:31], v[228:231], v[56:59], v[16:31]
    ds_read_b128 v[236:239], v67 offset:8192
    ds_read_b64_tr_b16 v[48:49], v71 offset:24576
    ds_read_b64_tr_b16 v[50:51], v71 offset:25344
    v_mfma_f32_32x32x16_bf16 v[32:47], v[228:231], v[60:63], v[32:47]
    ds_read_b64_tr_b16 v[52:53], v71 offset:24640
    ds_read_b64_tr_b16 v[54:55], v71 offset:25408
    buffer_load_dwordx4 v78, s[16:19], s51 offen offset:2048 lds
    v_add_u32 v64, s52, v64
    v_add_u32 v68, 81920, v68
    s_waitcnt vmcnt(7)
    s_barrier
    s_waitcnt lgkmcnt(5)
    v_mfma_f32_32x32x16_bf16 v[16:31], v[232:235], v[8:11], v[16:31]
    ds_read_b128 v[240:243], v64 offset:0
    ds_read_b64_tr_b16 v[56:57], v68 offset:0
    ds_read_b64_tr_b16 v[58:59], v68 offset:768
    v_mfma_f32_32x32x16_bf16 v[32:47], v[232:235], v[12:15], v[32:47]
    ds_read_b64_tr_b16 v[60:61], v68 offset:64
    ds_read_b64_tr_b16 v[62:63], v68 offset:832
    buffer_load_dwordx4 v79, s[16:19], s51 offen offset:3072 lds
    v_add_u32 v65, s52, v65
    v_add_u32 v69, 81920, v69
    s_waitcnt lgkmcnt(5)
    v_mfma_f32_32x32x16_bf16 v[16:31], v[236:239], v[48:51], v[16:31]
    ds_read_b128 v[244:247], v65 offset:0
    ds_read_b64_tr_b16 v[8:9], v69 offset:0
    ds_read_b64_tr_b16 v[10:11], v69 offset:768
    v_mfma_f32_32x32x16_bf16 v[32:47], v[236:239], v[52:55], v[32:47]
    ds_read_b64_tr_b16 v[12:13], v69 offset:64
    ds_read_b64_tr_b16 v[14:15], v69 offset:832
    s_xor_b32 s51, s56, 4
    s_mul_i32 s51, s51, 229376
    s_add_u32 m0, s100, 40960
    s_add_u32 s51, s101, s51
    buffer_load_dwordx4 v76, s[16:19], s51 offen offset:0 lds
    v_mfma_f32_16x16x32_bf16 v[88:91], v[96:99], v[48:51], v[88:91]
    v_mfma_f32_16x16x32_bf16 v[92:95], v[96:99], v[52:55], v[92:95]
    v_add_u32 v66, s52, v66
    v_add_u32 v70, 81920, v70
    s_waitcnt lgkmcnt(5)
    v_mfma_f32_32x32x16_bf16 v[16:31], v[240:243], v[56:59], v[16:31]
    ds_read_b128 v[248:251], v66 offset:0
    ds_read_b64_tr_b16 v[48:49], v70 offset:0
    ds_read_b64_tr_b16 v[50:51], v70 offset:768
    v_mfma_f32_32x32x16_bf16 v[32:47], v[240:243], v[60:63], v[32:47]
    ds_read_b64_tr_b16 v[52:53], v70 offset:64
    ds_read_b64_tr_b16 v[54:55], v70 offset:832
    buffer_load_dwordx4 v77, s[16:19], s51 offen offset:1024 lds
    v_add_u32 v67, s52, v67
    v_add_u32 v71, 81920, v71
    s_waitcnt lgkmcnt(5)
    v_mfma_f32_32x32x16_bf16 v[16:31], v[244:247], v[8:11], v[16:31]
    ds_read_b128 v[252:255], v67 offset:0
    ds_read_b64_tr_b16 v[56:57], v71 offset:0
    ds_read_b64_tr_b16 v[58:59], v71 offset:768
    v_mfma_f32_32x32x16_bf16 v[32:47], v[244:247], v[12:15], v[32:47]
    ds_read_b64_tr_b16 v[60:61], v71 offset:64
    ds_read_b64_tr_b16 v[62:63], v71 offset:832
    buffer_load_dwordx4 v78, s[16:19], s51 offen offset:2048 lds
    s_barrier
    s_waitcnt lgkmcnt(5)
    v_mfma_f32_32x32x16_bf16 v[16:31], v[248:251], v[48:51], v[16:31]
    v_mfma_f32_32x32x16_bf16 v[32:47], v[248:251], v[52:55], v[32:47]
    buffer_load_dwordx4 v79, s[16:19], s51 offen offset:3072 lds
    s_xor_b32 s51, s56, 6
    s_mul_i32 s51, s51, 229376
    s_add_u32 m0, s100, 73728
    s_add_u32 s51, s101, s51
    buffer_load_dwordx4 v76, s[16:19], s51 offen offset:0 lds
    s_waitcnt lgkmcnt(0)
    v_mfma_f32_32x32x16_bf16 v[16:31], v[252:255], v[56:59], v[16:31]
    v_mfma_f32_32x32x16_bf16 v[32:47], v[252:255], v[60:63], v[32:47]
    buffer_load_dwordx4 v77, s[16:19], s51 offen offset:1024 lds
    buffer_load_dwordx4 v78, s[16:19], s51 offen offset:2048 lds
    v_mfma_f32_16x16x32_bf16 v[88:91], v[96:99], v[56:59], v[88:91]
    v_mfma_f32_16x16x32_bf16 v[92:95], v[96:99], v[60:63], v[92:95]
    buffer_load_dwordx4 v79, s[16:19], s51 offen offset:3072 lds
    s_lshl_b32 s50, s44, 8
    s_add_u32 s51, s50, 159744
    v_lshl_add_u32 v116, v0, 3, s51
    v_lshlrev_b32 v117, 4, v0
    v_add_u32 v117, 160768, v117
    s_lshl_b32 s50, s44, 2
    v_add_u32 v118, s50, v117
    s_mul_i32 s52, s43, 3
    s_add_u32 s52, s52, 0
    s_lshl_b32 s55, s52, 17
    s_lshl_b32 s50, s42, 2
    s_add_u32 s50, s50, s44
    s_mul_i32 s54, s50, 114688
    s_lshl_b32 s50, s50, 10
    s_add_u32 s55, s55, s50
    ds_write_b32 v118, v88
    ds_write_b32 v118, v92 offset:512
    s_lshl_b32 s50, s48, 5
    s_add_u32 s54, s54, s50
    s_add_u32 s54, s54, 10485760
    s_waitcnt vmcnt(8) lgkmcnt(0)
    s_barrier
    ds_read_b64 v[8:9], v116
    ds_read_b128 v[88:91], v117
    ds_read_b128 v[92:95], v117 offset:512
    s_setprio 2
    ds_read_b64_tr_b16 v[48:49], v4 offset:40960
    ds_read_b64_tr_b16 v[50:51], v4 offset:41984
    ds_read_b64_tr_b16 v[52:53], v5 offset:40960
    ds_read_b64_tr_b16 v[54:55], v5 offset:41984
    ds_read_b64_tr_b16 v[56:57], v6 offset:40960
    ds_read_b64_tr_b16 v[58:59], v6 offset:41984
    ds_read_b64_tr_b16 v[60:61], v7 offset:40960
    ds_read_b64_tr_b16 v[62:63], v7 offset:41984
    s_waitcnt lgkmcnt(6)
    v_mfma_f32_32x32x16_bf16 v[64:79], v[48:51], v[128:131], 0
    ds_read_b64_tr_b16 v[48:49], v4 offset:57344
    ds_read_b64_tr_b16 v[50:51], v4 offset:58368
    v_mul_f32 v8, 0xbb000000, v8
    v_mul_f32 v9, 0x3b000000, v9
    v_add_f32 v88, v88, v89
    v_fma_f32 v9, -v8, v8, v9
    s_waitcnt lgkmcnt(6)
    v_mfma_f32_32x32x16_bf16 v[64:79], v[52:55], v[132:135], v[64:79]
    ds_read_b64_tr_b16 v[52:53], v5 offset:57344
    ds_read_b64_tr_b16 v[54:55], v5 offset:58368
    v_add_f32 v90, v90, v91
    v_max_f32 v82, 0, v9
    v_add_f32 v13, v88, v90
    v_add_f32 v9, 0x3727c5ac, v82
    s_waitcnt lgkmcnt(6)
    v_mfma_f32_32x32x16_bf16 v[64:79], v[56:59], v[136:139], v[64:79]
    ds_read_b64_tr_b16 v[56:57], v6 offset:57344
    ds_read_b64_tr_b16 v[58:59], v6 offset:58368
    v_rsq_f32 v111, v9
    v_cvt_pk_bf16_f32 v10, v8, v8
    v_and_b32 v10, 0xffff0000, v10
    v_sub_f32 v11, v8, v10
    s_waitcnt lgkmcnt(6)
    v_mfma_f32_32x32x16_bf16 v[64:79], v[60:63], v[140:143], v[64:79]
    ds_read_b64_tr_b16 v[60:61], v7 offset:57344
    ds_read_b64_tr_b16 v[62:63], v7 offset:58368
    v_cvt_pk_bf16_f32 v12, v10, v11
    v_add_f32 v92, v92, v93
    v_add_f32 v94, v94, v95
    v_add_f32 v14, v92, v94
    s_waitcnt lgkmcnt(6)
    v_mfma_f32_32x32x16_bf16 v[64:79], v[48:51], v[144:147], v[64:79]
    v_xor_b32 v4, 0x10000, v4
    ds_read_b64_tr_b16 v[48:49], v4 offset:8192
    ds_read_b64_tr_b16 v[50:51], v4 offset:9216
    s_lshl_b32 s50, s3, 7
    s_add_u32 s50, s50, 162304
    v_lshl_add_u32 v10, v0, 2, s50
    ds_write_b32 v10, v111
    v_lshrrev_b32 v11, 5, v1
    v_lshl_add_u32 v11, v11, 4, s50
    s_waitcnt lgkmcnt(7)
    v_mfma_f32_32x32x16_bf16 v[64:79], v[52:55], v[148:151], v[64:79]
    v_xor_b32 v5, 0x10000, v5
    ds_read_b64_tr_b16 v[52:53], v5 offset:8192
    ds_read_b64_tr_b16 v[54:55], v5 offset:9216
    ds_read_b128 v[88:91], v11 offset:0
    ds_read_b128 v[92:95], v11 offset:32
    ds_read_b128 v[116:119], v11 offset:64
    ds_read_b128 v[120:123], v11 offset:96
    s_waitcnt lgkmcnt(11)
    v_mfma_f32_32x32x16_bf16 v[64:79], v[56:59], v[152:155], v[64:79]
    v_xor_b32 v6, 0x10000, v6
    ds_read_b64_tr_b16 v[56:57], v6 offset:8192
    ds_read_b64_tr_b16 v[58:59], v6 offset:9216
    v_cndmask_b32 v100, 0, v12, s[6:7]
    v_cndmask_b32 v101, 0, v12, s[6:7]
    v_cvt_pk_bf16_f32 v104, v13, v13
    v_and_b32 v10, 0xffff0000, v104
    s_waitcnt lgkmcnt(11)
    v_mfma_f32_32x32x16_bf16 v[64:79], v[60:63], v[156:159], v[64:79]
    v_xor_b32 v7, 0x10000, v7
    ds_read_b64_tr_b16 v[60:61], v7 offset:8192
    ds_read_b64_tr_b16 v[62:63], v7 offset:9216
    v_sub_f32 v10, v13, v10
    v_cvt_pk_bf16_f32 v105, v10, v10
    s_nop 1
    v_mfma_f32_32x32x16_bf16 v[16:31], v[100:103], v[104:107], v[16:31]
    v_cvt_pk_bf16_f32 v104, v14, v14
    s_waitcnt lgkmcnt(11)
    v_mfma_f32_32x32x16_bf16 v[64:79], v[48:51], v[160:163], v[64:79]
    ds_read_b64_tr_b16 v[48:49], v4 offset:24576
    ds_read_b64_tr_b16 v[50:51], v4 offset:25600
    v_and_b32 v10, 0xffff0000, v104
    v_sub_f32 v10, v14, v10
    v_cvt_pk_bf16_f32 v105, v10, v10
    s_nop 1
    v_mfma_f32_32x32x16_bf16 v[32:47], v[100:103], v[104:107], v[32:47]
    s_waitcnt lgkmcnt(10)
    v_mfma_f32_32x32x16_bf16 v[64:79], v[52:55], v[164:167], v[64:79]
    ds_read_b64_tr_b16 v[52:53], v5 offset:24576
    ds_read_b64_tr_b16 v[54:55], v5 offset:25600
    s_waitcnt lgkmcnt(6)
    v_mfma_f32_32x32x16_bf16 v[64:79], v[56:59], v[168:171], v[64:79]
    ds_read_b64_tr_b16 v[56:57], v6 offset:24576
    ds_read_b64_tr_b16 v[58:59], v6 offset:25600
    s_waitcnt lgkmcnt(6)
    v_mfma_f32_32x32x16_bf16 v[64:79], v[60:63], v[172:175], v[64:79]
    ds_read_b64_tr_b16 v[60:61], v7 offset:24576
    ds_read_b64_tr_b16 v[62:63], v7 offset:25600
    s_waitcnt lgkmcnt(12)
    v_mul_f32 v16, v16, v88
    v_mul_f32 v17, v17, v89
    v_mul_f32 v18, v18, v90
    v_mul_f32 v19, v19, v91
    s_waitcnt lgkmcnt(6)
    v_mfma_f32_32x32x16_bf16 v[64:79], v[48:51], v[176:179], v[64:79]
    s_waitcnt vmcnt(0)
    s_barrier
    ds_read_b64_tr_b16 v[48:49], v4 offset:40960
    ds_read_b64_tr_b16 v[50:51], v4 offset:41984
    v_mul_f32 v20, v20, v92
    v_mul_f32 v21, v21, v93
    v_mul_f32 v22, v22, v94
    v_mul_f32 v23, v23, v95
    s_waitcnt lgkmcnt(6)
    v_mfma_f32_32x32x16_bf16 v[64:79], v[52:55], v[180:183], v[64:79]
    ds_read_b64_tr_b16 v[52:53], v5 offset:40960
    ds_read_b64_tr_b16 v[54:55], v5 offset:41984
    v_mul_f32 v24, v24, v116
    v_mul_f32 v25, v25, v117
    v_mul_f32 v26, v26, v118
    v_mul_f32 v27, v27, v119
    s_waitcnt lgkmcnt(6)
    v_mfma_f32_32x32x16_bf16 v[64:79], v[56:59], v[184:187], v[64:79]
    ds_read_b64_tr_b16 v[56:57], v6 offset:40960
    ds_read_b64_tr_b16 v[58:59], v6 offset:41984
    v_mul_f32 v28, v28, v120
    v_mul_f32 v29, v29, v121
    v_mul_f32 v30, v30, v122
    v_mul_f32 v31, v31, v123
    s_waitcnt lgkmcnt(6)
    v_mfma_f32_32x32x16_bf16 v[64:79], v[60:63], v[188:191], v[64:79]
    ds_read_b64_tr_b16 v[60:61], v7 offset:40960
    ds_read_b64_tr_b16 v[62:63], v7 offset:41984
    v_cvt_pk_bf16_f32 v16, v16, v17
    v_cvt_pk_bf16_f32 v17, v18, v19
    v_cvt_pk_bf16_f32 v18, v20, v21
    v_cvt_pk_bf16_f32 v19, v22, v23
    s_waitcnt lgkmcnt(6)
    v_mfma_f32_32x32x16_bf16 v[64:79], v[48:51], v[192:195], v[64:79]
    ds_read_b64_tr_b16 v[48:49], v4 offset:57344
    ds_read_b64_tr_b16 v[50:51], v4 offset:58368
    v_cvt_pk_bf16_f32 v20, v24, v25
    v_cvt_pk_bf16_f32 v21, v26, v27
    v_cvt_pk_bf16_f32 v22, v28, v29
    v_cvt_pk_bf16_f32 v23, v30, v31
    s_waitcnt lgkmcnt(6)
    v_mfma_f32_32x32x16_bf16 v[64:79], v[52:55], v[196:199], v[64:79]
    ds_read_b64_tr_b16 v[52:53], v5 offset:57344
    ds_read_b64_tr_b16 v[54:55], v5 offset:58368
    s_add_u32 s50, s55, 0
    buffer_store_dwordx4 v[16:19], v85, s[20:23], s50 offen sc1
    s_add_u32 s50, s55, 512
    buffer_store_dwordx4 v[20:23], v85, s[20:23], s50 offen sc1
    v_mul_f32 v32, v32, v88
    v_mul_f32 v33, v33, v89
    s_waitcnt lgkmcnt(6)
    v_mfma_f32_32x32x16_bf16 v[64:79], v[56:59], v[200:203], v[64:79]
    ds_read_b64_tr_b16 v[56:57], v6 offset:57344
    ds_read_b64_tr_b16 v[58:59], v6 offset:58368
    v_mul_f32 v34, v34, v90
    v_mul_f32 v35, v35, v91
    v_mul_f32 v36, v36, v92
    v_mul_f32 v37, v37, v93
    s_waitcnt lgkmcnt(6)
    v_mfma_f32_32x32x16_bf16 v[64:79], v[60:63], v[204:207], v[64:79]
    ds_read_b64_tr_b16 v[60:61], v7 offset:57344
    ds_read_b64_tr_b16 v[62:63], v7 offset:58368
    v_mul_f32 v38, v38, v94
    v_mul_f32 v39, v39, v95
    v_mul_f32 v40, v40, v116
    v_mul_f32 v41, v41, v117
    s_waitcnt lgkmcnt(6)
    v_mfma_f32_32x32x16_bf16 v[64:79], v[48:51], v[208:211], v[64:79]
    v_xor_b32 v4, 0x10000, v4
    ds_read_b64_tr_b16 v[48:49], v4 offset:8192
    ds_read_b64_tr_b16 v[50:51], v4 offset:9216
    v_mul_f32 v42, v42, v118
    v_mul_f32 v43, v43, v119
    v_mul_f32 v44, v44, v120
    v_mul_f32 v45, v45, v121
    s_waitcnt lgkmcnt(6)
    v_mfma_f32_32x32x16_bf16 v[64:79], v[52:55], v[212:215], v[64:79]
    v_xor_b32 v5, 0x10000, v5
    ds_read_b64_tr_b16 v[52:53], v5 offset:8192
    ds_read_b64_tr_b16 v[54:55], v5 offset:9216
    v_mul_f32 v46, v46, v122
    v_mul_f32 v47, v47, v123
    v_cvt_pk_bf16_f32 v32, v32, v33
    v_cvt_pk_bf16_f32 v33, v34, v35
    s_waitcnt lgkmcnt(6)
    v_mfma_f32_32x32x16_bf16 v[64:79], v[56:59], v[216:219], v[64:79]
    v_xor_b32 v6, 0x10000, v6
    ds_read_b64_tr_b16 v[56:57], v6 offset:8192
    ds_read_b64_tr_b16 v[58:59], v6 offset:9216
    v_cvt_pk_bf16_f32 v34, v36, v37
    v_cvt_pk_bf16_f32 v35, v38, v39
    v_cvt_pk_bf16_f32 v36, v40, v41
    v_cvt_pk_bf16_f32 v37, v42, v43
    s_waitcnt lgkmcnt(6)
    v_mfma_f32_32x32x16_bf16 v[64:79], v[60:63], v[220:223], v[64:79]
    v_xor_b32 v7, 0x10000, v7
    ds_read_b64_tr_b16 v[60:61], v7 offset:8192
    ds_read_b64_tr_b16 v[62:63], v7 offset:9216
    v_cvt_pk_bf16_f32 v38, v44, v45
    v_cvt_pk_bf16_f32 v39, v46, v47
    s_add_u32 s50, s55, 131072
    buffer_store_dwordx4 v[32:35], v85, s[20:23], s50 offen sc1
    s_add_u32 s50, s55, 131584
    buffer_store_dwordx4 v[36:39], v85, s[20:23], s50 offen sc1
    s_waitcnt lgkmcnt(6)
    v_mfma_f32_32x32x16_bf16 v[64:79], v[48:51], v[224:227], v[64:79]
    ds_read_b64_tr_b16 v[48:49], v4 offset:24576
    ds_read_b64_tr_b16 v[50:51], v4 offset:25600
    v_add_f32 v8, 0x3727c5ac, v82
    v_fmamk_f32 v8, v8, 0x3727c5ac, v82
    v_rsq_f32 v9, v8
    s_nop 0
    v_mul_f32 v114, v8, v9
    s_waitcnt lgkmcnt(6)
    v_mfma_f32_32x32x16_bf16 v[64:79], v[52:55], v[228:231], v[64:79]
    ds_read_b64_tr_b16 v[52:53], v5 offset:24576
    ds_read_b64_tr_b16 v[54:55], v5 offset:25600
    v_mul_f32 v112, 0xc0135761, v9
    v_mul_f32 v9, v9, v9
    v_mul_f32 v9, 0x3d372713, v9
    v_mul_f32 v113, v112, v9
    s_waitcnt lgkmcnt(6)
    v_mfma_f32_32x32x16_bf16 v[64:79], v[56:59], v[232:235], v[64:79]
    ds_read_b64_tr_b16 v[56:57], v6 offset:24576
    ds_read_b64_tr_b16 v[58:59], v6 offset:25600
    v_cvt_pk_bf16_f32 v8, v114, v114
    v_and_b32 v8, 0xffff0000, v8
    v_sub_f32 v9, v114, v8
    v_cvt_pk_bf16_f32 v8, v8, v9
    s_waitcnt lgkmcnt(6)
    v_mfma_f32_32x32x16_bf16 v[64:79], v[60:63], v[236:239], v[64:79]
    ds_read_b64_tr_b16 v[60:61], v7 offset:24576
    ds_read_b64_tr_b16 v[62:63], v7 offset:25600
    v_cndmask_b32 v102, 0, v8, s[6:7]
    s_waitcnt lgkmcnt(6)
    v_mfma_f32_32x32x16_bf16 v[64:79], v[48:51], v[240:243], v[64:79]
    s_waitcnt lgkmcnt(4)
    v_mfma_f32_32x32x16_bf16 v[64:79], v[52:55], v[244:247], v[64:79]
    s_waitcnt lgkmcnt(2)
    v_mfma_f32_32x32x16_bf16 v[64:79], v[56:59], v[248:251], v[64:79]
    s_waitcnt lgkmcnt(0)
    v_mfma_f32_32x32x16_bf16 v[64:79], v[60:63], v[252:255], v[64:79]
    s_waitcnt vmcnt(0)
    s_barrier
L_f0:
    s_setprio 3
    v_lshlrev_b32 v11, 2, v0
    v_add_u32 v11, 163328, v11
    ds_read_b32 v10, v11 offset:0
    s_mov_b32 s62, 0
    s_lshl_b32 s63, s57, 16
    s_lshl_b32 s59, s44, 10
    s_add_u32 s63, s63, s59
    s_cmp_eq_u32 s53, 0
    s_cbranch_scc1 L_a0
    s_waitcnt lgkmcnt(0)
    v_cvt_pk_bf16_f32 v104, v10, v10
    v_lshl_or_b32 v106, v108, 16, v108
    v_and_b32 v8, 0xffff0000, v104
    v_sub_f32 v8, v10, v8
    v_cvt_pk_bf16_f32 v105, v8, v8
    s_nop 1
    v_mfma_f32_32x32x16_bf16 v[64:79], v[104:107], v[100:103], v[64:79]
    s_setprio 1
    v_xor_b32 v4, 64, v4
    v_xor_b32 v5, 64, v5
    v_xor_b32 v6, 64, v6
    v_xor_b32 v7, 64, v7
    s_nop 6
    v_mul_f32 v32, v64, v64
    v_mul_f32 v33, v65, v65
    v_mul_f32 v34, v66, v66
    v_mul_f32 v35, v67, v67
    v_mul_f32 v36, v68, v68
    v_mul_f32 v37, v69, v69
    v_mul_f32 v38, v70, v70
    v_mul_f32 v39, v71, v71
    v_mul_f32 v40, v72, v72
    v_mul_f32 v41, v73, v73
    v_mul_f32 v42, v74, v74
    v_mul_f32 v43, v75, v75
    v_mul_f32 v44, v76, v76
    v_mul_f32 v45, v77, v77
    v_mul_f32 v46, v78, v78
    v_mul_f32 v47, v79, v79
    v_fma_f32 v32, v32, v113, v112
    v_fma_f32 v33, v33, v113, v112
    v_fma_f32 v34, v34, v113, v112
    v_fma_f32 v35, v35, v113, v112
    v_fma_f32 v36, v36, v113, v112
    v_fma_f32 v37, v37, v113, v112
    v_fma_f32 v38, v38, v113, v112
    v_fma_f32 v39, v39, v113, v112
    v_fma_f32 v40, v40, v113, v112
    v_fma_f32 v41, v41, v113, v112
    v_fma_f32 v42, v42, v113, v112
    v_fma_f32 v43, v43, v113, v112
    v_fma_f32 v44, v44, v113, v112
    v_fma_f32 v45, v45, v113, v112
    v_fma_f32 v46, v46, v113, v112
    v_fma_f32 v47, v47, v113, v112
    v_mul_f32 v32, v32, v64
    v_mul_f32 v33, v33, v65
    v_mul_f32 v34, v34, v66
    v_mul_f32 v35, v35, v67
    v_mul_f32 v36, v36, v68
    v_mul_f32 v37, v37, v69
    v_mul_f32 v38, v38, v70
    v_mul_f32 v39, v39, v71
    v_mul_f32 v40, v40, v72
    v_mul_f32 v41, v41, v73
    v_mul_f32 v42, v42, v74
    v_mul_f32 v43, v43, v75
    v_mul_f32 v44, v44, v76
    v_mul_f32 v45, v45, v77
    v_mul_f32 v46, v46, v78
    v_mul_f32 v47, v47, v79
    v_exp_f32 v32, v32
    v_exp_f32 v33, v33
    v_exp_f32 v34, v34
    v_exp_f32 v35, v35
    v_exp_f32 v36, v36
    v_exp_f32 v37, v37
    v_exp_f32 v38, v38
    v_exp_f32 v39, v39
    v_exp_f32 v40, v40
    v_exp_f32 v41, v41
    v_exp_f32 v42, v42
    v_exp_f32 v43, v43
    v_exp_f32 v44, v44
    v_exp_f32 v45, v45
    v_exp_f32 v46, v46
    v_exp_f32 v47, v47
    v_fma_f32 v32, v32, v114, v114
    v_fma_f32 v33, v33, v114, v114
    v_fma_f32 v34, v34, v114, v114
    v_fma_f32 v35, v35, v114, v114
    v_fma_f32 v36, v36, v114, v114
    v_fma_f32 v37, v37, v114, v114
    v_fma_f32 v38, v38, v114, v114
    v_fma_f32 v39, v39, v114, v114
    v_fma_f32 v40, v40, v114, v114
    v_fma_f32 v41, v41, v114, v114
    v_fma_f32 v42, v42, v114, v114
    v_fma_f32 v43, v43, v114, v114
    v_fma_f32 v44, v44, v114, v114
    v_fma_f32 v45, v45, v114, v114
    v_fma_f32 v46, v46, v114, v114
    v_fma_f32 v47, v47, v114, v114
    v_rcp_f32 v32, v32
    v_rcp_f32 v33, v33
    v_rcp_f32 v34, v34
    v_rcp_f32 v35, v35
    v_rcp_f32 v36, v36
    v_rcp_f32 v37, v37
    v_rcp_f32 v38, v38
    v_rcp_f32 v39, v39
    v_rcp_f32 v40, v40
    v_rcp_f32 v41, v41
    v_rcp_f32 v42, v42
    v_rcp_f32 v43, v43
    v_rcp_f32 v44, v44
    v_rcp_f32 v45, v45
    v_rcp_f32 v46, v46
    v_rcp_f32 v47, v47
    v_mul_f32 v32, v32, v64
    v_mul_f32 v33, v33, v65
    v_mul_f32 v34, v34, v66
    v_mul_f32 v35, v35, v67
    v_mul_f32 v36, v36, v68
    v_mul_f32 v37, v37, v69
    v_mul_f32 v38, v38, v70
    v_mul_f32 v39, v39, v71
    v_mul_f32 v40, v40, v72
    v_mul_f32 v41, v41, v73
    v_mul_f32 v42, v42, v74
    v_mul_f32 v43, v43, v75
    v_mul_f32 v44, v44, v76
    v_mul_f32 v45, v45, v77
    v_mul_f32 v46, v46, v78
    v_mul_f32 v47, v47, v79
    v_cvt_pk_bf16_f32 v116, v32, v33
    v_cvt_pk_bf16_f32 v117, v34, v35
    v_cvt_pk_bf16_f32 v118, v36, v37
    v_cvt_pk_bf16_f32 v119, v38, v39
    v_cvt_pk_bf16_f32 v120, v40, v41
    v_cvt_pk_bf16_f32 v121, v42, v43
    v_cvt_pk_bf16_f32 v122, v44, v45
    v_cvt_pk_bf16_f32 v123, v46, v47
    buffer_store_dwordx4 v[116:119], v2, s[20:23], s54 offen offset:0 sc1
    buffer_store_dwordx4 v[120:123], v2, s[20:23], s54 offen offset:1024 sc1
    s_setprio 2
    ds_read_b64_tr_b16 v[48:49], v4 offset:40960
    ds_read_b64_tr_b16 v[50:51], v4 offset:41984
    ds_read_b64_tr_b16 v[52:53], v5 offset:40960
    ds_read_b64_tr_b16 v[54:55], v5 offset:41984
    ds_read_b64_tr_b16 v[56:57], v6 offset:40960
    ds_read_b64_tr_b16 v[58:59], v6 offset:41984
    ds_read_b64_tr_b16 v[60:61], v7 offset:40960
    ds_read_b64_tr_b16 v[62:63], v7 offset:41984
    s_waitcnt lgkmcnt(6)
    v_mfma_f32_32x32x16_bf16 v[16:31], v[48:51], v[128:131], 0
    ds_read_b64_tr_b16 v[48:49], v4 offset:57344
    ds_read_b64_tr_b16 v[50:51], v4 offset:58368
    s_waitcnt lgkmcnt(6)
    v_mfma_f32_32x32x16_bf16 v[16:31], v[52:55], v[132:135], v[16:31]
    ds_read_b64_tr_b16 v[52:53], v5 offset:57344
    ds_read_b64_tr_b16 v[54:55], v5 offset:58368
    s_waitcnt lgkmcnt(6)
    v_mfma_f32_32x32x16_bf16 v[16:31], v[56:59], v[136:139], v[16:31]
    ds_read_b64_tr_b16 v[56:57], v6 offset:57344
    ds_read_b64_tr_b16 v[58:59], v6 offset:58368
    s_waitcnt lgkmcnt(6)
    v_mfma_f32_32x32x16_bf16 v[16:31], v[60:63], v[140:143], v[16:31]
    ds_read_b64_tr_b16 v[60:61], v7 offset:57344
    ds_read_b64_tr_b16 v[62:63], v7 offset:58368
    s_waitcnt lgkmcnt(6)
    v_mfma_f32_32x32x16_bf16 v[16:31], v[48:51], v[144:147], v[16:31]
    v_xor_b32 v4, 0x10000, v4
    ds_read_b64_tr_b16 v[48:49], v4 offset:8192
    ds_read_b64_tr_b16 v[50:51], v4 offset:9216
    s_waitcnt lgkmcnt(6)
    v_mfma_f32_32x32x16_bf16 v[16:31], v[52:55], v[148:151], v[16:31]
    v_xor_b32 v5, 0x10000, v5
    ds_read_b64_tr_b16 v[52:53], v5 offset:8192
    ds_read_b64_tr_b16 v[54:55], v5 offset:9216
    v_mov_b32 v64, 0
    v_mov_b32 v65, 0
    s_waitcnt lgkmcnt(6)
    v_mfma_f32_32x32x16_bf16 v[16:31], v[56:59], v[152:155], v[16:31]
    v_xor_b32 v6, 0x10000, v6
    ds_read_b64_tr_b16 v[56:57], v6 offset:8192
    ds_read_b64_tr_b16 v[58:59], v6 offset:9216
    v_mov_b32 v66, 0
    v_mov_b32 v67, 0
    s_waitcnt lgkmcnt(6)
    v_mfma_f32_32x32x16_bf16 v[16:31], v[60:63], v[156:159], v[16:31]
    v_xor_b32 v7, 0x10000, v7
    ds_read_b64_tr_b16 v[60:61], v7 offset:8192
    ds_read_b64_tr_b16 v[62:63], v7 offset:9216
    v_mov_b32 v68, 0
    v_mov_b32 v69, 0
    s_waitcnt lgkmcnt(6)
    v_mfma_f32_32x32x16_bf16 v[16:31], v[48:51], v[160:163], v[16:31]
    ds_read_b64_tr_b16 v[48:49], v4 offset:24576
    ds_read_b64_tr_b16 v[50:51], v4 offset:25600
    v_mov_b32 v70, 0
    v_mov_b32 v71, 0
    s_waitcnt lgkmcnt(6)
    v_mfma_f32_32x32x16_bf16 v[16:31], v[52:55], v[164:167], v[16:31]
    ds_read_b64_tr_b16 v[52:53], v5 offset:24576
    ds_read_b64_tr_b16 v[54:55], v5 offset:25600
    v_mov_b32 v72, 0
    v_mov_b32 v73, 0
    s_waitcnt lgkmcnt(6)
    v_mfma_f32_32x32x16_bf16 v[16:31], v[56:59], v[168:171], v[16:31]
    ds_read_b64_tr_b16 v[56:57], v6 offset:24576
    ds_read_b64_tr_b16 v[58:59], v6 offset:25600
    v_mov_b32 v74, 0
    v_mov_b32 v75, 0
    s_waitcnt lgkmcnt(6)
    v_mfma_f32_32x32x16_bf16 v[16:31], v[60:63], v[172:175], v[16:31]
    ds_read_b64_tr_b16 v[60:61], v7 offset:24576
    ds_read_b64_tr_b16 v[62:63], v7 offset:25600
    v_mov_b32 v76, 0
    v_mov_b32 v77, 0
    s_waitcnt lgkmcnt(6)
    v_mfma_f32_32x32x16_bf16 v[16:31], v[48:51], v[176:179], v[16:31]
    ds_read_b64_tr_b16 v[48:49], v4 offset:40960
    ds_read_b64_tr_b16 v[50:51], v4 offset:41984
    v_mov_b32 v78, 0
    v_mov_b32 v79, 0
    s_waitcnt lgkmcnt(6)
    v_mfma_f32_32x32x16_bf16 v[16:31], v[52:55], v[180:183], v[16:31]
    ds_read_b64_tr_b16 v[52:53], v5 offset:40960
    ds_read_b64_tr_b16 v[54:55], v5 offset:41984
    v_mov_b32 v128, 0
    v_mov_b32 v129, 0
    s_waitcnt lgkmcnt(6)
    v_mfma_f32_32x32x16_bf16 v[16:31], v[56:59], v[184:187], v[16:31]
    ds_read_b64_tr_b16 v[56:57], v6 offset:40960
    ds_read_b64_tr_b16 v[58:59], v6 offset:41984
    v_mov_b32 v130, 0
    v_mov_b32 v131, 0
    s_waitcnt lgkmcnt(6)
    v_mfma_f32_32x32x16_bf16 v[16:31], v[60:63], v[188:191], v[16:31]
    ds_read_b64_tr_b16 v[60:61], v7 offset:40960
    ds_read_b64_tr_b16 v[62:63], v7 offset:41984
    v_mov_b32 v132, 0
    v_mov_b32 v133, 0
    s_waitcnt lgkmcnt(6)
    v_mfma_f32_32x32x16_bf16 v[16:31], v[48:51], v[192:195], v[16:31]
    ds_read_b64_tr_b16 v[48:49], v4 offset:57344
    ds_read_b64_tr_b16 v[50:51], v4 offset:58368
    v_mov_b32 v134, 0
    v_mov_b32 v135, 0
    s_waitcnt lgkmcnt(6)
    v_mfma_f32_32x32x16_bf16 v[16:31], v[52:55], v[196:199], v[16:31]
    ds_read_b64_tr_b16 v[52:53], v5 offset:57344
    ds_read_b64_tr_b16 v[54:55], v5 offset:58368
    v_mov_b32 v136, 0
    v_mov_b32 v137, 0
    s_waitcnt lgkmcnt(6)
    v_mfma_f32_32x32x16_bf16 v[16:31], v[56:59], v[200:203], v[16:31]
    ds_read_b64_tr_b16 v[56:57], v6 offset:57344
    ds_read_b64_tr_b16 v[58:59], v6 offset:58368
    v_mov_b32 v138, 0
    v_mov_b32 v139, 0
    s_waitcnt lgkmcnt(6)
    v_mfma_f32_32x32x16_bf16 v[16:31], v[60:63], v[204:207], v[16:31]
    ds_read_b64_tr_b16 v[60:61], v7 offset:57344
    ds_read_b64_tr_b16 v[62:63], v7 offset:58368
    v_mov_b32 v140, 0
    v_mov_b32 v141, 0
    s_waitcnt lgkmcnt(6)
    v_mfma_f32_32x32x16_bf16 v[16:31], v[48:51], v[208:211], v[16:31]
    v_xor_b32 v4, 0x10000, v4
    ds_read_b64_tr_b16 v[48:49], v4 offset:8192
    ds_read_b64_tr_b16 v[50:51], v4 offset:9216
    v_mov_b32 v142, 0
    v_mov_b32 v143, 0
    s_waitcnt lgkmcnt(6)
    v_mfma_f32_32x32x16_bf16 v[16:31], v[52:55], v[212:215], v[16:31]
    ds_read_b32 v10, v11 offset:128
    v_xor_b32 v5, 0x10000, v5
    ds_read_b64_tr_b16 v[52:53], v5 offset:8192
    ds_read_b64_tr_b16 v[54:55], v5 offset:9216
    buffer_load_dword v3, v83, s[20:23], 0 offen sc1
    s_waitcnt lgkmcnt(7)
    v_mfma_f32_32x32x16_bf16 v[16:31], v[56:59], v[216:219], v[16:31]
    v_xor_b32 v6, 0x10000, v6
    ds_read_b64_tr_b16 v[56:57], v6 offset:8192
    ds_read_b64_tr_b16 v[58:59], v6 offset:9216
    s_waitcnt lgkmcnt(7)
    v_mfma_f32_32x32x16_bf16 v[16:31], v[60:63], v[220:223], v[16:31]
    v_xor_b32 v7, 0x10000, v7
    ds_read_b64_tr_b16 v[60:61], v7 offset:8192
    ds_read_b64_tr_b16 v[62:63], v7 offset:9216
    s_waitcnt lgkmcnt(7)
    v_mfma_f32_32x32x16_bf16 v[16:31], v[48:51], v[224:227], v[16:31]
    ds_read_b64_tr_b16 v[48:49], v4 offset:24576
    ds_read_b64_tr_b16 v[50:51], v4 offset:25600
    s_waitcnt lgkmcnt(6)
    v_mfma_f32_32x32x16_bf16 v[16:31], v[52:55], v[228:231], v[16:31]
    ds_read_b64_tr_b16 v[52:53], v5 offset:24576
    ds_read_b64_tr_b16 v[54:55], v5 offset:25600
    s_waitcnt lgkmcnt(6)
    v_mfma_f32_32x32x16_bf16 v[16:31], v[56:59], v[232:235], v[16:31]
    ds_read_b64_tr_b16 v[56:57], v6 offset:24576
    ds_read_b64_tr_b16 v[58:59], v6 offset:25600
    s_waitcnt lgkmcnt(6)
    v_mfma_f32_32x32x16_bf16 v[16:31], v[60:63], v[236:239], v[16:31]
    ds_read_b64_tr_b16 v[60:61], v7 offset:24576
    ds_read_b64_tr_b16 v[62:63], v7 offset:25600
    v_cvt_pk_bf16_f32 v104, v10, v10
    v_lshl_or_b32 v106, v109, 16, v109
    s_waitcnt lgkmcnt(6)
    v_mfma_f32_32x32x16_bf16 v[16:31], v[48:51], v[240:243], v[16:31]
    v_and_b32 v8, 0xffff0000, v104
    v_sub_f32 v8, v10, v8
    s_waitcnt lgkmcnt(4)
    v_mfma_f32_32x32x16_bf16 v[16:31], v[52:55], v[244:247], v[16:31]
    v_cvt_pk_bf16_f32 v105, v8, v8
    s_waitcnt lgkmcnt(2)
    v_mfma_f32_32x32x16_bf16 v[16:31], v[56:59], v[248:251], v[16:31]
    s_waitcnt lgkmcnt(0)
    v_mfma_f32_32x32x16_bf16 v[16:31], v[60:63], v[252:255], v[16:31]
    v_mfma_f32_32x32x16_bf16 v[16:31], v[104:107], v[100:103], v[16:31]
    s_waitcnt vmcnt(0)
    v_cmp_ne_u32 vcc, 16, v3
    s_cbranch_vccnz L_nkv
    s_mov_b32 s62, 1
    s_add_u32 m0, s59, 0
    s_add_u32 s50, s63, 2097152
    buffer_load_dwordx4 v2, s[20:23], s50 offen sc1 lds
    s_sub_u32 m0, 146432, s59
    s_add_u32 s50, s63, 4194304
    buffer_load_dwordx4 v2, s[20:23], s50 offen sc1 lds
    s_lshl_b32 s50, s58, 13
    s_add_u32 s50, s50, s63
    s_add_u32 s50, s50, s59
    s_lshl_b32 s51, s59, 1
    s_add_u32 m0, s51, 147456
    s_nop 0
    buffer_load_dwordx4 v2, s[20:23], s50 offen sc1 lds
    buffer_load_dwordx4 v2, s[20:23], s50 offen offset:1024 sc1 lds
    s_add_u32 m0, s59, 4096
    s_add_u32 s50, s63, 2101248
    buffer_load_dwordx4 v2, s[20:23], s50 offen sc1 lds
    s_sub_u32 m0, 142336, s59
    s_add_u32 s50, s63, 4198400
    buffer_load_dwordx4 v2, s[20:23], s50 offen sc1 lds
L_nkv:
    s_setprio 1
    s_nop 7
    v_mul_f32 v32, v16, v16
    v_mul_f32 v33, v17, v17
    v_mul_f32 v34, v18, v18
    v_mul_f32 v35, v19, v19
    v_mul_f32 v36, v20, v20
    v_mul_f32 v37, v21, v21
    v_mul_f32 v38, v22, v22
    v_mul_f32 v39, v23, v23
    v_mul_f32 v40, v24, v24
    v_mul_f32 v41, v25, v25
    v_mul_f32 v42, v26, v26
    v_mul_f32 v43, v27, v27
    v_mul_f32 v44, v28, v28
    v_mul_f32 v45, v29, v29
    v_mul_f32 v46, v30, v30
    v_mul_f32 v47, v31, v31
    v_fma_f32 v32, v32, v113, v112
    v_fma_f32 v33, v33, v113, v112
    v_fma_f32 v34, v34, v113, v112
    v_fma_f32 v35, v35, v113, v112
    v_fma_f32 v36, v36, v113, v112
    v_fma_f32 v37, v37, v113, v112
    v_fma_f32 v38, v38, v113, v112
    v_fma_f32 v39, v39, v113, v112
    v_fma_f32 v40, v40, v113, v112
    v_fma_f32 v41, v41, v113, v112
    v_fma_f32 v42, v42, v113, v112
    v_fma_f32 v43, v43, v113, v112
    v_fma_f32 v44, v44, v113, v112
    v_fma_f32 v45, v45, v113, v112
    v_fma_f32 v46, v46, v113, v112
    v_fma_f32 v47, v47, v113, v112
    v_mul_f32 v32, v32, v16
    v_mul_f32 v33, v33, v17
    v_mul_f32 v34, v34, v18
    v_mul_f32 v35, v35, v19
    v_mul_f32 v36, v36, v20
    v_mul_f32 v37, v37, v21
    v_mul_f32 v38, v38, v22
    v_mul_f32 v39, v39, v23
    v_mul_f32 v40, v40, v24
    v_mul_f32 v41, v41, v25
    v_mul_f32 v42, v42, v26
    v_mul_f32 v43, v43, v27
    v_mul_f32 v44, v44, v28
    v_mul_f32 v45, v45, v29
    v_mul_f32 v46, v46, v30
    v_mul_f32 v47, v47, v31
    v_exp_f32 v32, v32
    v_exp_f32 v33, v33
    v_exp_f32 v34, v34
    v_exp_f32 v35, v35
    v_exp_f32 v36, v36
    v_exp_f32 v37, v37
    v_exp_f32 v38, v38
    v_exp_f32 v39, v39
    v_exp_f32 v40, v40
    v_exp_f32 v41, v41
    v_exp_f32 v42, v42
    v_exp_f32 v43, v43
    v_exp_f32 v44, v44
    v_exp_f32 v45, v45
    v_exp_f32 v46, v46
    v_exp_f32 v47, v47
    v_fma_f32 v32, v32, v114, v114
    v_fma_f32 v33, v33, v114, v114
    v_fma_f32 v34, v34, v114, v114
    v_fma_f32 v35, v35, v114, v114
    v_fma_f32 v36, v36, v114, v114
    v_fma_f32 v37, v37, v114, v114
    v_fma_f32 v38, v38, v114, v114
    v_fma_f32 v39, v39, v114, v114
    v_fma_f32 v40, v40, v114, v114
    v_fma_f32 v41, v41, v114, v114
    v_fma_f32 v42, v42, v114, v114
    v_fma_f32 v43, v43, v114, v114
    v_fma_f32 v44, v44, v114, v114
    v_fma_f32 v45, v45, v114, v114
    v_fma_f32 v46, v46, v114, v114
    v_fma_f32 v47, v47, v114, v114
    v_rcp_f32 v32, v32
    v_rcp_f32 v33, v33
    v_rcp_f32 v34, v34
    v_rcp_f32 v35, v35
    v_rcp_f32 v36, v36
    v_rcp_f32 v37, v37
    v_rcp_f32 v38, v38
    v_rcp_f32 v39, v39
    v_rcp_f32 v40, v40
    v_rcp_f32 v41, v41
    v_rcp_f32 v42, v42
    v_rcp_f32 v43, v43
    v_rcp_f32 v44, v44
    v_rcp_f32 v45, v45
    v_rcp_f32 v46, v46
    v_rcp_f32 v47, v47
    v_mul_f32 v32, v32, v16
    v_mul_f32 v33, v33, v17
    v_mul_f32 v34, v34, v18
    v_mul_f32 v35, v35, v19
    v_mul_f32 v36, v36, v20
    v_mul_f32 v37, v37, v21
    v_mul_f32 v38, v38, v22
    v_mul_f32 v39, v39, v23
    v_mul_f32 v40, v40, v24
    v_mul_f32 v41, v41, v25
    v_mul_f32 v42, v42, v26
    v_mul_f32 v43, v43, v27
    v_mul_f32 v44, v44, v28
    v_mul_f32 v45, v45, v29
    v_mul_f32 v46, v46, v30
    v_mul_f32 v47, v47, v31
    v_cvt_pk_bf16_f32 v116, v32, v33
    v_cvt_pk_bf16_f32 v117, v34, v35
    v_cvt_pk_bf16_f32 v118, v36, v37
    v_cvt_pk_bf16_f32 v119, v38, v39
    v_cvt_pk_bf16_f32 v120, v40, v41
    v_cvt_pk_bf16_f32 v121, v42, v43
    v_cvt_pk_bf16_f32 v122, v44, v45
    v_cvt_pk_bf16_f32 v123, v46, v47
    buffer_store_dwordx4 v[116:119], v2, s[20:23], s54 offen offset:2048 sc1
    buffer_store_dwordx4 v[120:123], v2, s[20:23], s54 offen offset:3072 sc1
    s_branch L_attn
L_a0:
    v_mov_b32 v64, 0
    v_mov_b32 v128, 0
    v_mov_b32 v65, 0
    v_mov_b32 v129, 0
    v_mov_b32 v66, 0
    v_mov_b32 v130, 0
    v_mov_b32 v67, 0
    v_mov_b32 v131, 0
    v_mov_b32 v68, 0
    v_mov_b32 v132, 0
    v_mov_b32 v69, 0
    v_mov_b32 v133, 0
    v_mov_b32 v70, 0
    v_mov_b32 v134, 0
    v_mov_b32 v71, 0
    v_mov_b32 v135, 0
    v_mov_b32 v72, 0
    v_mov_b32 v136, 0
    v_mov_b32 v73, 0
    v_mov_b32 v137, 0
    v_mov_b32 v74, 0
    v_mov_b32 v138, 0
    v_mov_b32 v75, 0
    v_mov_b32 v139, 0
    v_mov_b32 v76, 0
    v_mov_b32 v140, 0
    v_mov_b32 v77, 0
    v_mov_b32 v141, 0
    v_mov_b32 v78, 0
    v_mov_b32 v142, 0
    v_mov_b32 v79, 0
    v_mov_b32 v143, 0
L_attn:
    s_setprio 0
    v_mov_b32 v176, 0xdddddddd
    s_lshl_b32 s50, s3, 11
    s_add_u32 s50, s50, 147456
    v_add_u32 v184, s50, v2
    s_lshl_b32 s50, s3, 2
    s_add_u32 s50, s50, 163328
    v_mov_b32 v177, s50
    v_mov_b32 v178, 1
    ds_write_b32 v177, v110
    s_cmp_lg_u32 s62, 0
    s_cbranch_scc1 L_kvd
    s_mov_b32 s60, 200000
    s_mov_b64 exec, 7
L_pl3:
    buffer_load_dword v3, v83, s[20:23], 0 offen sc1
    s_waitcnt vmcnt(0)
    v_cmp_ne_u32 vcc, 16, v3
    s_cbranch_vccz L_pd3
    s_sleep 8
    s_sub_u32 s60, s60, 1
    s_cbranch_scc0 L_pl3
L_pd3:
    s_mov_b64 exec, -1
    s_add_u32 m0, s59, 0
    s_add_u32 s50, s63, 2097152
    buffer_load_dwordx4 v2, s[20:23], s50 offen sc1 lds
    s_sub_u32 m0, 146432, s59
    s_add_u32 s50, s63, 4194304
    buffer_load_dwordx4 v2, s[20:23], s50 offen sc1 lds
    s_lshl_b32 s50, s58, 13
    s_add_u32 s50, s50, s63
    s_add_u32 s50, s50, s59
    s_lshl_b32 s51, s59, 1
    s_add_u32 m0, s51, 147456
    s_nop 0
    buffer_load_dwordx4 v2, s[20:23], s50 offen sc1 lds
    buffer_load_dwordx4 v2, s[20:23], s50 offen offset:1024 sc1 lds
    s_add_u32 m0, s59, 4096
    s_add_u32 s50, s63, 2101248
    buffer_load_dwordx4 v2, s[20:23], s50 offen sc1 lds
    s_sub_u32 m0, 142336, s59
    s_add_u32 s50, s63, 4198400
    buffer_load_dwordx4 v2, s[20:23], s50 offen sc1 lds
    s_waitcnt vmcnt(0)
L_kvd:
    s_waitcnt vmcnt(2) lgkmcnt(0)
    s_barrier
    ds_read_b128 v[144:147], v184
    ds_read_b128 v[148:151], v184 offset:1024
    ds_read_b128 v[152:155], v80
    ds_read_b128 v[160:163], v81 offset:3072
    ds_read_b128 v[164:167], v81 offset:3584
    s_waitcnt lgkmcnt(2)
    v_mfma_f32_32x32x16_bf16 v[16:31], v[152:155], v[144:147], 0
    s_nop 7
    s_nop 3
    v_exp_f32 v16, v16
    v_exp_f32 v17, v17
    v_exp_f32 v18, v18
    v_exp_f32 v19, v19
    v_exp_f32 v20, v20
    ds_read_b128 v[156:159], v80 offset:1024
    v_exp_f32 v21, v21
    v_exp_f32 v22, v22
    v_mfma_f32_32x32x16_bf16 v[32:47], v[152:155], v[148:151], 0
    s_waitcnt lgkmcnt(1)
    v_exp_f32 v23, v23
    v_exp_f32 v24, v24
    v_exp_f32 v25, v25
    v_smfmac_f32_32x32x32_bf16 v[64:79], v[160:163], v[16:23], v176
    ds_read_b128 v[168:171], v81 offset:2048
    v_exp_f32 v26, v26
    v_exp_f32 v27, v27
    v_exp_f32 v28, v28
    v_exp_f32 v29, v29
    v_exp_f32 v30, v30
    v_exp_f32 v31, v31
    v_exp_f32 v32, v32
    v_exp_f32 v33, v33
    v_exp_f32 v34, v34
    v_exp_f32 v35, v35
    v_exp_f32 v36, v36
    v_smfmac_f32_32x32x32_bf16 v[64:79], v[164:167], v[24:31], v176
    s_waitcnt lgkmcnt(1)
    ds_read_b128 v[172:175], v81 offset:2560
    v_exp_f32 v37, v37
    v_exp_f32 v38, v38
    v_mfma_f32_32x32x16_bf16 v[16:31], v[156:159], v[144:147], 0
    s_nop 0
    v_exp_f32 v39, v39
    v_exp_f32 v40, v40
    v_exp_f32 v41, v41
    v_smfmac_f32_32x32x32_bf16 v[128:143], v[160:163], v[32:39], v176
    s_nop 0
    v_exp_f32 v42, v42
    v_exp_f32 v43, v43
    v_exp_f32 v44, v44
    v_exp_f32 v45, v45
    v_exp_f32 v46, v46
    v_exp_f32 v47, v47
    v_exp_f32 v16, v16
    v_exp_f32 v17, v17
    v_exp_f32 v18, v18
    v_exp_f32 v19, v19
    v_exp_f32 v20, v20
    v_smfmac_f32_32x32x32_bf16 v[128:143], v[164:167], v[40:47], v176
    ds_read_b128 v[152:155], v80 offset:2048
    v_exp_f32 v21, v21
    v_exp_f32 v22, v22
    v_mfma_f32_32x32x16_bf16 v[32:47], v[156:159], v[148:151], 0
    s_waitcnt lgkmcnt(1)
    v_exp_f32 v23, v23
    v_exp_f32 v24, v24
    v_exp_f32 v25, v25
    v_smfmac_f32_32x32x32_bf16 v[64:79], v[168:171], v[16:23], v176
    ds_read_b128 v[160:163], v81 offset:1024
    v_exp_f32 v26, v26
    v_exp_f32 v27, v27
    v_exp_f32 v28, v28
    v_exp_f32 v29, v29
    v_exp_f32 v30, v30
    v_exp_f32 v31, v31
    v_exp_f32 v32, v32
    v_exp_f32 v33, v33
    v_exp_f32 v34, v34
    v_exp_f32 v35, v35
    v_exp_f32 v36, v36
    v_smfmac_f32_32x32x32_bf16 v[64:79], v[172:175], v[24:31], v176
    s_waitcnt lgkmcnt(1)
    ds_read_b128 v[164:167], v81 offset:1536
    v_exp_f32 v37, v37
    v_exp_f32 v38, v38
    v_mfma_f32_32x32x16_bf16 v[16:31], v[152:155], v[144:147], 0
    s_nop 0
    v_exp_f32 v39, v39
    v_exp_f32 v40, v40
    v_exp_f32 v41, v41
    v_smfmac_f32_32x32x32_bf16 v[128:143], v[168:171], v[32:39], v176
    s_nop 0
    v_exp_f32 v42, v42
    v_exp_f32 v43, v43
    v_exp_f32 v44, v44
    v_exp_f32 v45, v45
    v_exp_f32 v46, v46
    v_exp_f32 v47, v47
    v_exp_f32 v16, v16
    v_exp_f32 v17, v17
    v_exp_f32 v18, v18
    v_exp_f32 v19, v19
    v_exp_f32 v20, v20
    v_smfmac_f32_32x32x32_bf16 v[128:143], v[172:175], v[40:47], v176
    ds_read_b128 v[156:159], v80 offset:3072
    v_exp_f32 v21, v21
    v_exp_f32 v22, v22
    v_mfma_f32_32x32x16_bf16 v[32:47], v[152:155], v[148:151], 0
    s_waitcnt lgkmcnt(1)
    v_exp_f32 v23, v23
    v_exp_f32 v24, v24
    v_exp_f32 v25, v25
    v_smfmac_f32_32x32x32_bf16 v[64:79], v[160:163], v[16:23], v176
    ds_read_b128 v[168:171], v81 offset:0
    v_exp_f32 v26, v26
    v_exp_f32 v27, v27
    v_exp_f32 v28, v28
    v_exp_f32 v29, v29
    v_exp_f32 v30, v30
    v_exp_f32 v31, v31
    v_exp_f32 v32, v32
    v_exp_f32 v33, v33
    v_exp_f32 v34, v34
    v_exp_f32 v35, v35
    v_exp_f32 v36, v36
    v_smfmac_f32_32x32x32_bf16 v[64:79], v[164:167], v[24:31], v176
    s_waitcnt lgkmcnt(1)
    ds_read_b128 v[172:175], v81 offset:512
    v_exp_f32 v37, v37
    v_exp_f32 v38, v38
    v_mfma_f32_32x32x16_bf16 v[16:31], v[156:159], v[144:147], 0
    s_nop 0
    v_exp_f32 v39, v39
    v_exp_f32 v40, v40
    v_exp_f32 v41, v41
    v_smfmac_f32_32x32x32_bf16 v[128:143], v[160:163], v[32:39], v176
    s_nop 0
    v_exp_f32 v42, v42
    v_exp_f32 v43, v43
    v_exp_f32 v44, v44
    v_exp_f32 v45, v45
    v_exp_f32 v46, v46
    v_exp_f32 v47, v47
    v_sub_u32 v81, v81, v84
    v_exp_f32 v16, v16
    v_exp_f32 v17, v17
    v_exp_f32 v18, v18
    v_exp_f32 v19, v19
    v_exp_f32 v20, v20
    v_smfmac_f32_32x32x32_bf16 v[128:143], v[164:167], v[40:47], v176
    ds_read_b128 v[152:155], v80 offset:4096
    v_exp_f32 v21, v21
    v_exp_f32 v22, v22
    v_mfma_f32_32x32x16_bf16 v[32:47], v[156:159], v[148:151], 0
    s_waitcnt lgkmcnt(1)
    v_exp_f32 v23, v23
    v_exp_f32 v24, v24
    v_exp_f32 v25, v25
    v_smfmac_f32_32x32x32_bf16 v[64:79], v[168:171], v[16:23], v176
    ds_read_b128 v[160:163], v81 offset:3072
    v_exp_f32 v26, v26
    v_exp_f32 v27, v27
    v_exp_f32 v28, v28
    v_exp_f32 v29, v29
    v_exp_f32 v30, v30
    v_exp_f32 v31, v31
    v_exp_f32 v32, v32
    v_exp_f32 v33, v33
    v_exp_f32 v34, v34
    v_exp_f32 v35, v35
    v_exp_f32 v36, v36
    v_smfmac_f32_32x32x32_bf16 v[64:79], v[172:175], v[24:31], v176
    s_waitcnt lgkmcnt(1)
    ds_read_b128 v[164:167], v81 offset:3584
    v_exp_f32 v37, v37
    v_exp_f32 v38, v38
    v_mfma_f32_32x32x16_bf16 v[16:31], v[152:155], v[144:147], 0
    s_nop 0
    v_exp_f32 v39, v39
    v_exp_f32 v40, v40
    v_exp_f32 v41, v41
    v_smfmac_f32_32x32x32_bf16 v[128:143], v[168:171], v[32:39], v176
    s_nop 0
    v_exp_f32 v42, v42
    v_exp_f32 v43, v43
    v_exp_f32 v44, v44
    v_exp_f32 v45, v45
    v_exp_f32 v46, v46
    v_exp_f32 v47, v47
    v_exp_f32 v16, v16
    v_exp_f32 v17, v17
    v_exp_f32 v18, v18
    v_exp_f32 v19, v19
    v_exp_f32 v20, v20
    v_smfmac_f32_32x32x32_bf16 v[128:143], v[172:175], v[40:47], v176
    ds_read_b128 v[156:159], v80 offset:5120
    v_exp_f32 v21, v21
    v_exp_f32 v22, v22
    v_mfma_f32_32x32x16_bf16 v[32:47], v[152:155], v[148:151], 0
    s_waitcnt lgkmcnt(1)
    v_exp_f32 v23, v23
    v_exp_f32 v24, v24
    v_exp_f32 v25, v25
    v_smfmac_f32_32x32x32_bf16 v[64:79], v[160:163], v[16:23], v176
    ds_read_b128 v[168:171], v81 offset:2048
    v_exp_f32 v26, v26
    v_exp_f32 v27, v27
    v_exp_f32 v28, v28
    v_exp_f32 v29, v29
    v_exp_f32 v30, v30
    v_exp_f32 v31, v31
    v_exp_f32 v32, v32
    v_exp_f32 v33, v33
    v_exp_f32 v34, v34
    v_exp_f32 v35, v35
    v_exp_f32 v36, v36
    v_smfmac_f32_32x32x32_bf16 v[64:79], v[164:167], v[24:31], v176
    s_waitcnt lgkmcnt(1)
    ds_read_b128 v[172:175], v81 offset:2560
    v_exp_f32 v37, v37
    v_exp_f32 v38, v38
    v_mfma_f32_32x32x16_bf16 v[16:31], v[156:159], v[144:147], 0
    s_nop 0
    v_exp_f32 v39, v39
    v_exp_f32 v40, v40
    v_exp_f32 v41, v41
    v_smfmac_f32_32x32x32_bf16 v[128:143], v[160:163], v[32:39], v176
    s_nop 0
    v_exp_f32 v42, v42
    v_exp_f32 v43, v43
    v_exp_f32 v44, v44
    v_exp_f32 v45, v45
    v_exp_f32 v46, v46
    v_exp_f32 v47, v47
    v_exp_f32 v16, v16
    v_exp_f32 v17, v17
    v_exp_f32 v18, v18
    v_exp_f32 v19, v19
    v_exp_f32 v20, v20
    v_smfmac_f32_32x32x32_bf16 v[128:143], v[164:167], v[40:47], v176
    ds_read_b128 v[152:155], v80 offset:6144
    v_exp_f32 v21, v21
    v_exp_f32 v22, v22
    v_mfma_f32_32x32x16_bf16 v[32:47], v[156:159], v[148:151], 0
    s_waitcnt lgkmcnt(1)
    v_exp_f32 v23, v23
    v_exp_f32 v24, v24
    v_exp_f32 v25, v25
    v_smfmac_f32_32x32x32_bf16 v[64:79], v[168:171], v[16:23], v176
    ds_read_b128 v[160:163], v81 offset:1024
    v_exp_f32 v26, v26
    v_exp_f32 v27, v27
    v_exp_f32 v28, v28
    v_exp_f32 v29, v29
    v_exp_f32 v30, v30
    v_exp_f32 v31, v31
    v_exp_f32 v32, v32
    v_exp_f32 v33, v33
    v_exp_f32 v34, v34
    v_exp_f32 v35, v35
    v_exp_f32 v36, v36
    v_smfmac_f32_32x32x32_bf16 v[64:79], v[172:175], v[24:31], v176
    s_waitcnt lgkmcnt(1)
    ds_read_b128 v[164:167], v81 offset:1536
    v_exp_f32 v37, v37
    v_exp_f32 v38, v38
    v_mfma_f32_32x32x16_bf16 v[16:31], v[152:155], v[144:147], 0
    s_nop 0
    v_exp_f32 v39, v39
    v_exp_f32 v40, v40
    v_exp_f32 v41, v41
    v_smfmac_f32_32x32x32_bf16 v[128:143], v[168:171], v[32:39], v176
    s_nop 0
    v_exp_f32 v42, v42
    v_exp_f32 v43, v43
    v_exp_f32 v44, v44
    v_exp_f32 v45, v45
    v_exp_f32 v46, v46
    v_exp_f32 v47, v47
    v_exp_f32 v16, v16
    v_exp_f32 v17, v17
    v_exp_f32 v18, v18
    v_exp_f32 v19, v19
    v_exp_f32 v20, v20
    v_smfmac_f32_32x32x32_bf16 v[128:143], v[172:175], v[40:47], v176
    ds_read_b128 v[156:159], v80 offset:7168
    v_exp_f32 v21, v21
    v_exp_f32 v22, v22
    v_mfma_f32_32x32x16_bf16 v[32:47], v[152:155], v[148:151], 0
    s_waitcnt lgkmcnt(1)
    v_exp_f32 v23, v23
    v_exp_f32 v24, v24
    v_exp_f32 v25, v25
    v_smfmac_f32_32x32x32_bf16 v[64:79], v[160:163], v[16:23], v176
    ds_read_b128 v[168:171], v81 offset:0
    v_exp_f32 v26, v26
    v_exp_f32 v27, v27
    v_exp_f32 v28, v28
    v_exp_f32 v29, v29
    v_exp_f32 v30, v30
    v_exp_f32 v31, v31
    v_exp_f32 v32, v32
    v_exp_f32 v33, v33
    v_exp_f32 v34, v34
    v_exp_f32 v35, v35
    v_exp_f32 v36, v36
    v_smfmac_f32_32x32x32_bf16 v[64:79], v[164:167], v[24:31], v176
    s_waitcnt lgkmcnt(1)
    ds_read_b128 v[172:175], v81 offset:512
    v_exp_f32 v37, v37
    v_exp_f32 v38, v38
    v_mfma_f32_32x32x16_bf16 v[16:31], v[156:159], v[144:147], 0
    s_nop 0
    v_exp_f32 v39, v39
    v_exp_f32 v40, v40
    v_exp_f32 v41, v41
    v_smfmac_f32_32x32x32_bf16 v[128:143], v[160:163], v[32:39], v176
    s_nop 0
    v_exp_f32 v42, v42
    v_exp_f32 v43, v43
    v_exp_f32 v44, v44
    v_exp_f32 v45, v45
    v_exp_f32 v46, v46
    v_exp_f32 v47, v47
    s_waitcnt vmcnt(0)
    s_barrier
    v_sub_u32 v81, v81, v84
    v_exp_f32 v16, v16
    v_exp_f32 v17, v17
    v_exp_f32 v18, v18
    v_exp_f32 v19, v19
    v_exp_f32 v20, v20
    v_smfmac_f32_32x32x32_bf16 v[128:143], v[164:167], v[40:47], v176
    ds_read_b128 v[152:155], v80 offset:8192
    v_exp_f32 v21, v21
    v_exp_f32 v22, v22
    v_mfma_f32_32x32x16_bf16 v[32:47], v[156:159], v[148:151], 0
    s_waitcnt lgkmcnt(1)
    v_exp_f32 v23, v23
    v_exp_f32 v24, v24
    v_exp_f32 v25, v25
    v_smfmac_f32_32x32x32_bf16 v[64:79], v[168:171], v[16:23], v176
    ds_read_b128 v[160:163], v81 offset:3072
    v_exp_f32 v26, v26
    v_exp_f32 v27, v27
    v_exp_f32 v28, v28
    v_exp_f32 v29, v29
    v_exp_f32 v30, v30
    v_exp_f32 v31, v31
    v_exp_f32 v32, v32
    v_exp_f32 v33, v33
    v_exp_f32 v34, v34
    v_exp_f32 v35, v35
    v_exp_f32 v36, v36
    v_smfmac_f32_32x32x32_bf16 v[64:79], v[172:175], v[24:31], v176
    s_waitcnt lgkmcnt(1)
    ds_read_b128 v[164:167], v81 offset:3584
    v_exp_f32 v37, v37
    v_exp_f32 v38, v38
    v_mfma_f32_32x32x16_bf16 v[16:31], v[152:155], v[144:147], 0
    s_nop 0
    v_exp_f32 v39, v39
    v_exp_f32 v40, v40
    v_exp_f32 v41, v41
    v_smfmac_f32_32x32x32_bf16 v[128:143], v[168:171], v[32:39], v176
    s_nop 0
    v_exp_f32 v42, v42
    v_exp_f32 v43, v43
    v_exp_f32 v44, v44
    v_exp_f32 v45, v45
    v_exp_f32 v46, v46
    v_exp_f32 v47, v47
    v_exp_f32 v16, v16
    v_exp_f32 v17, v17
    v_exp_f32 v18, v18
    v_exp_f32 v19, v19
    v_exp_f32 v20, v20
    v_smfmac_f32_32x32x32_bf16 v[128:143], v[172:175], v[40:47], v176
    ds_read_b128 v[156:159], v80 offset:9216
    v_exp_f32 v21, v21
    v_exp_f32 v22, v22
    v_mfma_f32_32x32x16_bf16 v[32:47], v[152:155], v[148:151], 0
    s_waitcnt lgkmcnt(1)
    v_exp_f32 v23, v23
    v_exp_f32 v24, v24
    v_exp_f32 v25, v25
    v_smfmac_f32_32x32x32_bf16 v[64:79], v[160:163], v[16:23], v176
    ds_read_b128 v[168:171], v81 offset:2048
    v_exp_f32 v26, v26
    v_exp_f32 v27, v27
    v_exp_f32 v28, v28
    v_exp_f32 v29, v29
    v_exp_f32 v30, v30
    v_exp_f32 v31, v31
    v_exp_f32 v32, v32
    v_exp_f32 v33, v33
    v_exp_f32 v34, v34
    v_exp_f32 v35, v35
    v_exp_f32 v36, v36
    v_smfmac_f32_32x32x32_bf16 v[64:79], v[164:167], v[24:31], v176
    s_waitcnt lgkmcnt(1)
    ds_read_b128 v[172:175], v81 offset:2560
    v_exp_f32 v37, v37
    v_exp_f32 v38, v38
    v_mfma_f32_32x32x16_bf16 v[16:31], v[156:159], v[144:147], 0
    s_nop 0
    v_exp_f32 v39, v39
    v_exp_f32 v40, v40
    v_exp_f32 v41, v41
    v_smfmac_f32_32x32x32_bf16 v[128:143], v[160:163], v[32:39], v176
    s_nop 0
    v_exp_f32 v42, v42
    v_exp_f32 v43, v43
    v_exp_f32 v44, v44
    v_exp_f32 v45, v45
    v_exp_f32 v46, v46
    v_exp_f32 v47, v47
    v_exp_f32 v16, v16
    v_exp_f32 v17, v17
    v_exp_f32 v18, v18
    v_exp_f32 v19, v19
    v_exp_f32 v20, v20
    v_smfmac_f32_32x32x32_bf16 v[128:143], v[164:167], v[40:47], v176
    ds_read_b128 v[152:155], v80 offset:10240
    v_exp_f32 v21, v21
    v_exp_f32 v22, v22
    v_mfma_f32_32x32x16_bf16 v[32:47], v[156:159], v[148:151], 0
    s_waitcnt lgkmcnt(1)
    v_exp_f32 v23, v23
    v_exp_f32 v24, v24
    v_exp_f32 v25, v25
    v_smfmac_f32_32x32x32_bf16 v[64:79], v[168:171], v[16:23], v176
    ds_read_b128 v[160:163], v81 offset:1024
    v_exp_f32 v26, v26
    v_exp_f32 v27, v27
    v_exp_f32 v28, v28
    v_exp_f32 v29, v29
    v_exp_f32 v30, v30
    v_exp_f32 v31, v31
    v_exp_f32 v32, v32
    v_exp_f32 v33, v33
    v_exp_f32 v34, v34
    v_exp_f32 v35, v35
    v_exp_f32 v36, v36
    v_smfmac_f32_32x32x32_bf16 v[64:79], v[172:175], v[24:31], v176
    s_waitcnt lgkmcnt(1)
    ds_read_b128 v[164:167], v81 offset:1536
    v_exp_f32 v37, v37
    v_exp_f32 v38, v38
    v_mfma_f32_32x32x16_bf16 v[16:31], v[152:155], v[144:147], 0
    s_nop 0
    v_exp_f32 v39, v39
    v_exp_f32 v40, v40
    v_exp_f32 v41, v41
    v_smfmac_f32_32x32x32_bf16 v[128:143], v[168:171], v[32:39], v176
    s_nop 0
    v_exp_f32 v42, v42
    v_exp_f32 v43, v43
    v_exp_f32 v44, v44
    v_exp_f32 v45, v45
    v_exp_f32 v46, v46
    v_exp_f32 v47, v47
    v_exp_f32 v16, v16
    v_exp_f32 v17, v17
    v_exp_f32 v18, v18
    v_exp_f32 v19, v19
    v_exp_f32 v20, v20
    v_smfmac_f32_32x32x32_bf16 v[128:143], v[172:175], v[40:47], v176
    ds_read_b128 v[156:159], v80 offset:11264
    v_exp_f32 v21, v21
    v_exp_f32 v22, v22
    v_mfma_f32_32x32x16_bf16 v[32:47], v[152:155], v[148:151], 0
    s_waitcnt lgkmcnt(1)
    v_exp_f32 v23, v23
    v_exp_f32 v24, v24
    v_exp_f32 v25, v25
    v_smfmac_f32_32x32x32_bf16 v[64:79], v[160:163], v[16:23], v176
    ds_read_b128 v[168:171], v81 offset:0
    v_exp_f32 v26, v26
    v_exp_f32 v27, v27
    v_exp_f32 v28, v28
    v_exp_f32 v29, v29
    v_exp_f32 v30, v30
    v_exp_f32 v31, v31
    v_exp_f32 v32, v32
    v_exp_f32 v33, v33
    v_exp_f32 v34, v34
    v_exp_f32 v35, v35
    v_exp_f32 v36, v36
    v_smfmac_f32_32x32x32_bf16 v[64:79], v[164:167], v[24:31], v176
    s_waitcnt lgkmcnt(1)
    ds_read_b128 v[172:175], v81 offset:512
    v_exp_f32 v37, v37
    v_exp_f32 v38, v38
    v_mfma_f32_32x32x16_bf16 v[16:31], v[156:159], v[144:147], 0
    s_nop 0
    v_exp_f32 v39, v39
    v_exp_f32 v40, v40
    v_exp_f32 v41, v41
    v_smfmac_f32_32x32x32_bf16 v[128:143], v[160:163], v[32:39], v176
    s_nop 0
    v_exp_f32 v42, v42
    v_exp_f32 v43, v43
    v_exp_f32 v44, v44
    v_exp_f32 v45, v45
    v_exp_f32 v46, v46
    v_exp_f32 v47, v47
    v_sub_u32 v81, v81, v84
    v_exp_f32 v16, v16
    v_exp_f32 v17, v17
    v_exp_f32 v18, v18
    v_exp_f32 v19, v19
    v_exp_f32 v20, v20
    v_smfmac_f32_32x32x32_bf16 v[128:143], v[164:167], v[40:47], v176
    ds_read_b128 v[152:155], v80 offset:12288
    v_exp_f32 v21, v21
    v_exp_f32 v22, v22
    v_mfma_f32_32x32x16_bf16 v[32:47], v[156:159], v[148:151], 0
    s_waitcnt lgkmcnt(1)
    v_exp_f32 v23, v23
    v_exp_f32 v24, v24
    v_exp_f32 v25, v25
    v_smfmac_f32_32x32x32_bf16 v[64:79], v[168:171], v[16:23], v176
    ds_read_b128 v[160:163], v81 offset:3072
    v_exp_f32 v26, v26
    v_exp_f32 v27, v27
    v_exp_f32 v28, v28
    v_exp_f32 v29, v29
    v_exp_f32 v30, v30
    v_exp_f32 v31, v31
    v_exp_f32 v32, v32
    v_exp_f32 v33, v33
    v_exp_f32 v34, v34
    v_exp_f32 v35, v35
    v_exp_f32 v36, v36
    v_smfmac_f32_32x32x32_bf16 v[64:79], v[172:175], v[24:31], v176
    s_waitcnt lgkmcnt(1)
    ds_read_b128 v[164:167], v81 offset:3584
    v_exp_f32 v37, v37
    v_exp_f32 v38, v38
    v_mfma_f32_32x32x16_bf16 v[16:31], v[152:155], v[144:147], 0
    s_nop 0
    v_exp_f32 v39, v39
    v_exp_f32 v40, v40
    v_exp_f32 v41, v41
    v_smfmac_f32_32x32x32_bf16 v[128:143], v[168:171], v[32:39], v176
    s_nop 0
    v_exp_f32 v42, v42
    v_exp_f32 v43, v43
    v_exp_f32 v44, v44
    v_exp_f32 v45, v45
    v_exp_f32 v46, v46
    v_exp_f32 v47, v47
    v_exp_f32 v16, v16
    v_exp_f32 v17, v17
    v_exp_f32 v18, v18
    v_exp_f32 v19, v19
    v_exp_f32 v20, v20
    v_smfmac_f32_32x32x32_bf16 v[128:143], v[172:175], v[40:47], v176
    ds_read_b128 v[156:159], v80 offset:13312
    v_exp_f32 v21, v21
    v_exp_f32 v22, v22
    v_mfma_f32_32x32x16_bf16 v[32:47], v[152:155], v[148:151], 0
    s_waitcnt lgkmcnt(1)
    v_exp_f32 v23, v23
    v_exp_f32 v24, v24
    v_exp_f32 v25, v25
    v_smfmac_f32_32x32x32_bf16 v[64:79], v[160:163], v[16:23], v176
    ds_read_b128 v[168:171], v81 offset:2048
    v_exp_f32 v26, v26
    v_exp_f32 v27, v27
    v_exp_f32 v28, v28
    v_exp_f32 v29, v29
    v_exp_f32 v30, v30
    v_exp_f32 v31, v31
    v_exp_f32 v32, v32
    v_exp_f32 v33, v33
    v_exp_f32 v34, v34
    v_exp_f32 v35, v35
    v_exp_f32 v36, v36
    v_smfmac_f32_32x32x32_bf16 v[64:79], v[164:167], v[24:31], v176
    s_waitcnt lgkmcnt(1)
    ds_read_b128 v[172:175], v81 offset:2560
    v_exp_f32 v37, v37
    v_exp_f32 v38, v38
    v_mfma_f32_32x32x16_bf16 v[16:31], v[156:159], v[144:147], 0
    s_nop 0
    v_exp_f32 v39, v39
    v_exp_f32 v40, v40
    v_exp_f32 v41, v41
    v_smfmac_f32_32x32x32_bf16 v[128:143], v[160:163], v[32:39], v176
    s_nop 0
    v_exp_f32 v42, v42
    v_exp_f32 v43, v43
    v_exp_f32 v44, v44
    v_exp_f32 v45, v45
    v_exp_f32 v46, v46
    v_exp_f32 v47, v47
    v_exp_f32 v16, v16
    v_exp_f32 v17, v17
    v_exp_f32 v18, v18
    v_exp_f32 v19, v19
    v_exp_f32 v20, v20
    v_smfmac_f32_32x32x32_bf16 v[128:143], v[164:167], v[40:47], v176
    ds_read_b128 v[152:155], v80 offset:14336
    v_exp_f32 v21, v21
    v_exp_f32 v22, v22
    v_mfma_f32_32x32x16_bf16 v[32:47], v[156:159], v[148:151], 0
    s_waitcnt lgkmcnt(1)
    v_exp_f32 v23, v23
    v_exp_f32 v24, v24
    v_exp_f32 v25, v25
    v_smfmac_f32_32x32x32_bf16 v[64:79], v[168:171], v[16:23], v176
    ds_read_b128 v[160:163], v81 offset:1024
    v_exp_f32 v26, v26
    v_exp_f32 v27, v27
    v_exp_f32 v28, v28
    v_exp_f32 v29, v29
    v_exp_f32 v30, v30
    v_exp_f32 v31, v31
    v_exp_f32 v32, v32
    v_exp_f32 v33, v33
    v_exp_f32 v34, v34
    v_exp_f32 v35, v35
    v_exp_f32 v36, v36
    v_smfmac_f32_32x32x32_bf16 v[64:79], v[172:175], v[24:31], v176
    s_waitcnt lgkmcnt(1)
    ds_read_b128 v[164:167], v81 offset:1536
    v_exp_f32 v37, v37
    v_exp_f32 v38, v38
    v_mfma_f32_32x32x16_bf16 v[16:31], v[152:155], v[144:147], 0
    s_nop 0
    v_exp_f32 v39, v39
    v_exp_f32 v40, v40
    v_exp_f32 v41, v41
    v_smfmac_f32_32x32x32_bf16 v[128:143], v[168:171], v[32:39], v176
    s_nop 0
    v_exp_f32 v42, v42
    v_exp_f32 v43, v43
    v_exp_f32 v44, v44
    v_exp_f32 v45, v45
    v_exp_f32 v46, v46
    v_exp_f32 v47, v47
    v_exp_f32 v16, v16
    v_exp_f32 v17, v17
    v_exp_f32 v18, v18
    v_exp_f32 v19, v19
    v_exp_f32 v20, v20
    v_smfmac_f32_32x32x32_bf16 v[128:143], v[172:175], v[40:47], v176
    ds_read_b128 v[156:159], v80 offset:15360
    v_exp_f32 v21, v21
    v_exp_f32 v22, v22
    v_mfma_f32_32x32x16_bf16 v[32:47], v[152:155], v[148:151], 0
    s_waitcnt lgkmcnt(1)
    v_exp_f32 v23, v23
    v_exp_f32 v24, v24
    v_exp_f32 v25, v25
    v_smfmac_f32_32x32x32_bf16 v[64:79], v[160:163], v[16:23], v176
    ds_read_b128 v[168:171], v81 offset:0
    v_exp_f32 v26, v26
    v_exp_f32 v27, v27
    v_exp_f32 v28, v28
    v_exp_f32 v29, v29
    v_exp_f32 v30, v30
    v_exp_f32 v31, v31
    v_exp_f32 v32, v32
    v_exp_f32 v33, v33
    v_exp_f32 v34, v34
    v_exp_f32 v35, v35
    v_exp_f32 v36, v36
    v_smfmac_f32_32x32x32_bf16 v[64:79], v[164:167], v[24:31], v176
    s_waitcnt lgkmcnt(1)
    ds_read_b128 v[172:175], v81 offset:512
    v_exp_f32 v37, v37
    v_exp_f32 v38, v38
    v_mfma_f32_32x32x16_bf16 v[16:31], v[156:159], v[144:147], 0
    s_nop 0
    v_exp_f32 v39, v39
    v_exp_f32 v40, v40
    v_exp_f32 v41, v41
    v_smfmac_f32_32x32x32_bf16 v[128:143], v[160:163], v[32:39], v176
    s_nop 0
    v_exp_f32 v42, v42
    v_exp_f32 v43, v43
    v_exp_f32 v44, v44
    v_exp_f32 v45, v45
    v_exp_f32 v46, v46
    v_exp_f32 v47, v47
    s_waitcnt vmcnt(0)
    s_barrier
    v_sub_u32 v81, v81, v84
    v_exp_f32 v16, v16
    v_exp_f32 v17, v17
    v_exp_f32 v18, v18
    v_exp_f32 v19, v19
    v_exp_f32 v20, v20
    v_smfmac_f32_32x32x32_bf16 v[128:143], v[164:167], v[40:47], v176
    ds_read_b128 v[152:155], v80 offset:16384
    v_exp_f32 v21, v21
    v_exp_f32 v22, v22
    v_mfma_f32_32x32x16_bf16 v[32:47], v[156:159], v[148:151], 0
    s_waitcnt lgkmcnt(1)
    v_exp_f32 v23, v23
    v_exp_f32 v24, v24
    v_exp_f32 v25, v25
    v_smfmac_f32_32x32x32_bf16 v[64:79], v[168:171], v[16:23], v176
    ds_read_b128 v[160:163], v81 offset:3072
    v_exp_f32 v26, v26
    v_exp_f32 v27, v27
    v_exp_f32 v28, v28
    v_exp_f32 v29, v29
    v_exp_f32 v30, v30
    v_exp_f32 v31, v31
    v_exp_f32 v32, v32
    v_exp_f32 v33, v33
    v_exp_f32 v34, v34
    v_exp_f32 v35, v35
    v_exp_f32 v36, v36
    v_smfmac_f32_32x32x32_bf16 v[64:79], v[172:175], v[24:31], v176
    s_waitcnt lgkmcnt(1)
    ds_read_b128 v[164:167], v81 offset:3584
    v_exp_f32 v37, v37
    v_exp_f32 v38, v38
    v_mfma_f32_32x32x16_bf16 v[16:31], v[152:155], v[144:147], 0
    s_nop 0
    v_exp_f32 v39, v39
    v_exp_f32 v40, v40
    v_exp_f32 v41, v41
    v_smfmac_f32_32x32x32_bf16 v[128:143], v[168:171], v[32:39], v176
    s_nop 0
    v_exp_f32 v42, v42
    v_exp_f32 v43, v43
    v_exp_f32 v44, v44
    v_exp_f32 v45, v45
    v_exp_f32 v46, v46
    v_exp_f32 v47, v47
    v_exp_f32 v16, v16
    v_exp_f32 v17, v17
    v_exp_f32 v18, v18
    v_exp_f32 v19, v19
    v_exp_f32 v20, v20
    v_smfmac_f32_32x32x32_bf16 v[128:143], v[172:175], v[40:47], v176
    ds_read_b128 v[156:159], v80 offset:17408
    v_exp_f32 v21, v21
    v_exp_f32 v22, v22
    v_mfma_f32_32x32x16_bf16 v[32:47], v[152:155], v[148:151], 0
    s_waitcnt lgkmcnt(1)
    v_exp_f32 v23, v23
    v_exp_f32 v24, v24
    v_exp_f32 v25, v25
    v_smfmac_f32_32x32x32_bf16 v[64:79], v[160:163], v[16:23], v176
    ds_read_b128 v[168:171], v81 offset:2048
    v_exp_f32 v26, v26
    v_exp_f32 v27, v27
    v_exp_f32 v28, v28
    v_exp_f32 v29, v29
    v_exp_f32 v30, v30
    v_exp_f32 v31, v31
    v_exp_f32 v32, v32
    v_exp_f32 v33, v33
    v_exp_f32 v34, v34
    v_exp_f32 v35, v35
    v_exp_f32 v36, v36
    v_smfmac_f32_32x32x32_bf16 v[64:79], v[164:167], v[24:31], v176
    s_waitcnt lgkmcnt(1)
    ds_read_b128 v[172:175], v81 offset:2560
    v_exp_f32 v37, v37
    v_exp_f32 v38, v38
    v_mfma_f32_32x32x16_bf16 v[16:31], v[156:159], v[144:147], 0
    s_nop 0
    v_exp_f32 v39, v39
    v_exp_f32 v40, v40
    v_exp_f32 v41, v41
    v_smfmac_f32_32x32x32_bf16 v[128:143], v[160:163], v[32:39], v176
    s_nop 0
    v_exp_f32 v42, v42
    v_exp_f32 v43, v43
    v_exp_f32 v44, v44
    v_exp_f32 v45, v45
    v_exp_f32 v46, v46
    v_exp_f32 v47, v47
    v_exp_f32 v16, v16
    v_exp_f32 v17, v17
    v_exp_f32 v18, v18
    v_exp_f32 v19, v19
    v_exp_f32 v20, v20
    v_smfmac_f32_32x32x32_bf16 v[128:143], v[164:167], v[40:47], v176
    ds_read_b128 v[152:155], v80 offset:18432
    v_exp_f32 v21, v21
    v_exp_f32 v22, v22
    v_mfma_f32_32x32x16_bf16 v[32:47], v[156:159], v[148:151], 0
    s_waitcnt lgkmcnt(1)
    v_exp_f32 v23, v23
    v_exp_f32 v24, v24
    v_exp_f32 v25, v25
    v_smfmac_f32_32x32x32_bf16 v[64:79], v[168:171], v[16:23], v176
    ds_read_b128 v[160:163], v81 offset:1024
    v_exp_f32 v26, v26
    v_exp_f32 v27, v27
    v_exp_f32 v28, v28
    v_exp_f32 v29, v29
    v_exp_f32 v30, v30
    v_exp_f32 v31, v31
    v_exp_f32 v32, v32
    v_exp_f32 v33, v33
    v_exp_f32 v34, v34
    v_exp_f32 v35, v35
    v_exp_f32 v36, v36
    v_smfmac_f32_32x32x32_bf16 v[64:79], v[172:175], v[24:31], v176
    s_waitcnt lgkmcnt(1)
    ds_read_b128 v[164:167], v81 offset:1536
    v_exp_f32 v37, v37
    v_exp_f32 v38, v38
    v_mfma_f32_32x32x16_bf16 v[16:31], v[152:155], v[144:147], 0
    s_nop 0
    v_exp_f32 v39, v39
    v_exp_f32 v40, v40
    v_exp_f32 v41, v41
    v_smfmac_f32_32x32x32_bf16 v[128:143], v[168:171], v[32:39], v176
    s_nop 0
    v_exp_f32 v42, v42
    v_exp_f32 v43, v43
    v_exp_f32 v44, v44
    v_exp_f32 v45, v45
    v_exp_f32 v46, v46
    v_exp_f32 v47, v47
    v_exp_f32 v16, v16
    v_exp_f32 v17, v17
    v_exp_f32 v18, v18
    v_exp_f32 v19, v19
    v_exp_f32 v20, v20
    v_smfmac_f32_32x32x32_bf16 v[128:143], v[172:175], v[40:47], v176
    ds_read_b128 v[156:159], v80 offset:19456
    v_exp_f32 v21, v21
    v_exp_f32 v22, v22
    v_mfma_f32_32x32x16_bf16 v[32:47], v[152:155], v[148:151], 0
    s_waitcnt lgkmcnt(1)
    v_exp_f32 v23, v23
    v_exp_f32 v24, v24
    v_exp_f32 v25, v25
    v_smfmac_f32_32x32x32_bf16 v[64:79], v[160:163], v[16:23], v176
    ds_read_b128 v[168:171], v81 offset:0
    v_exp_f32 v26, v26
    v_exp_f32 v27, v27
    v_exp_f32 v28, v28
    v_exp_f32 v29, v29
    v_exp_f32 v30, v30
    v_exp_f32 v31, v31
    v_exp_f32 v32, v32
    v_exp_f32 v33, v33
    v_exp_f32 v34, v34
    v_exp_f32 v35, v35
    v_exp_f32 v36, v36
    v_smfmac_f32_32x32x32_bf16 v[64:79], v[164:167], v[24:31], v176
    s_waitcnt lgkmcnt(1)
    ds_read_b128 v[172:175], v81 offset:512
    v_exp_f32 v37, v37
    v_exp_f32 v38, v38
    v_mfma_f32_32x32x16_bf16 v[16:31], v[156:159], v[144:147], 0
    s_nop 0
    v_exp_f32 v39, v39
    v_exp_f32 v40, v40
    v_exp_f32 v41, v41
    v_smfmac_f32_32x32x32_bf16 v[128:143], v[160:163], v[32:39], v176
    s_nop 0
    v_exp_f32 v42, v42
    v_exp_f32 v43, v43
    v_exp_f32 v44, v44
    v_exp_f32 v45, v45
    v_exp_f32 v46, v46
    v_exp_f32 v47, v47
    v_sub_u32 v81, v81, v84
    v_exp_f32 v16, v16
    v_exp_f32 v17, v17
    v_exp_f32 v18, v18
    v_exp_f32 v19, v19
    v_exp_f32 v20, v20
    v_smfmac_f32_32x32x32_bf16 v[128:143], v[164:167], v[40:47], v176
    ds_read_b128 v[152:155], v80 offset:20480
    v_exp_f32 v21, v21
    v_exp_f32 v22, v22
    v_mfma_f32_32x32x16_bf16 v[32:47], v[156:159], v[148:151], 0
    s_waitcnt lgkmcnt(1)
    v_exp_f32 v23, v23
    v_exp_f32 v24, v24
    v_exp_f32 v25, v25
    v_smfmac_f32_32x32x32_bf16 v[64:79], v[168:171], v[16:23], v176
    ds_read_b128 v[160:163], v81 offset:3072
    v_exp_f32 v26, v26
    v_exp_f32 v27, v27
    v_exp_f32 v28, v28
    v_exp_f32 v29, v29
    v_exp_f32 v30, v30
    v_exp_f32 v31, v31
    v_exp_f32 v32, v32
    v_exp_f32 v33, v33
    v_exp_f32 v34, v34
    v_exp_f32 v35, v35
    v_exp_f32 v36, v36
    v_smfmac_f32_32x32x32_bf16 v[64:79], v[172:175], v[24:31], v176
    s_waitcnt lgkmcnt(1)
    ds_read_b128 v[164:167], v81 offset:3584
    v_exp_f32 v37, v37
    v_exp_f32 v38, v38
    v_mfma_f32_32x32x16_bf16 v[16:31], v[152:155], v[144:147], 0
    s_nop 0
    v_exp_f32 v39, v39
    v_exp_f32 v40, v40
    v_exp_f32 v41, v41
    v_smfmac_f32_32x32x32_bf16 v[128:143], v[168:171], v[32:39], v176
    s_nop 0
    v_exp_f32 v42, v42
    v_exp_f32 v43, v43
    v_exp_f32 v44, v44
    v_exp_f32 v45, v45
    v_exp_f32 v46, v46
    v_exp_f32 v47, v47
    v_exp_f32 v16, v16
    v_exp_f32 v17, v17
    v_exp_f32 v18, v18
    v_exp_f32 v19, v19
    v_exp_f32 v20, v20
    v_smfmac_f32_32x32x32_bf16 v[128:143], v[172:175], v[40:47], v176
    ds_read_b128 v[156:159], v80 offset:21504
    v_exp_f32 v21, v21
    v_exp_f32 v22, v22
    v_mfma_f32_32x32x16_bf16 v[32:47], v[152:155], v[148:151], 0
    s_waitcnt lgkmcnt(1)
    v_exp_f32 v23, v23
    v_exp_f32 v24, v24
    v_exp_f32 v25, v25
    v_smfmac_f32_32x32x32_bf16 v[64:79], v[160:163], v[16:23], v176
    ds_read_b128 v[168:171], v81 offset:2048
    v_exp_f32 v26, v26
    v_exp_f32 v27, v27
    v_exp_f32 v28, v28
    v_exp_f32 v29, v29
    v_exp_f32 v30, v30
    v_exp_f32 v31, v31
    v_exp_f32 v32, v32
    v_exp_f32 v33, v33
    v_exp_f32 v34, v34
    v_exp_f32 v35, v35
    v_exp_f32 v36, v36
    v_smfmac_f32_32x32x32_bf16 v[64:79], v[164:167], v[24:31], v176
    s_waitcnt lgkmcnt(1)
    ds_read_b128 v[172:175], v81 offset:2560
    v_exp_f32 v37, v37
    v_exp_f32 v38, v38
    v_mfma_f32_32x32x16_bf16 v[16:31], v[156:159], v[144:147], 0
    s_nop 0
    v_exp_f32 v39, v39
    v_exp_f32 v40, v40
    v_exp_f32 v41, v41
    v_smfmac_f32_32x32x32_bf16 v[128:143], v[160:163], v[32:39], v176
    s_nop 0
    v_exp_f32 v42, v42
    v_exp_f32 v43, v43
    v_exp_f32 v44, v44
    v_exp_f32 v45, v45
    v_exp_f32 v46, v46
    v_exp_f32 v47, v47
    v_exp_f32 v16, v16
    v_exp_f32 v17, v17
    v_exp_f32 v18, v18
    v_exp_f32 v19, v19
    v_exp_f32 v20, v20
    v_smfmac_f32_32x32x32_bf16 v[128:143], v[164:167], v[40:47], v176
    ds_read_b128 v[152:155], v80 offset:22528
    v_exp_f32 v21, v21
    v_exp_f32 v22, v22
    v_mfma_f32_32x32x16_bf16 v[32:47], v[156:159], v[148:151], 0
    s_waitcnt lgkmcnt(1)
    v_exp_f32 v23, v23
    v_exp_f32 v24, v24
    v_exp_f32 v25, v25
    v_smfmac_f32_32x32x32_bf16 v[64:79], v[168:171], v[16:23], v176
    ds_read_b128 v[160:163], v81 offset:1024
    v_exp_f32 v26, v26
    v_exp_f32 v27, v27
    v_exp_f32 v28, v28
    v_exp_f32 v29, v29
    v_exp_f32 v30, v30
    v_exp_f32 v31, v31
    v_exp_f32 v32, v32
    v_exp_f32 v33, v33
    v_exp_f32 v34, v34
    v_exp_f32 v35, v35
    v_exp_f32 v36, v36
    v_smfmac_f32_32x32x32_bf16 v[64:79], v[172:175], v[24:31], v176
    s_waitcnt lgkmcnt(1)
    ds_read_b128 v[164:167], v81 offset:1536
    v_exp_f32 v37, v37
    v_exp_f32 v38, v38
    v_mfma_f32_32x32x16_bf16 v[16:31], v[152:155], v[144:147], 0
    s_nop 0
    v_exp_f32 v39, v39
    v_exp_f32 v40, v40
    v_exp_f32 v41, v41
    v_smfmac_f32_32x32x32_bf16 v[128:143], v[168:171], v[32:39], v176
    s_nop 0
    v_exp_f32 v42, v42
    v_exp_f32 v43, v43
    v_exp_f32 v44, v44
    v_exp_f32 v45, v45
    v_exp_f32 v46, v46
    v_exp_f32 v47, v47
    v_exp_f32 v16, v16
    v_exp_f32 v17, v17
    v_exp_f32 v18, v18
    v_exp_f32 v19, v19
    v_exp_f32 v20, v20
    v_smfmac_f32_32x32x32_bf16 v[128:143], v[172:175], v[40:47], v176
    ds_read_b128 v[156:159], v80 offset:23552
    v_exp_f32 v21, v21
    v_exp_f32 v22, v22
    v_mfma_f32_32x32x16_bf16 v[32:47], v[152:155], v[148:151], 0
    s_waitcnt lgkmcnt(1)
    v_exp_f32 v23, v23
    v_exp_f32 v24, v24
    v_exp_f32 v25, v25
    v_smfmac_f32_32x32x32_bf16 v[64:79], v[160:163], v[16:23], v176
    ds_read_b128 v[168:171], v81 offset:0
    v_exp_f32 v26, v26
    v_exp_f32 v27, v27
    v_exp_f32 v28, v28
    v_exp_f32 v29, v29
    v_exp_f32 v30, v30
    v_exp_f32 v31, v31
    v_exp_f32 v32, v32
    v_exp_f32 v33, v33
    v_exp_f32 v34, v34
    v_exp_f32 v35, v35
    v_exp_f32 v36, v36
    v_smfmac_f32_32x32x32_bf16 v[64:79], v[164:167], v[24:31], v176
    s_waitcnt lgkmcnt(1)
    ds_read_b128 v[172:175], v81 offset:512
    v_exp_f32 v37, v37
    v_exp_f32 v38, v38
    v_mfma_f32_32x32x16_bf16 v[16:31], v[156:159], v[144:147], 0
    s_nop 0
    v_exp_f32 v39, v39
    v_exp_f32 v40, v40
    v_exp_f32 v41, v41
    v_smfmac_f32_32x32x32_bf16 v[128:143], v[160:163], v[32:39], v176
    s_nop 0
    v_exp_f32 v42, v42
    v_exp_f32 v43, v43
    v_exp_f32 v44, v44
    v_exp_f32 v45, v45
    v_exp_f32 v46, v46
    v_exp_f32 v47, v47
    v_sub_u32 v81, v81, v84
    v_exp_f32 v16, v16
    v_exp_f32 v17, v17
    v_exp_f32 v18, v18
    v_exp_f32 v19, v19
    v_exp_f32 v20, v20
    v_smfmac_f32_32x32x32_bf16 v[128:143], v[164:167], v[40:47], v176
    ds_read_b128 v[152:155], v80 offset:24576
    v_exp_f32 v21, v21
    v_exp_f32 v22, v22
    v_mfma_f32_32x32x16_bf16 v[32:47], v[156:159], v[148:151], 0
    s_waitcnt lgkmcnt(1)
    v_exp_f32 v23, v23
    v_exp_f32 v24, v24
    v_exp_f32 v25, v25
    v_smfmac_f32_32x32x32_bf16 v[64:79], v[168:171], v[16:23], v176
    ds_read_b128 v[160:163], v81 offset:3072
    v_exp_f32 v26, v26
    v_exp_f32 v27, v27
    v_exp_f32 v28, v28
    v_exp_f32 v29, v29
    v_exp_f32 v30, v30
    v_exp_f32 v31, v31
    v_exp_f32 v32, v32
    v_exp_f32 v33, v33
    v_exp_f32 v34, v34
    v_exp_f32 v35, v35
    v_exp_f32 v36, v36
    v_smfmac_f32_32x32x32_bf16 v[64:79], v[172:175], v[24:31], v176
    s_waitcnt lgkmcnt(1)
    ds_read_b128 v[164:167], v81 offset:3584
    v_exp_f32 v37, v37
    v_exp_f32 v38, v38
    v_mfma_f32_32x32x16_bf16 v[16:31], v[152:155], v[144:147], 0
    s_nop 0
    v_exp_f32 v39, v39
    v_exp_f32 v40, v40
    v_exp_f32 v41, v41
    v_smfmac_f32_32x32x32_bf16 v[128:143], v[168:171], v[32:39], v176
    s_nop 0
    v_exp_f32 v42, v42
    v_exp_f32 v43, v43
    v_exp_f32 v44, v44
    v_exp_f32 v45, v45
    v_exp_f32 v46, v46
    v_exp_f32 v47, v47
    v_exp_f32 v16, v16
    v_exp_f32 v17, v17
    v_exp_f32 v18, v18
    v_exp_f32 v19, v19
    v_exp_f32 v20, v20
    v_smfmac_f32_32x32x32_bf16 v[128:143], v[172:175], v[40:47], v176
    ds_read_b128 v[156:159], v80 offset:25600
    v_exp_f32 v21, v21
    v_exp_f32 v22, v22
    v_mfma_f32_32x32x16_bf16 v[32:47], v[152:155], v[148:151], 0
    s_waitcnt lgkmcnt(1)
    v_exp_f32 v23, v23
    v_exp_f32 v24, v24
    v_exp_f32 v25, v25
    v_smfmac_f32_32x32x32_bf16 v[64:79], v[160:163], v[16:23], v176
    ds_read_b128 v[168:171], v81 offset:2048
    v_exp_f32 v26, v26
    v_exp_f32 v27, v27
    v_exp_f32 v28, v28
    v_exp_f32 v29, v29
    v_exp_f32 v30, v30
    v_exp_f32 v31, v31
    v_exp_f32 v32, v32
    v_exp_f32 v33, v33
    v_exp_f32 v34, v34
    v_exp_f32 v35, v35
    v_exp_f32 v36, v36
    v_smfmac_f32_32x32x32_bf16 v[64:79], v[164:167], v[24:31], v176
    s_waitcnt lgkmcnt(1)
    ds_read_b128 v[172:175], v81 offset:2560
    v_exp_f32 v37, v37
    v_exp_f32 v38, v38
    v_mfma_f32_32x32x16_bf16 v[16:31], v[156:159], v[144:147], 0
    s_nop 0
    v_exp_f32 v39, v39
    v_exp_f32 v40, v40
    v_exp_f32 v41, v41
    v_smfmac_f32_32x32x32_bf16 v[128:143], v[160:163], v[32:39], v176
    s_nop 0
    v_exp_f32 v42, v42
    v_exp_f32 v43, v43
    v_exp_f32 v44, v44
    v_exp_f32 v45, v45
    v_exp_f32 v46, v46
    v_exp_f32 v47, v47
    v_exp_f32 v16, v16
    v_exp_f32 v17, v17
    v_exp_f32 v18, v18
    v_exp_f32 v19, v19
    v_exp_f32 v20, v20
    v_smfmac_f32_32x32x32_bf16 v[128:143], v[164:167], v[40:47], v176
    ds_read_b128 v[152:155], v80 offset:26624
    v_exp_f32 v21, v21
    v_exp_f32 v22, v22
    v_mfma_f32_32x32x16_bf16 v[32:47], v[156:159], v[148:151], 0
    s_waitcnt lgkmcnt(1)
    v_exp_f32 v23, v23
    v_exp_f32 v24, v24
    v_exp_f32 v25, v25
    v_smfmac_f32_32x32x32_bf16 v[64:79], v[168:171], v[16:23], v176
    ds_read_b128 v[160:163], v81 offset:1024
    v_exp_f32 v26, v26
    v_exp_f32 v27, v27
    v_exp_f32 v28, v28
    v_exp_f32 v29, v29
    v_exp_f32 v30, v30
    v_exp_f32 v31, v31
    v_exp_f32 v32, v32
    v_exp_f32 v33, v33
    v_exp_f32 v34, v34
    v_exp_f32 v35, v35
    v_exp_f32 v36, v36
    v_smfmac_f32_32x32x32_bf16 v[64:79], v[172:175], v[24:31], v176
    s_waitcnt lgkmcnt(1)
    ds_read_b128 v[164:167], v81 offset:1536
    v_exp_f32 v37, v37
    v_exp_f32 v38, v38
    v_mfma_f32_32x32x16_bf16 v[16:31], v[152:155], v[144:147], 0
    s_nop 0
    v_exp_f32 v39, v39
    v_exp_f32 v40, v40
    v_exp_f32 v41, v41
    v_smfmac_f32_32x32x32_bf16 v[128:143], v[168:171], v[32:39], v176
    s_nop 0
    v_exp_f32 v42, v42
    v_exp_f32 v43, v43
    v_exp_f32 v44, v44
    v_exp_f32 v45, v45
    v_exp_f32 v46, v46
    v_exp_f32 v47, v47
    v_exp_f32 v16, v16
    v_exp_f32 v17, v17
    v_exp_f32 v18, v18
    v_exp_f32 v19, v19
    v_exp_f32 v20, v20
    v_smfmac_f32_32x32x32_bf16 v[128:143], v[172:175], v[40:47], v176
    ds_read_b128 v[156:159], v80 offset:27648
    v_exp_f32 v21, v21
    v_exp_f32 v22, v22
    v_mfma_f32_32x32x16_bf16 v[32:47], v[152:155], v[148:151], 0
    s_waitcnt lgkmcnt(1)
    v_exp_f32 v23, v23
    v_exp_f32 v24, v24
    v_exp_f32 v25, v25
    v_smfmac_f32_32x32x32_bf16 v[64:79], v[160:163], v[16:23], v176
    ds_read_b128 v[168:171], v81 offset:0
    v_exp_f32 v26, v26
    v_exp_f32 v27, v27
    v_exp_f32 v28, v28
    v_exp_f32 v29, v29
    v_exp_f32 v30, v30
    v_exp_f32 v31, v31
    v_exp_f32 v32, v32
    v_exp_f32 v33, v33
    v_exp_f32 v34, v34
    v_exp_f32 v35, v35
    v_exp_f32 v36, v36
    v_smfmac_f32_32x32x32_bf16 v[64:79], v[164:167], v[24:31], v176
    s_waitcnt lgkmcnt(1)
    ds_read_b128 v[172:175], v81 offset:512
    v_exp_f32 v37, v37
    v_exp_f32 v38, v38
    v_mfma_f32_32x32x16_bf16 v[16:31], v[156:159], v[144:147], 0
    s_nop 0
    v_exp_f32 v39, v39
    v_exp_f32 v40, v40
    v_exp_f32 v41, v41
    v_smfmac_f32_32x32x32_bf16 v[128:143], v[160:163], v[32:39], v176
    s_nop 0
    v_exp_f32 v42, v42
    v_exp_f32 v43, v43
    v_exp_f32 v44, v44
    v_exp_f32 v45, v45
    v_exp_f32 v46, v46
    v_exp_f32 v47, v47
    v_sub_u32 v81, v81, v84
    v_exp_f32 v16, v16
    v_exp_f32 v17, v17
    v_exp_f32 v18, v18
    v_exp_f32 v19, v19
    v_exp_f32 v20, v20
    v_smfmac_f32_32x32x32_bf16 v[128:143], v[164:167], v[40:47], v176
    ds_read_b128 v[152:155], v80 offset:28672
    v_exp_f32 v21, v21
    v_exp_f32 v22, v22
    v_mfma_f32_32x32x16_bf16 v[32:47], v[156:159], v[148:151], 0
    s_waitcnt lgkmcnt(1)
    v_exp_f32 v23, v23
    v_exp_f32 v24, v24
    v_exp_f32 v25, v25
    v_smfmac_f32_32x32x32_bf16 v[64:79], v[168:171], v[16:23], v176
    ds_read_b128 v[160:163], v81 offset:3072
    v_exp_f32 v26, v26
    v_exp_f32 v27, v27
    v_exp_f32 v28, v28
    v_exp_f32 v29, v29
    v_exp_f32 v30, v30
    v_exp_f32 v31, v31
    v_exp_f32 v32, v32
    v_exp_f32 v33, v33
    v_exp_f32 v34, v34
    v_exp_f32 v35, v35
    v_exp_f32 v36, v36
    v_smfmac_f32_32x32x32_bf16 v[64:79], v[172:175], v[24:31], v176
    s_waitcnt lgkmcnt(1)
    ds_read_b128 v[164:167], v81 offset:3584
    v_exp_f32 v37, v37
    v_exp_f32 v38, v38
    v_mfma_f32_32x32x16_bf16 v[16:31], v[152:155], v[144:147], 0
    s_nop 0
    v_exp_f32 v39, v39
    v_exp_f32 v40, v40
    v_exp_f32 v41, v41
    v_smfmac_f32_32x32x32_bf16 v[128:143], v[168:171], v[32:39], v176
    s_nop 0
    v_exp_f32 v42, v42
    v_exp_f32 v43, v43
    v_exp_f32 v44, v44
    v_exp_f32 v45, v45
    v_exp_f32 v46, v46
    v_exp_f32 v47, v47
    v_exp_f32 v16, v16
    v_exp_f32 v17, v17
    v_exp_f32 v18, v18
    v_exp_f32 v19, v19
    v_exp_f32 v20, v20
    v_smfmac_f32_32x32x32_bf16 v[128:143], v[172:175], v[40:47], v176
    ds_read_b128 v[156:159], v80 offset:29696
    v_exp_f32 v21, v21
    v_exp_f32 v22, v22
    v_mfma_f32_32x32x16_bf16 v[32:47], v[152:155], v[148:151], 0
    s_waitcnt lgkmcnt(1)
    v_exp_f32 v23, v23
    v_exp_f32 v24, v24
    v_exp_f32 v25, v25
    v_smfmac_f32_32x32x32_bf16 v[64:79], v[160:163], v[16:23], v176
    ds_read_b128 v[168:171], v81 offset:2048
    v_exp_f32 v26, v26
    v_exp_f32 v27, v27
    v_exp_f32 v28, v28
    v_exp_f32 v29, v29
    v_exp_f32 v30, v30
    v_exp_f32 v31, v31
    v_exp_f32 v32, v32
    v_exp_f32 v33, v33
    v_exp_f32 v34, v34
    v_exp_f32 v35, v35
    v_exp_f32 v36, v36
    v_smfmac_f32_32x32x32_bf16 v[64:79], v[164:167], v[24:31], v176
    s_waitcnt lgkmcnt(1)
    ds_read_b128 v[172:175], v81 offset:2560
    v_exp_f32 v37, v37
    v_exp_f32 v38, v38
    v_mfma_f32_32x32x16_bf16 v[16:31], v[156:159], v[144:147], 0
    s_nop 0
    v_exp_f32 v39, v39
    v_exp_f32 v40, v40
    v_exp_f32 v41, v41
    v_smfmac_f32_32x32x32_bf16 v[128:143], v[160:163], v[32:39], v176
    s_nop 0
    v_exp_f32 v42, v42
    v_exp_f32 v43, v43
    v_exp_f32 v44, v44
    v_exp_f32 v45, v45
    v_exp_f32 v46, v46
    v_exp_f32 v47, v47
    v_exp_f32 v16, v16
    v_exp_f32 v17, v17
    v_exp_f32 v18, v18
    v_exp_f32 v19, v19
    v_exp_f32 v20, v20
    v_smfmac_f32_32x32x32_bf16 v[128:143], v[164:167], v[40:47], v176
    ds_read_b128 v[152:155], v80 offset:30720
    v_exp_f32 v21, v21
    v_exp_f32 v22, v22
    v_mfma_f32_32x32x16_bf16 v[32:47], v[156:159], v[148:151], 0
    s_waitcnt lgkmcnt(1)
    v_exp_f32 v23, v23
    v_exp_f32 v24, v24
    v_exp_f32 v25, v25
    v_smfmac_f32_32x32x32_bf16 v[64:79], v[168:171], v[16:23], v176
    ds_read_b128 v[160:163], v81 offset:1024
    v_exp_f32 v26, v26
    v_exp_f32 v27, v27
    v_exp_f32 v28, v28
    v_exp_f32 v29, v29
    v_exp_f32 v30, v30
    v_exp_f32 v31, v31
    v_exp_f32 v32, v32
    v_exp_f32 v33, v33
    v_exp_f32 v34, v34
    v_exp_f32 v35, v35
    v_exp_f32 v36, v36
    v_smfmac_f32_32x32x32_bf16 v[64:79], v[172:175], v[24:31], v176
    s_waitcnt lgkmcnt(1)
    ds_read_b128 v[164:167], v81 offset:1536
    v_exp_f32 v37, v37
    v_exp_f32 v38, v38
    v_mfma_f32_32x32x16_bf16 v[16:31], v[152:155], v[144:147], 0
    s_nop 0
    v_exp_f32 v39, v39
    v_exp_f32 v40, v40
    v_exp_f32 v41, v41
    v_smfmac_f32_32x32x32_bf16 v[128:143], v[168:171], v[32:39], v176
    s_nop 0
    v_exp_f32 v42, v42
    v_exp_f32 v43, v43
    v_exp_f32 v44, v44
    v_exp_f32 v45, v45
    v_exp_f32 v46, v46
    v_exp_f32 v47, v47
    v_exp_f32 v16, v16
    v_exp_f32 v17, v17
    v_exp_f32 v18, v18
    v_exp_f32 v19, v19
    v_exp_f32 v20, v20
    v_smfmac_f32_32x32x32_bf16 v[128:143], v[172:175], v[40:47], v176
    ds_read_b128 v[156:159], v80 offset:31744
    v_exp_f32 v21, v21
    v_exp_f32 v22, v22
    v_mfma_f32_32x32x16_bf16 v[32:47], v[152:155], v[148:151], 0
    s_waitcnt lgkmcnt(1)
    v_exp_f32 v23, v23
    v_exp_f32 v24, v24
    v_exp_f32 v25, v25
    v_smfmac_f32_32x32x32_bf16 v[64:79], v[160:163], v[16:23], v176
    ds_read_b128 v[168:171], v81 offset:0
    v_exp_f32 v26, v26
    v_exp_f32 v27, v27
    v_exp_f32 v28, v28
    v_exp_f32 v29, v29
    v_exp_f32 v30, v30
    v_exp_f32 v31, v31
    v_exp_f32 v32, v32
    v_exp_f32 v33, v33
    v_exp_f32 v34, v34
    v_exp_f32 v35, v35
    v_exp_f32 v36, v36
    v_smfmac_f32_32x32x32_bf16 v[64:79], v[164:167], v[24:31], v176
    s_waitcnt lgkmcnt(1)
    ds_read_b128 v[172:175], v81 offset:512
    v_exp_f32 v37, v37
    v_exp_f32 v38, v38
    v_mfma_f32_32x32x16_bf16 v[16:31], v[156:159], v[144:147], 0
    s_nop 0
    v_exp_f32 v39, v39
    v_exp_f32 v40, v40
    v_exp_f32 v41, v41
    v_smfmac_f32_32x32x32_bf16 v[128:143], v[160:163], v[32:39], v176
    s_nop 0
    v_exp_f32 v42, v42
    v_exp_f32 v43, v43
    v_exp_f32 v44, v44
    v_exp_f32 v45, v45
    v_exp_f32 v46, v46
    v_exp_f32 v47, v47
    v_sub_u32 v81, v81, v84
    v_exp_f32 v16, v16
    v_exp_f32 v17, v17
    v_exp_f32 v18, v18
    v_exp_f32 v19, v19
    v_exp_f32 v20, v20
    v_smfmac_f32_32x32x32_bf16 v[128:143], v[164:167], v[40:47], v176
    ds_read_b128 v[152:155], v80 offset:32768
    v_exp_f32 v21, v21
    v_exp_f32 v22, v22
    v_mfma_f32_32x32x16_bf16 v[32:47], v[156:159], v[148:151], 0
    s_waitcnt lgkmcnt(1)
    v_exp_f32 v23, v23
    v_exp_f32 v24, v24
    v_exp_f32 v25, v25
    v_smfmac_f32_32x32x32_bf16 v[64:79], v[168:171], v[16:23], v176
    ds_read_b128 v[160:163], v81 offset:3072
    v_exp_f32 v26, v26
    v_exp_f32 v27, v27
    v_exp_f32 v28, v28
    v_exp_f32 v29, v29
    v_exp_f32 v30, v30
    v_exp_f32 v31, v31
    v_exp_f32 v32, v32
    v_exp_f32 v33, v33
    v_exp_f32 v34, v34
    v_exp_f32 v35, v35
    v_exp_f32 v36, v36
    v_smfmac_f32_32x32x32_bf16 v[64:79], v[172:175], v[24:31], v176
    s_waitcnt lgkmcnt(1)
    ds_read_b128 v[164:167], v81 offset:3584
    v_exp_f32 v37, v37
    v_exp_f32 v38, v38
    v_mfma_f32_32x32x16_bf16 v[16:31], v[152:155], v[144:147], 0
    s_nop 0
    v_exp_f32 v39, v39
    v_exp_f32 v40, v40
    v_exp_f32 v41, v41
    v_smfmac_f32_32x32x32_bf16 v[128:143], v[168:171], v[32:39], v176
    ds_write_b32 v177, v178
    v_exp_f32 v42, v42
    v_exp_f32 v43, v43
    v_exp_f32 v44, v44
    v_exp_f32 v45, v45
    v_exp_f32 v46, v46
    v_exp_f32 v47, v47
    v_exp_f32 v16, v16
    v_exp_f32 v17, v17
    v_exp_f32 v18, v18
    v_exp_f32 v19, v19
    v_exp_f32 v20, v20
    v_smfmac_f32_32x32x32_bf16 v[128:143], v[172:175], v[40:47], v176
    ds_read_b128 v[156:159], v80 offset:33792
    v_exp_f32 v21, v21
    v_exp_f32 v22, v22
    v_mfma_f32_32x32x16_bf16 v[32:47], v[152:155], v[148:151], 0
    s_waitcnt lgkmcnt(1)
    v_exp_f32 v23, v23
    v_exp_f32 v24, v24
    v_exp_f32 v25, v25
    v_smfmac_f32_32x32x32_bf16 v[64:79], v[160:163], v[16:23], v176
    ds_read_b128 v[168:171], v81 offset:2048
    v_exp_f32 v26, v26
    v_exp_f32 v27, v27
    v_exp_f32 v28, v28
    v_exp_f32 v29, v29
    v_exp_f32 v30, v30
    v_exp_f32 v31, v31
    v_exp_f32 v32, v32
    v_exp_f32 v33, v33
    v_exp_f32 v34, v34
    v_exp_f32 v35, v35
    v_exp_f32 v36, v36
    v_smfmac_f32_32x32x32_bf16 v[64:79], v[164:167], v[24:31], v176
    s_waitcnt lgkmcnt(1)
    ds_read_b128 v[172:175], v81 offset:2560
    v_exp_f32 v37, v37
    v_exp_f32 v38, v38
    v_mfma_f32_32x32x16_bf16 v[16:31], v[156:159], v[144:147], 0
    s_nop 0
    v_exp_f32 v39, v39
    v_exp_f32 v40, v40
    v_exp_f32 v41, v41
    v_smfmac_f32_32x32x32_bf16 v[128:143], v[160:163], v[32:39], v176
    s_nop 0
    v_exp_f32 v42, v42
    v_exp_f32 v43, v43
    v_exp_f32 v44, v44
    v_exp_f32 v45, v45
    v_exp_f32 v46, v46
    v_exp_f32 v47, v47
    v_exp_f32 v16, v16
    v_exp_f32 v17, v17
    v_exp_f32 v18, v18
    v_exp_f32 v19, v19
    v_exp_f32 v20, v20
    v_smfmac_f32_32x32x32_bf16 v[128:143], v[164:167], v[40:47], v176
    ds_read_b128 v[152:155], v80 offset:34816
    v_exp_f32 v21, v21
    v_exp_f32 v22, v22
    v_mfma_f32_32x32x16_bf16 v[32:47], v[156:159], v[148:151], 0
    s_waitcnt lgkmcnt(1)
    v_exp_f32 v23, v23
    v_exp_f32 v24, v24
    v_exp_f32 v25, v25
    v_smfmac_f32_32x32x32_bf16 v[64:79], v[168:171], v[16:23], v176
    ds_read_b128 v[160:163], v81 offset:1024
    v_exp_f32 v26, v26
    v_exp_f32 v27, v27
    v_exp_f32 v28, v28
    v_exp_f32 v29, v29
    v_exp_f32 v30, v30
    v_exp_f32 v31, v31
    v_exp_f32 v32, v32
    v_exp_f32 v33, v33
    v_exp_f32 v34, v34
    v_exp_f32 v35, v35
    v_exp_f32 v36, v36
    v_smfmac_f32_32x32x32_bf16 v[64:79], v[172:175], v[24:31], v176
    s_waitcnt lgkmcnt(1)
    ds_read_b128 v[164:167], v81 offset:1536
    v_exp_f32 v37, v37
    v_exp_f32 v38, v38
    v_mfma_f32_32x32x16_bf16 v[16:31], v[152:155], v[144:147], 0
    s_nop 0
    v_exp_f32 v39, v39
    v_exp_f32 v40, v40
    v_exp_f32 v41, v41
    v_smfmac_f32_32x32x32_bf16 v[128:143], v[168:171], v[32:39], v176
    s_nop 0
    v_exp_f32 v42, v42
    v_exp_f32 v43, v43
    v_exp_f32 v44, v44
    v_exp_f32 v45, v45
    v_exp_f32 v46, v46
    v_exp_f32 v47, v47
    v_exp_f32 v16, v16
    v_exp_f32 v17, v17
    v_exp_f32 v18, v18
    v_exp_f32 v19, v19
    v_exp_f32 v20, v20
    v_smfmac_f32_32x32x32_bf16 v[128:143], v[172:175], v[40:47], v176
    ds_read_b128 v[156:159], v80 offset:35840
    v_exp_f32 v21, v21
    v_exp_f32 v22, v22
    v_mfma_f32_32x32x16_bf16 v[32:47], v[152:155], v[148:151], 0
    s_waitcnt lgkmcnt(1)
    v_exp_f32 v23, v23
    v_exp_f32 v24, v24
    v_exp_f32 v25, v25
    v_smfmac_f32_32x32x32_bf16 v[64:79], v[160:163], v[16:23], v176
    ds_read_b128 v[168:171], v81 offset:0
    v_exp_f32 v26, v26
    v_exp_f32 v27, v27
    v_exp_f32 v28, v28
    v_exp_f32 v29, v29
    v_exp_f32 v30, v30
    v_exp_f32 v31, v31
    v_exp_f32 v32, v32
    v_exp_f32 v33, v33
    v_exp_f32 v34, v34
    v_exp_f32 v35, v35
    v_exp_f32 v36, v36
    v_smfmac_f32_32x32x32_bf16 v[64:79], v[164:167], v[24:31], v176
    s_waitcnt lgkmcnt(1)
    ds_read_b128 v[172:175], v81 offset:512
    v_exp_f32 v37, v37
    v_exp_f32 v38, v38
    v_mfma_f32_32x32x16_bf16 v[16:31], v[156:159], v[144:147], 0
    s_nop 0
    v_exp_f32 v39, v39
    v_exp_f32 v40, v40
    v_exp_f32 v41, v41
    v_smfmac_f32_32x32x32_bf16 v[128:143], v[160:163], v[32:39], v176
    s_nop 0
    v_exp_f32 v42, v42
    v_exp_f32 v43, v43
    v_exp_f32 v44, v44
    v_exp_f32 v45, v45
    v_exp_f32 v46, v46
    v_exp_f32 v47, v47
    v_sub_u32 v81, v81, v84
    v_exp_f32 v16, v16
    v_exp_f32 v17, v17
    v_exp_f32 v18, v18
    v_exp_f32 v19, v19
    v_exp_f32 v20, v20
    v_smfmac_f32_32x32x32_bf16 v[128:143], v[164:167], v[40:47], v176
    ds_read_b128 v[152:155], v80 offset:36864
    v_exp_f32 v21, v21
    v_exp_f32 v22, v22
    v_mfma_f32_32x32x16_bf16 v[32:47], v[156:159], v[148:151], 0
    s_waitcnt lgkmcnt(1)
    v_exp_f32 v23, v23
    v_exp_f32 v24, v24
    v_exp_f32 v25, v25
    v_smfmac_f32_32x32x32_bf16 v[64:79], v[168:171], v[16:23], v176
    ds_read_b128 v[160:163], v81 offset:3072
    v_exp_f32 v26, v26
    v_exp_f32 v27, v27
    v_exp_f32 v28, v28
    v_exp_f32 v29, v29
    v_exp_f32 v30, v30
    v_exp_f32 v31, v31
    v_exp_f32 v32, v32
    v_exp_f32 v33, v33
    v_exp_f32 v34, v34
    v_exp_f32 v35, v35
    v_exp_f32 v36, v36
    v_smfmac_f32_32x32x32_bf16 v[64:79], v[172:175], v[24:31], v176
    s_waitcnt lgkmcnt(1)
    ds_read_b128 v[164:167], v81 offset:3584
    v_exp_f32 v37, v37
    v_exp_f32 v38, v38
    v_mfma_f32_32x32x16_bf16 v[16:31], v[152:155], v[144:147], 0
    s_nop 0
    v_exp_f32 v39, v39
    v_exp_f32 v40, v40
    v_exp_f32 v41, v41
    v_smfmac_f32_32x32x32_bf16 v[128:143], v[168:171], v[32:39], v176
    s_nop 0
    v_exp_f32 v42, v42
    v_exp_f32 v43, v43
    v_exp_f32 v44, v44
    v_exp_f32 v45, v45
    v_exp_f32 v46, v46
    v_exp_f32 v47, v47
    v_exp_f32 v16, v16
    v_exp_f32 v17, v17
    v_exp_f32 v18, v18
    v_exp_f32 v19, v19
    v_exp_f32 v20, v20
    v_smfmac_f32_32x32x32_bf16 v[128:143], v[172:175], v[40:47], v176
    ds_read_b128 v[156:159], v80 offset:37888
    v_exp_f32 v21, v21
    v_exp_f32 v22, v22
    v_mfma_f32_32x32x16_bf16 v[32:47], v[152:155], v[148:151], 0
    s_waitcnt lgkmcnt(1)
    v_exp_f32 v23, v23
    v_exp_f32 v24, v24
    v_exp_f32 v25, v25
    v_smfmac_f32_32x32x32_bf16 v[64:79], v[160:163], v[16:23], v176
    ds_read_b128 v[168:171], v81 offset:2048
    v_exp_f32 v26, v26
    v_exp_f32 v27, v27
    v_exp_f32 v28, v28
    v_exp_f32 v29, v29
    v_exp_f32 v30, v30
    v_exp_f32 v31, v31
    v_exp_f32 v32, v32
    v_exp_f32 v33, v33
    v_exp_f32 v34, v34
    v_exp_f32 v35, v35
    v_exp_f32 v36, v36
    v_smfmac_f32_32x32x32_bf16 v[64:79], v[164:167], v[24:31], v176
    s_waitcnt lgkmcnt(1)
    ds_read_b128 v[172:175], v81 offset:2560
    v_exp_f32 v37, v37
    v_exp_f32 v38, v38
    v_mfma_f32_32x32x16_bf16 v[16:31], v[156:159], v[144:147], 0
    s_nop 0
    v_exp_f32 v39, v39
    v_exp_f32 v40, v40
    v_exp_f32 v41, v41
    v_smfmac_f32_32x32x32_bf16 v[128:143], v[160:163], v[32:39], v176
    s_nop 0
    v_exp_f32 v42, v42
    v_exp_f32 v43, v43
    v_exp_f32 v44, v44
    v_exp_f32 v45, v45
    v_exp_f32 v46, v46
    v_exp_f32 v47, v47
    v_exp_f32 v16, v16
    v_exp_f32 v17, v17
    v_exp_f32 v18, v18
    v_exp_f32 v19, v19
    v_exp_f32 v20, v20
    v_smfmac_f32_32x32x32_bf16 v[128:143], v[164:167], v[40:47], v176
    ds_read_b128 v[152:155], v80 offset:38912
    v_exp_f32 v21, v21
    v_exp_f32 v22, v22
    v_mfma_f32_32x32x16_bf16 v[32:47], v[156:159], v[148:151], 0
    s_waitcnt lgkmcnt(1)
    v_exp_f32 v23, v23
    v_exp_f32 v24, v24
    v_exp_f32 v25, v25
    v_smfmac_f32_32x32x32_bf16 v[64:79], v[168:171], v[16:23], v176
    ds_read_b128 v[160:163], v81 offset:1024
    v_exp_f32 v26, v26
    v_exp_f32 v27, v27
    v_exp_f32 v28, v28
    v_exp_f32 v29, v29
    v_exp_f32 v30, v30
    v_exp_f32 v31, v31
    v_exp_f32 v32, v32
    v_exp_f32 v33, v33
    v_exp_f32 v34, v34
    v_exp_f32 v35, v35
    v_exp_f32 v36, v36
    v_smfmac_f32_32x32x32_bf16 v[64:79], v[172:175], v[24:31], v176
    s_waitcnt lgkmcnt(1)
    ds_read_b128 v[164:167], v81 offset:1536
    v_exp_f32 v37, v37
    v_exp_f32 v38, v38
    v_mfma_f32_32x32x16_bf16 v[16:31], v[152:155], v[144:147], 0
    s_nop 0
    v_exp_f32 v39, v39
    v_exp_f32 v40, v40
    v_exp_f32 v41, v41
    v_smfmac_f32_32x32x32_bf16 v[128:143], v[168:171], v[32:39], v176
    s_nop 0
    v_exp_f32 v42, v42
    v_exp_f32 v43, v43
    v_exp_f32 v44, v44
    v_exp_f32 v45, v45
    v_exp_f32 v46, v46
    v_exp_f32 v47, v47
    v_exp_f32 v16, v16
    v_exp_f32 v17, v17
    v_exp_f32 v18, v18
    v_exp_f32 v19, v19
    v_exp_f32 v20, v20
    v_smfmac_f32_32x32x32_bf16 v[128:143], v[172:175], v[40:47], v176
    ds_read_b128 v[156:159], v80 offset:39936
    v_exp_f32 v21, v21
    v_exp_f32 v22, v22
    v_mfma_f32_32x32x16_bf16 v[32:47], v[152:155], v[148:151], 0
    s_waitcnt lgkmcnt(1)
    v_exp_f32 v23, v23
    v_exp_f32 v24, v24
    v_exp_f32 v25, v25
    v_smfmac_f32_32x32x32_bf16 v[64:79], v[160:163], v[16:23], v176
    ds_read_b128 v[168:171], v81 offset:0
    v_exp_f32 v26, v26
    v_exp_f32 v27, v27
    v_exp_f32 v28, v28
    v_exp_f32 v29, v29
    v_exp_f32 v30, v30
    v_exp_f32 v31, v31
    v_exp_f32 v32, v32
    v_exp_f32 v33, v33
    v_exp_f32 v34, v34
    v_exp_f32 v35, v35
    v_exp_f32 v36, v36
    v_smfmac_f32_32x32x32_bf16 v[64:79], v[164:167], v[24:31], v176
    s_waitcnt lgkmcnt(1)
    ds_read_b128 v[172:175], v81 offset:512
    v_exp_f32 v37, v37
    v_exp_f32 v38, v38
    v_mfma_f32_32x32x16_bf16 v[16:31], v[156:159], v[144:147], 0
    s_nop 0
    v_exp_f32 v39, v39
    v_exp_f32 v40, v40
    v_exp_f32 v41, v41
    v_smfmac_f32_32x32x32_bf16 v[128:143], v[160:163], v[32:39], v176
    s_nop 0
    v_exp_f32 v42, v42
    v_exp_f32 v43, v43
    v_exp_f32 v44, v44
    v_exp_f32 v45, v45
    v_exp_f32 v46, v46
    v_exp_f32 v47, v47
    v_sub_u32 v81, v81, v84
    v_exp_f32 v16, v16
    v_exp_f32 v17, v17
    v_exp_f32 v18, v18
    v_exp_f32 v19, v19
    v_exp_f32 v20, v20
    v_smfmac_f32_32x32x32_bf16 v[128:143], v[164:167], v[40:47], v176
    ds_read_b128 v[152:155], v80 offset:40960
    v_exp_f32 v21, v21
    v_exp_f32 v22, v22
    v_mfma_f32_32x32x16_bf16 v[32:47], v[156:159], v[148:151], 0
    s_waitcnt lgkmcnt(1)
    v_exp_f32 v23, v23
    v_exp_f32 v24, v24
    v_exp_f32 v25, v25
    v_smfmac_f32_32x32x32_bf16 v[64:79], v[168:171], v[16:23], v176
    ds_read_b128 v[160:163], v81 offset:3072
    v_exp_f32 v26, v26
    v_exp_f32 v27, v27
    v_exp_f32 v28, v28
    v_exp_f32 v29, v29
    v_exp_f32 v30, v30
    v_exp_f32 v31, v31
    v_exp_f32 v32, v32
    v_exp_f32 v33, v33
    v_exp_f32 v34, v34
    v_exp_f32 v35, v35
    v_exp_f32 v36, v36
    v_smfmac_f32_32x32x32_bf16 v[64:79], v[172:175], v[24:31], v176
    s_waitcnt lgkmcnt(1)
    ds_read_b128 v[164:167], v81 offset:3584
    v_exp_f32 v37, v37
    v_exp_f32 v38, v38
    v_mfma_f32_32x32x16_bf16 v[16:31], v[152:155], v[144:147], 0
    s_nop 0
    v_exp_f32 v39, v39
    v_exp_f32 v40, v40
    v_exp_f32 v41, v41
    v_smfmac_f32_32x32x32_bf16 v[128:143], v[168:171], v[32:39], v176
    s_nop 0
    v_exp_f32 v42, v42
    v_exp_f32 v43, v43
    v_exp_f32 v44, v44
    v_exp_f32 v45, v45
    v_exp_f32 v46, v46
    v_exp_f32 v47, v47
    v_exp_f32 v16, v16
    v_exp_f32 v17, v17
    v_exp_f32 v18, v18
    v_exp_f32 v19, v19
    v_exp_f32 v20, v20
    v_smfmac_f32_32x32x32_bf16 v[128:143], v[172:175], v[40:47], v176
    ds_read_b128 v[156:159], v80 offset:41984
    v_exp_f32 v21, v21
    v_exp_f32 v22, v22
    v_mfma_f32_32x32x16_bf16 v[32:47], v[152:155], v[148:151], 0
    s_waitcnt lgkmcnt(1)
    v_exp_f32 v23, v23
    v_exp_f32 v24, v24
    v_exp_f32 v25, v25
    v_smfmac_f32_32x32x32_bf16 v[64:79], v[160:163], v[16:23], v176
    ds_read_b128 v[168:171], v81 offset:2048
    v_exp_f32 v26, v26
    v_exp_f32 v27, v27
    v_exp_f32 v28, v28
    v_exp_f32 v29, v29
    v_exp_f32 v30, v30
    v_exp_f32 v31, v31
    v_exp_f32 v32, v32
    v_exp_f32 v33, v33
    v_exp_f32 v34, v34
    v_exp_f32 v35, v35
    v_exp_f32 v36, v36
    v_smfmac_f32_32x32x32_bf16 v[64:79], v[164:167], v[24:31], v176
    s_waitcnt lgkmcnt(1)
    ds_read_b128 v[172:175], v81 offset:2560
    v_exp_f32 v37, v37
    v_exp_f32 v38, v38
    v_mfma_f32_32x32x16_bf16 v[16:31], v[156:159], v[144:147], 0
    s_nop 0
    v_exp_f32 v39, v39
    v_exp_f32 v40, v40
    v_exp_f32 v41, v41
    v_smfmac_f32_32x32x32_bf16 v[128:143], v[160:163], v[32:39], v176
    s_nop 0
    v_exp_f32 v42, v42
    v_exp_f32 v43, v43
    v_exp_f32 v44, v44
    v_exp_f32 v45, v45
    v_exp_f32 v46, v46
    v_exp_f32 v47, v47
    v_exp_f32 v16, v16
    v_exp_f32 v17, v17
    v_exp_f32 v18, v18
    v_exp_f32 v19, v19
    v_exp_f32 v20, v20
    v_smfmac_f32_32x32x32_bf16 v[128:143], v[164:167], v[40:47], v176
    ds_read_b128 v[152:155], v80 offset:43008
    v_exp_f32 v21, v21
    v_exp_f32 v22, v22
    v_mfma_f32_32x32x16_bf16 v[32:47], v[156:159], v[148:151], 0
    s_waitcnt lgkmcnt(1)
    v_exp_f32 v23, v23
    v_exp_f32 v24, v24
    v_exp_f32 v25, v25
    v_smfmac_f32_32x32x32_bf16 v[64:79], v[168:171], v[16:23], v176
    ds_read_b128 v[160:163], v81 offset:1024
    v_exp_f32 v26, v26
    v_exp_f32 v27, v27
    v_exp_f32 v28, v28
    v_exp_f32 v29, v29
    v_exp_f32 v30, v30
    v_exp_f32 v31, v31
    v_exp_f32 v32, v32
    v_exp_f32 v33, v33
    v_exp_f32 v34, v34
    v_exp_f32 v35, v35
    v_exp_f32 v36, v36
    v_smfmac_f32_32x32x32_bf16 v[64:79], v[172:175], v[24:31], v176
    s_waitcnt lgkmcnt(1)
    ds_read_b128 v[164:167], v81 offset:1536
    v_exp_f32 v37, v37
    v_exp_f32 v38, v38
    v_mfma_f32_32x32x16_bf16 v[16:31], v[152:155], v[144:147], 0
    s_nop 0
    v_exp_f32 v39, v39
    v_exp_f32 v40, v40
    v_exp_f32 v41, v41
    v_smfmac_f32_32x32x32_bf16 v[128:143], v[168:171], v[32:39], v176
    s_nop 0
    v_exp_f32 v42, v42
    v_exp_f32 v43, v43
    v_exp_f32 v44, v44
    v_exp_f32 v45, v45
    v_exp_f32 v46, v46
    v_exp_f32 v47, v47
    v_exp_f32 v16, v16
    v_exp_f32 v17, v17
    v_exp_f32 v18, v18
    v_exp_f32 v19, v19
    v_exp_f32 v20, v20
    v_smfmac_f32_32x32x32_bf16 v[128:143], v[172:175], v[40:47], v176
    ds_read_b128 v[156:159], v80 offset:44032
    v_exp_f32 v21, v21
    v_exp_f32 v22, v22
    v_mfma_f32_32x32x16_bf16 v[32:47], v[152:155], v[148:151], 0
    s_waitcnt lgkmcnt(1)
    v_exp_f32 v23, v23
    v_exp_f32 v24, v24
    v_exp_f32 v25, v25
    v_smfmac_f32_32x32x32_bf16 v[64:79], v[160:163], v[16:23], v176
    ds_read_b128 v[168:171], v81 offset:0
    v_exp_f32 v26, v26
    v_exp_f32 v27, v27
    v_exp_f32 v28, v28
    v_exp_f32 v29, v29
    v_exp_f32 v30, v30
    v_exp_f32 v31, v31
    v_exp_f32 v32, v32
    v_exp_f32 v33, v33
    v_exp_f32 v34, v34
    v_exp_f32 v35, v35
    v_exp_f32 v36, v36
    v_smfmac_f32_32x32x32_bf16 v[64:79], v[164:167], v[24:31], v176
    s_waitcnt lgkmcnt(1)
    ds_read_b128 v[172:175], v81 offset:512
    v_exp_f32 v37, v37
    v_exp_f32 v38, v38
    v_mfma_f32_32x32x16_bf16 v[16:31], v[156:159], v[144:147], 0
    s_nop 0
    v_exp_f32 v39, v39
    v_exp_f32 v40, v40
    v_exp_f32 v41, v41
    v_smfmac_f32_32x32x32_bf16 v[128:143], v[160:163], v[32:39], v176
    s_nop 0
    v_exp_f32 v42, v42
    v_exp_f32 v43, v43
    v_exp_f32 v44, v44
    v_exp_f32 v45, v45
    v_exp_f32 v46, v46
    v_exp_f32 v47, v47
    v_sub_u32 v81, v81, v84
    v_exp_f32 v16, v16
    v_exp_f32 v17, v17
    v_exp_f32 v18, v18
    v_exp_f32 v19, v19
    v_exp_f32 v20, v20
    v_smfmac_f32_32x32x32_bf16 v[128:143], v[164:167], v[40:47], v176
    ds_read_b128 v[152:155], v80 offset:45056
    v_exp_f32 v21, v21
    v_exp_f32 v22, v22
    v_mfma_f32_32x32x16_bf16 v[32:47], v[156:159], v[148:151], 0
    s_waitcnt lgkmcnt(1)
    v_exp_f32 v23, v23
    v_exp_f32 v24, v24
    v_exp_f32 v25, v25
    v_smfmac_f32_32x32x32_bf16 v[64:79], v[168:171], v[16:23], v176
    ds_read_b128 v[160:163], v81 offset:3072
    v_exp_f32 v26, v26
    v_exp_f32 v27, v27
    v_exp_f32 v28, v28
    v_exp_f32 v29, v29
    v_exp_f32 v30, v30
    v_exp_f32 v31, v31
    v_exp_f32 v32, v32
    v_exp_f32 v33, v33
    v_exp_f32 v34, v34
    v_exp_f32 v35, v35
    v_exp_f32 v36, v36
    v_smfmac_f32_32x32x32_bf16 v[64:79], v[172:175], v[24:31], v176
    s_waitcnt lgkmcnt(1)
    ds_read_b128 v[164:167], v81 offset:3584
    v_exp_f32 v37, v37
    v_exp_f32 v38, v38
    v_mfma_f32_32x32x16_bf16 v[16:31], v[152:155], v[144:147], 0
    s_nop 0
    v_exp_f32 v39, v39
    v_exp_f32 v40, v40
    v_exp_f32 v41, v41
    v_smfmac_f32_32x32x32_bf16 v[128:143], v[168:171], v[32:39], v176
    s_nop 0
    v_exp_f32 v42, v42
    v_exp_f32 v43, v43
    v_exp_f32 v44, v44
    v_exp_f32 v45, v45
    v_exp_f32 v46, v46
    v_exp_f32 v47, v47
    v_exp_f32 v16, v16
    v_exp_f32 v17, v17
    v_exp_f32 v18, v18
    v_exp_f32 v19, v19
    v_exp_f32 v20, v20
    v_smfmac_f32_32x32x32_bf16 v[128:143], v[172:175], v[40:47], v176
    ds_read_b128 v[156:159], v80 offset:46080
    v_exp_f32 v21, v21
    v_exp_f32 v22, v22
    v_mfma_f32_32x32x16_bf16 v[32:47], v[152:155], v[148:151], 0
    s_waitcnt lgkmcnt(1)
    v_exp_f32 v23, v23
    v_exp_f32 v24, v24
    v_exp_f32 v25, v25
    v_smfmac_f32_32x32x32_bf16 v[64:79], v[160:163], v[16:23], v176
    ds_read_b128 v[168:171], v81 offset:2048
    v_exp_f32 v26, v26
    v_exp_f32 v27, v27
    v_exp_f32 v28, v28
    v_exp_f32 v29, v29
    v_exp_f32 v30, v30
    v_exp_f32 v31, v31
    v_exp_f32 v32, v32
    v_exp_f32 v33, v33
    v_exp_f32 v34, v34
    v_exp_f32 v35, v35
    v_exp_f32 v36, v36
    v_smfmac_f32_32x32x32_bf16 v[64:79], v[164:167], v[24:31], v176
    s_waitcnt lgkmcnt(1)
    ds_read_b128 v[172:175], v81 offset:2560
    v_exp_f32 v37, v37
    v_exp_f32 v38, v38
    v_mfma_f32_32x32x16_bf16 v[16:31], v[156:159], v[144:147], 0
    s_nop 0
    v_exp_f32 v39, v39
    v_exp_f32 v40, v40
    v_exp_f32 v41, v41
    v_smfmac_f32_32x32x32_bf16 v[128:143], v[160:163], v[32:39], v176
    s_nop 0
    v_exp_f32 v42, v42
    v_exp_f32 v43, v43
    v_exp_f32 v44, v44
    v_exp_f32 v45, v45
    v_exp_f32 v46, v46
    v_exp_f32 v47, v47
    v_exp_f32 v16, v16
    v_exp_f32 v17, v17
    v_exp_f32 v18, v18
    v_exp_f32 v19, v19
    v_exp_f32 v20, v20
    v_smfmac_f32_32x32x32_bf16 v[128:143], v[164:167], v[40:47], v176
    ds_read_b128 v[152:155], v80 offset:47104
    v_exp_f32 v21, v21
    v_exp_f32 v22, v22
    v_mfma_f32_32x32x16_bf16 v[32:47], v[156:159], v[148:151], 0
    s_waitcnt lgkmcnt(1)
    v_exp_f32 v23, v23
    v_exp_f32 v24, v24
    v_exp_f32 v25, v25
    v_smfmac_f32_32x32x32_bf16 v[64:79], v[168:171], v[16:23], v176
    ds_read_b128 v[160:163], v81 offset:1024
    v_exp_f32 v26, v26
    v_exp_f32 v27, v27
    v_exp_f32 v28, v28
    v_exp_f32 v29, v29
    v_exp_f32 v30, v30
    v_exp_f32 v31, v31
    v_exp_f32 v32, v32
    v_exp_f32 v33, v33
    v_exp_f32 v34, v34
    v_exp_f32 v35, v35
    v_exp_f32 v36, v36
    v_smfmac_f32_32x32x32_bf16 v[64:79], v[172:175], v[24:31], v176
    s_waitcnt lgkmcnt(1)
    ds_read_b128 v[164:167], v81 offset:1536
    v_exp_f32 v37, v37
    v_exp_f32 v38, v38
    v_mfma_f32_32x32x16_bf16 v[16:31], v[152:155], v[144:147], 0
    s_nop 0
    v_exp_f32 v39, v39
    v_exp_f32 v40, v40
    v_exp_f32 v41, v41
    v_smfmac_f32_32x32x32_bf16 v[128:143], v[168:171], v[32:39], v176
    s_nop 0
    v_exp_f32 v42, v42
    v_exp_f32 v43, v43
    v_exp_f32 v44, v44
    v_exp_f32 v45, v45
    v_exp_f32 v46, v46
    v_exp_f32 v47, v47
    v_exp_f32 v16, v16
    v_exp_f32 v17, v17
    v_exp_f32 v18, v18
    v_exp_f32 v19, v19
    v_exp_f32 v20, v20
    v_smfmac_f32_32x32x32_bf16 v[128:143], v[172:175], v[40:47], v176
    ds_read_b128 v[156:159], v80 offset:48128
    v_exp_f32 v21, v21
    v_exp_f32 v22, v22
    v_mfma_f32_32x32x16_bf16 v[32:47], v[152:155], v[148:151], 0
    s_waitcnt lgkmcnt(1)
    v_exp_f32 v23, v23
    v_exp_f32 v24, v24
    v_exp_f32 v25, v25
    v_smfmac_f32_32x32x32_bf16 v[64:79], v[160:163], v[16:23], v176
    ds_read_b128 v[168:171], v81 offset:0
    v_exp_f32 v26, v26
    v_exp_f32 v27, v27
    v_exp_f32 v28, v28
    v_exp_f32 v29, v29
    v_exp_f32 v30, v30
    v_exp_f32 v31, v31
    v_exp_f32 v32, v32
    v_exp_f32 v33, v33
    v_exp_f32 v34, v34
    v_exp_f32 v35, v35
    v_exp_f32 v36, v36
    v_smfmac_f32_32x32x32_bf16 v[64:79], v[164:167], v[24:31], v176
    s_waitcnt lgkmcnt(1)
    ds_read_b128 v[172:175], v81 offset:512
    v_exp_f32 v37, v37
    v_exp_f32 v38, v38
    v_mfma_f32_32x32x16_bf16 v[16:31], v[156:159], v[144:147], 0
    s_nop 0
    v_exp_f32 v39, v39
    v_exp_f32 v40, v40
    v_exp_f32 v41, v41
    v_smfmac_f32_32x32x32_bf16 v[128:143], v[160:163], v[32:39], v176
    s_nop 0
    v_exp_f32 v42, v42
    v_exp_f32 v43, v43
    v_exp_f32 v44, v44
    v_exp_f32 v45, v45
    v_exp_f32 v46, v46
    v_exp_f32 v47, v47
    v_sub_u32 v81, v81, v84
    v_exp_f32 v16, v16
    v_exp_f32 v17, v17
    v_exp_f32 v18, v18
    v_exp_f32 v19, v19
    v_exp_f32 v20, v20
    v_smfmac_f32_32x32x32_bf16 v[128:143], v[164:167], v[40:47], v176
    ds_read_b128 v[152:155], v80 offset:49152
    v_exp_f32 v21, v21
    v_exp_f32 v22, v22
    v_mfma_f32_32x32x16_bf16 v[32:47], v[156:159], v[148:151], 0
    s_waitcnt lgkmcnt(1)
    v_exp_f32 v23, v23
    v_exp_f32 v24, v24
    v_exp_f32 v25, v25
    v_smfmac_f32_32x32x32_bf16 v[64:79], v[168:171], v[16:23], v176
    ds_read_b128 v[160:163], v81 offset:3072
    v_exp_f32 v26, v26
    v_exp_f32 v27, v27
    v_exp_f32 v28, v28
    v_exp_f32 v29, v29
    v_exp_f32 v30, v30
    v_exp_f32 v31, v31
    v_exp_f32 v32, v32
    v_exp_f32 v33, v33
    v_exp_f32 v34, v34
    v_exp_f32 v35, v35
    v_exp_f32 v36, v36
    v_smfmac_f32_32x32x32_bf16 v[64:79], v[172:175], v[24:31], v176
    s_waitcnt lgkmcnt(1)
    ds_read_b128 v[164:167], v81 offset:3584
    v_exp_f32 v37, v37
    v_exp_f32 v38, v38
    v_mfma_f32_32x32x16_bf16 v[16:31], v[152:155], v[144:147], 0
    s_nop 0
    v_exp_f32 v39, v39
    v_exp_f32 v40, v40
    v_exp_f32 v41, v41
    v_smfmac_f32_32x32x32_bf16 v[128:143], v[168:171], v[32:39], v176
    s_nop 0
    v_exp_f32 v42, v42
    v_exp_f32 v43, v43
    v_exp_f32 v44, v44
    v_exp_f32 v45, v45
    v_exp_f32 v46, v46
    v_exp_f32 v47, v47
    v_exp_f32 v16, v16
    v_exp_f32 v17, v17
    v_exp_f32 v18, v18
    v_exp_f32 v19, v19
    v_exp_f32 v20, v20
    v_smfmac_f32_32x32x32_bf16 v[128:143], v[172:175], v[40:47], v176
    ds_read_b128 v[156:159], v80 offset:50176
    v_exp_f32 v21, v21
    v_exp_f32 v22, v22
    v_mfma_f32_32x32x16_bf16 v[32:47], v[152:155], v[148:151], 0
    s_waitcnt lgkmcnt(1)
    v_exp_f32 v23, v23
    v_exp_f32 v24, v24
    v_exp_f32 v25, v25
    v_smfmac_f32_32x32x32_bf16 v[64:79], v[160:163], v[16:23], v176
    ds_read_b128 v[168:171], v81 offset:2048
    v_exp_f32 v26, v26
    v_exp_f32 v27, v27
    v_exp_f32 v28, v28
    v_exp_f32 v29, v29
    v_exp_f32 v30, v30
    v_exp_f32 v31, v31
    v_exp_f32 v32, v32
    v_exp_f32 v33, v33
    v_exp_f32 v34, v34
    v_exp_f32 v35, v35
    v_exp_f32 v36, v36
    v_smfmac_f32_32x32x32_bf16 v[64:79], v[164:167], v[24:31], v176
    s_waitcnt lgkmcnt(1)
    ds_read_b128 v[172:175], v81 offset:2560
    v_exp_f32 v37, v37
    v_exp_f32 v38, v38
    v_mfma_f32_32x32x16_bf16 v[16:31], v[156:159], v[144:147], 0
    s_nop 0
    v_exp_f32 v39, v39
    v_exp_f32 v40, v40
    v_exp_f32 v41, v41
    v_smfmac_f32_32x32x32_bf16 v[128:143], v[160:163], v[32:39], v176
    s_nop 0
    v_exp_f32 v42, v42
    v_exp_f32 v43, v43
    v_exp_f32 v44, v44
    v_exp_f32 v45, v45
    v_exp_f32 v46, v46
    v_exp_f32 v47, v47
    v_exp_f32 v16, v16
    v_exp_f32 v17, v17
    v_exp_f32 v18, v18
    v_exp_f32 v19, v19
    v_exp_f32 v20, v20
    v_smfmac_f32_32x32x32_bf16 v[128:143], v[164:167], v[40:47], v176
    ds_read_b128 v[152:155], v80 offset:51200
    v_exp_f32 v21, v21
    v_exp_f32 v22, v22
    v_mfma_f32_32x32x16_bf16 v[32:47], v[156:159], v[148:151], 0
    s_waitcnt lgkmcnt(1)
    v_exp_f32 v23, v23
    v_exp_f32 v24, v24
    v_exp_f32 v25, v25
    v_smfmac_f32_32x32x32_bf16 v[64:79], v[168:171], v[16:23], v176
    ds_read_b128 v[160:163], v81 offset:1024
    v_exp_f32 v26, v26
    v_exp_f32 v27, v27
    v_exp_f32 v28, v28
    v_exp_f32 v29, v29
    v_exp_f32 v30, v30
    v_exp_f32 v31, v31
    v_exp_f32 v32, v32
    v_exp_f32 v33, v33
    v_exp_f32 v34, v34
    v_exp_f32 v35, v35
    v_exp_f32 v36, v36
    v_smfmac_f32_32x32x32_bf16 v[64:79], v[172:175], v[24:31], v176
    s_waitcnt lgkmcnt(1)
    ds_read_b128 v[164:167], v81 offset:1536
    v_exp_f32 v37, v37
    v_exp_f32 v38, v38
    v_mfma_f32_32x32x16_bf16 v[16:31], v[152:155], v[144:147], 0
    s_nop 0
    v_exp_f32 v39, v39
    v_exp_f32 v40, v40
    v_exp_f32 v41, v41
    v_smfmac_f32_32x32x32_bf16 v[128:143], v[168:171], v[32:39], v176
    s_nop 0
    v_exp_f32 v42, v42
    v_exp_f32 v43, v43
    v_exp_f32 v44, v44
    v_exp_f32 v45, v45
    v_exp_f32 v46, v46
    v_exp_f32 v47, v47
    v_exp_f32 v16, v16
    v_exp_f32 v17, v17
    v_exp_f32 v18, v18
    v_exp_f32 v19, v19
    v_exp_f32 v20, v20
    v_smfmac_f32_32x32x32_bf16 v[128:143], v[172:175], v[40:47], v176
    ds_read_b128 v[156:159], v80 offset:52224
    v_exp_f32 v21, v21
    v_exp_f32 v22, v22
    v_mfma_f32_32x32x16_bf16 v[32:47], v[152:155], v[148:151], 0
    s_waitcnt lgkmcnt(1)
    v_exp_f32 v23, v23
    v_exp_f32 v24, v24
    v_exp_f32 v25, v25
    v_smfmac_f32_32x32x32_bf16 v[64:79], v[160:163], v[16:23], v176
    ds_read_b128 v[168:171], v81 offset:0
    v_exp_f32 v26, v26
    v_exp_f32 v27, v27
    v_exp_f32 v28, v28
    v_exp_f32 v29, v29
    v_exp_f32 v30, v30
    v_exp_f32 v31, v31
    v_exp_f32 v32, v32
    v_exp_f32 v33, v33
    v_exp_f32 v34, v34
    v_exp_f32 v35, v35
    v_exp_f32 v36, v36
    v_smfmac_f32_32x32x32_bf16 v[64:79], v[164:167], v[24:31], v176
    s_waitcnt lgkmcnt(1)
    ds_read_b128 v[172:175], v81 offset:512
    v_exp_f32 v37, v37
    v_exp_f32 v38, v38
    v_mfma_f32_32x32x16_bf16 v[16:31], v[156:159], v[144:147], 0
    s_nop 0
    v_exp_f32 v39, v39
    v_exp_f32 v40, v40
    v_exp_f32 v41, v41
    v_smfmac_f32_32x32x32_bf16 v[128:143], v[160:163], v[32:39], v176
    s_nop 0
    v_exp_f32 v42, v42
    v_exp_f32 v43, v43
    v_exp_f32 v44, v44
    v_exp_f32 v45, v45
    v_exp_f32 v46, v46
    v_exp_f32 v47, v47
    v_sub_u32 v81, v81, v84
    v_exp_f32 v16, v16
    v_exp_f32 v17, v17
    v_exp_f32 v18, v18
    v_exp_f32 v19, v19
    v_exp_f32 v20, v20
    v_smfmac_f32_32x32x32_bf16 v[128:143], v[164:167], v[40:47], v176
    ds_read_b128 v[152:155], v80 offset:53248
    v_exp_f32 v21, v21
    v_exp_f32 v22, v22
    v_mfma_f32_32x32x16_bf16 v[32:47], v[156:159], v[148:151], 0
    s_waitcnt lgkmcnt(1)
    v_exp_f32 v23, v23
    v_exp_f32 v24, v24
    v_exp_f32 v25, v25
    v_smfmac_f32_32x32x32_bf16 v[64:79], v[168:171], v[16:23], v176
    ds_read_b128 v[160:163], v81 offset:3072
    v_exp_f32 v26, v26
    v_exp_f32 v27, v27
    v_exp_f32 v28, v28
    v_exp_f32 v29, v29
    v_exp_f32 v30, v30
    v_exp_f32 v31, v31
    v_exp_f32 v32, v32
    v_exp_f32 v33, v33
    v_exp_f32 v34, v34
    v_exp_f32 v35, v35
    v_exp_f32 v36, v36
    v_smfmac_f32_32x32x32_bf16 v[64:79], v[172:175], v[24:31], v176
    s_waitcnt lgkmcnt(1)
    ds_read_b128 v[164:167], v81 offset:3584
    v_exp_f32 v37, v37
    v_exp_f32 v38, v38
    v_mfma_f32_32x32x16_bf16 v[16:31], v[152:155], v[144:147], 0
    s_nop 0
    v_exp_f32 v39, v39
    v_exp_f32 v40, v40
    v_exp_f32 v41, v41
    v_smfmac_f32_32x32x32_bf16 v[128:143], v[168:171], v[32:39], v176
    s_nop 0
    v_exp_f32 v42, v42
    v_exp_f32 v43, v43
    v_exp_f32 v44, v44
    v_exp_f32 v45, v45
    v_exp_f32 v46, v46
    v_exp_f32 v47, v47
    v_exp_f32 v16, v16
    v_exp_f32 v17, v17
    v_exp_f32 v18, v18
    v_exp_f32 v19, v19
    v_exp_f32 v20, v20
    v_smfmac_f32_32x32x32_bf16 v[128:143], v[172:175], v[40:47], v176
    ds_read_b128 v[156:159], v80 offset:54272
    v_exp_f32 v21, v21
    v_exp_f32 v22, v22
    v_mfma_f32_32x32x16_bf16 v[32:47], v[152:155], v[148:151], 0
    s_waitcnt lgkmcnt(1)
    v_exp_f32 v23, v23
    v_exp_f32 v24, v24
    v_exp_f32 v25, v25
    v_smfmac_f32_32x32x32_bf16 v[64:79], v[160:163], v[16:23], v176
    ds_read_b128 v[168:171], v81 offset:2048
    v_exp_f32 v26, v26
    v_exp_f32 v27, v27
    v_exp_f32 v28, v28
    v_exp_f32 v29, v29
    v_exp_f32 v30, v30
    v_exp_f32 v31, v31
    v_exp_f32 v32, v32
    v_exp_f32 v33, v33
    v_exp_f32 v34, v34
    v_exp_f32 v35, v35
    v_exp_f32 v36, v36
    v_smfmac_f32_32x32x32_bf16 v[64:79], v[164:167], v[24:31], v176
    s_waitcnt lgkmcnt(1)
    ds_read_b128 v[172:175], v81 offset:2560
    v_exp_f32 v37, v37
    v_exp_f32 v38, v38
    v_mfma_f32_32x32x16_bf16 v[16:31], v[156:159], v[144:147], 0
    s_nop 0
    v_exp_f32 v39, v39
    v_exp_f32 v40, v40
    v_exp_f32 v41, v41
    v_smfmac_f32_32x32x32_bf16 v[128:143], v[160:163], v[32:39], v176
    s_nop 0
    v_exp_f32 v42, v42
    v_exp_f32 v43, v43
    v_exp_f32 v44, v44
    v_exp_f32 v45, v45
    v_exp_f32 v46, v46
    v_exp_f32 v47, v47
    v_exp_f32 v16, v16
    v_exp_f32 v17, v17
    v_exp_f32 v18, v18
    v_exp_f32 v19, v19
    v_exp_f32 v20, v20
    v_smfmac_f32_32x32x32_bf16 v[128:143], v[164:167], v[40:47], v176
    ds_read_b128 v[152:155], v80 offset:55296
    v_exp_f32 v21, v21
    v_exp_f32 v22, v22
    v_mfma_f32_32x32x16_bf16 v[32:47], v[156:159], v[148:151], 0
    s_waitcnt lgkmcnt(1)
    v_exp_f32 v23, v23
    v_exp_f32 v24, v24
    v_exp_f32 v25, v25
    v_smfmac_f32_32x32x32_bf16 v[64:79], v[168:171], v[16:23], v176
    ds_read_b128 v[160:163], v81 offset:1024
    v_exp_f32 v26, v26
    v_exp_f32 v27, v27
    v_exp_f32 v28, v28
    v_exp_f32 v29, v29
    v_exp_f32 v30, v30
    v_exp_f32 v31, v31
    v_exp_f32 v32, v32
    v_exp_f32 v33, v33
    v_exp_f32 v34, v34
    v_exp_f32 v35, v35
    v_exp_f32 v36, v36
    v_smfmac_f32_32x32x32_bf16 v[64:79], v[172:175], v[24:31], v176
    s_waitcnt lgkmcnt(1)
    ds_read_b128 v[164:167], v81 offset:1536
    v_exp_f32 v37, v37
    v_exp_f32 v38, v38
    v_mfma_f32_32x32x16_bf16 v[16:31], v[152:155], v[144:147], 0
    s_nop 0
    v_exp_f32 v39, v39
    v_exp_f32 v40, v40
    v_exp_f32 v41, v41
    v_smfmac_f32_32x32x32_bf16 v[128:143], v[168:171], v[32:39], v176
    s_nop 0
    v_exp_f32 v42, v42
    v_exp_f32 v43, v43
    v_exp_f32 v44, v44
    v_exp_f32 v45, v45
    v_exp_f32 v46, v46
    v_exp_f32 v47, v47
    v_exp_f32 v16, v16
    v_exp_f32 v17, v17
    v_exp_f32 v18, v18
    v_exp_f32 v19, v19
    v_exp_f32 v20, v20
    v_smfmac_f32_32x32x32_bf16 v[128:143], v[172:175], v[40:47], v176
    ds_read_b128 v[156:159], v80 offset:56320
    v_exp_f32 v21, v21
    v_exp_f32 v22, v22
    v_mfma_f32_32x32x16_bf16 v[32:47], v[152:155], v[148:151], 0
    s_waitcnt lgkmcnt(1)
    v_exp_f32 v23, v23
    v_exp_f32 v24, v24
    v_exp_f32 v25, v25
    v_smfmac_f32_32x32x32_bf16 v[64:79], v[160:163], v[16:23], v176
    ds_read_b128 v[168:171], v81 offset:0
    v_exp_f32 v26, v26
    v_exp_f32 v27, v27
    v_exp_f32 v28, v28
    v_exp_f32 v29, v29
    v_exp_f32 v30, v30
    v_exp_f32 v31, v31
    v_exp_f32 v32, v32
    v_exp_f32 v33, v33
    v_exp_f32 v34, v34
    v_exp_f32 v35, v35
    v_exp_f32 v36, v36
    v_smfmac_f32_32x32x32_bf16 v[64:79], v[164:167], v[24:31], v176
    s_waitcnt lgkmcnt(1)
    ds_read_b128 v[172:175], v81 offset:512
    v_exp_f32 v37, v37
    v_exp_f32 v38, v38
    v_mfma_f32_32x32x16_bf16 v[16:31], v[156:159], v[144:147], 0
    s_nop 0
    v_exp_f32 v39, v39
    v_exp_f32 v40, v40
    v_exp_f32 v41, v41
    v_smfmac_f32_32x32x32_bf16 v[128:143], v[160:163], v[32:39], v176
    s_nop 0
    v_exp_f32 v42, v42
    v_exp_f32 v43, v43
    v_exp_f32 v44, v44
    v_exp_f32 v45, v45
    v_exp_f32 v46, v46
    v_exp_f32 v47, v47
    v_sub_u32 v81, v81, v84
    v_exp_f32 v16, v16
    v_exp_f32 v17, v17
    v_exp_f32 v18, v18
    v_exp_f32 v19, v19
    v_exp_f32 v20, v20
    v_smfmac_f32_32x32x32_bf16 v[128:143], v[164:167], v[40:47], v176
    ds_read_b128 v[152:155], v80 offset:57344
    v_exp_f32 v21, v21
    v_exp_f32 v22, v22
    v_mfma_f32_32x32x16_bf16 v[32:47], v[156:159], v[148:151], 0
    s_waitcnt lgkmcnt(1)
    v_exp_f32 v23, v23
    v_exp_f32 v24, v24
    v_exp_f32 v25, v25
    v_smfmac_f32_32x32x32_bf16 v[64:79], v[168:171], v[16:23], v176
    ds_read_b128 v[160:163], v81 offset:3072
    v_exp_f32 v26, v26
    v_exp_f32 v27, v27
    v_exp_f32 v28, v28
    v_exp_f32 v29, v29
    v_exp_f32 v30, v30
    v_exp_f32 v31, v31
    v_exp_f32 v32, v32
    v_exp_f32 v33, v33
    v_exp_f32 v34, v34
    v_exp_f32 v35, v35
    v_exp_f32 v36, v36
    v_smfmac_f32_32x32x32_bf16 v[64:79], v[172:175], v[24:31], v176
    s_waitcnt lgkmcnt(1)
    ds_read_b128 v[164:167], v81 offset:3584
    v_exp_f32 v37, v37
    v_exp_f32 v38, v38
    v_mfma_f32_32x32x16_bf16 v[16:31], v[152:155], v[144:147], 0
    s_nop 0
    v_exp_f32 v39, v39
    v_exp_f32 v40, v40
    v_exp_f32 v41, v41
    v_smfmac_f32_32x32x32_bf16 v[128:143], v[168:171], v[32:39], v176
    s_nop 0
    v_exp_f32 v42, v42
    v_exp_f32 v43, v43
    v_exp_f32 v44, v44
    v_exp_f32 v45, v45
    v_exp_f32 v46, v46
    v_exp_f32 v47, v47
    v_exp_f32 v16, v16
    v_exp_f32 v17, v17
    v_exp_f32 v18, v18
    v_exp_f32 v19, v19
    v_exp_f32 v20, v20
    v_smfmac_f32_32x32x32_bf16 v[128:143], v[172:175], v[40:47], v176
    ds_read_b128 v[156:159], v80 offset:58368
    v_exp_f32 v21, v21
    v_exp_f32 v22, v22
    v_mfma_f32_32x32x16_bf16 v[32:47], v[152:155], v[148:151], 0
    s_waitcnt lgkmcnt(1)
    v_exp_f32 v23, v23
    v_exp_f32 v24, v24
    v_exp_f32 v25, v25
    v_smfmac_f32_32x32x32_bf16 v[64:79], v[160:163], v[16:23], v176
    ds_read_b128 v[168:171], v81 offset:2048
    v_exp_f32 v26, v26
    v_exp_f32 v27, v27
    v_exp_f32 v28, v28
    v_exp_f32 v29, v29
    v_exp_f32 v30, v30
    v_exp_f32 v31, v31
    v_exp_f32 v32, v32
    v_exp_f32 v33, v33
    v_exp_f32 v34, v34
    v_exp_f32 v35, v35
    v_exp_f32 v36, v36
    v_smfmac_f32_32x32x32_bf16 v[64:79], v[164:167], v[24:31], v176
    s_waitcnt lgkmcnt(1)
    ds_read_b128 v[172:175], v81 offset:2560
    v_exp_f32 v37, v37
    v_exp_f32 v38, v38
    v_mfma_f32_32x32x16_bf16 v[16:31], v[156:159], v[144:147], 0
    s_nop 0
    v_exp_f32 v39, v39
    v_exp_f32 v40, v40
    v_exp_f32 v41, v41
    v_smfmac_f32_32x32x32_bf16 v[128:143], v[160:163], v[32:39], v176
    s_nop 0
    v_exp_f32 v42, v42
    v_exp_f32 v43, v43
    v_exp_f32 v44, v44
    v_exp_f32 v45, v45
    v_exp_f32 v46, v46
    v_exp_f32 v47, v47
    v_exp_f32 v16, v16
    v_exp_f32 v17, v17
    v_exp_f32 v18, v18
    v_exp_f32 v19, v19
    v_exp_f32 v20, v20
    v_smfmac_f32_32x32x32_bf16 v[128:143], v[164:167], v[40:47], v176
    ds_read_b128 v[152:155], v80 offset:59392
    v_exp_f32 v21, v21
    v_exp_f32 v22, v22
    v_mfma_f32_32x32x16_bf16 v[32:47], v[156:159], v[148:151], 0
    s_waitcnt lgkmcnt(1)
    v_exp_f32 v23, v23
    v_exp_f32 v24, v24
    v_exp_f32 v25, v25
    v_smfmac_f32_32x32x32_bf16 v[64:79], v[168:171], v[16:23], v176
    ds_read_b128 v[160:163], v81 offset:1024
    v_exp_f32 v26, v26
    v_exp_f32 v27, v27
    v_exp_f32 v28, v28
    v_exp_f32 v29, v29
    v_exp_f32 v30, v30
    v_exp_f32 v31, v31
    v_exp_f32 v32, v32
    v_exp_f32 v33, v33
    v_exp_f32 v34, v34
    v_exp_f32 v35, v35
    v_exp_f32 v36, v36
    v_smfmac_f32_32x32x32_bf16 v[64:79], v[172:175], v[24:31], v176
    s_waitcnt lgkmcnt(1)
    ds_read_b128 v[164:167], v81 offset:1536
    v_exp_f32 v37, v37
    v_exp_f32 v38, v38
    v_mfma_f32_32x32x16_bf16 v[16:31], v[152:155], v[144:147], 0
    s_nop 0
    v_exp_f32 v39, v39
    v_exp_f32 v40, v40
    v_exp_f32 v41, v41
    v_smfmac_f32_32x32x32_bf16 v[128:143], v[168:171], v[32:39], v176
    s_nop 0
    v_exp_f32 v42, v42
    v_exp_f32 v43, v43
    v_exp_f32 v44, v44
    v_exp_f32 v45, v45
    v_exp_f32 v46, v46
    v_exp_f32 v47, v47
    v_exp_f32 v16, v16
    v_exp_f32 v17, v17
    v_exp_f32 v18, v18
    v_exp_f32 v19, v19
    v_exp_f32 v20, v20
    v_smfmac_f32_32x32x32_bf16 v[128:143], v[172:175], v[40:47], v176
    ds_read_b128 v[156:159], v80 offset:60416
    v_exp_f32 v21, v21
    v_exp_f32 v22, v22
    v_mfma_f32_32x32x16_bf16 v[32:47], v[152:155], v[148:151], 0
    s_waitcnt lgkmcnt(1)
    v_exp_f32 v23, v23
    v_exp_f32 v24, v24
    v_exp_f32 v25, v25
    v_smfmac_f32_32x32x32_bf16 v[64:79], v[160:163], v[16:23], v176
    ds_read_b128 v[168:171], v81 offset:0
    v_exp_f32 v26, v26
    v_exp_f32 v27, v27
    v_exp_f32 v28, v28
    v_exp_f32 v29, v29
    v_exp_f32 v30, v30
    v_exp_f32 v31, v31
    v_exp_f32 v32, v32
    v_exp_f32 v33, v33
    v_exp_f32 v34, v34
    v_exp_f32 v35, v35
    v_exp_f32 v36, v36
    v_smfmac_f32_32x32x32_bf16 v[64:79], v[164:167], v[24:31], v176
    s_waitcnt lgkmcnt(1)
    ds_read_b128 v[172:175], v81 offset:512
    v_exp_f32 v37, v37
    v_exp_f32 v38, v38
    v_mfma_f32_32x32x16_bf16 v[16:31], v[156:159], v[144:147], 0
    s_nop 0
    v_exp_f32 v39, v39
    v_exp_f32 v40, v40
    v_exp_f32 v41, v41
    v_smfmac_f32_32x32x32_bf16 v[128:143], v[160:163], v[32:39], v176
    s_nop 0
    v_exp_f32 v42, v42
    v_exp_f32 v43, v43
    v_exp_f32 v44, v44
    v_exp_f32 v45, v45
    v_exp_f32 v46, v46
    v_exp_f32 v47, v47
    v_sub_u32 v81, v81, v84
    v_exp_f32 v16, v16
    v_exp_f32 v17, v17
    v_exp_f32 v18, v18
    v_exp_f32 v19, v19
    v_exp_f32 v20, v20
    v_smfmac_f32_32x32x32_bf16 v[128:143], v[164:167], v[40:47], v176
    ds_read_b128 v[152:155], v80 offset:61440
    v_exp_f32 v21, v21
    v_exp_f32 v22, v22
    v_mfma_f32_32x32x16_bf16 v[32:47], v[156:159], v[148:151], 0
    s_waitcnt lgkmcnt(1)
    v_exp_f32 v23, v23
    v_exp_f32 v24, v24
    v_exp_f32 v25, v25
    v_smfmac_f32_32x32x32_bf16 v[64:79], v[168:171], v[16:23], v176
    ds_read_b128 v[160:163], v81 offset:3072
    v_exp_f32 v26, v26
    v_exp_f32 v27, v27
    v_exp_f32 v28, v28
    v_exp_f32 v29, v29
    v_exp_f32 v30, v30
    v_exp_f32 v31, v31
    v_exp_f32 v32, v32
    v_exp_f32 v33, v33
    v_exp_f32 v34, v34
    v_exp_f32 v35, v35
    v_exp_f32 v36, v36
    v_smfmac_f32_32x32x32_bf16 v[64:79], v[172:175], v[24:31], v176
    s_waitcnt lgkmcnt(1)
    ds_read_b128 v[164:167], v81 offset:3584
    v_exp_f32 v37, v37
    v_exp_f32 v38, v38
    v_mfma_f32_32x32x16_bf16 v[16:31], v[152:155], v[144:147], 0
    s_nop 0
    v_exp_f32 v39, v39
    v_exp_f32 v40, v40
    v_exp_f32 v41, v41
    v_smfmac_f32_32x32x32_bf16 v[128:143], v[168:171], v[32:39], v176
    s_nop 0
    v_exp_f32 v42, v42
    v_exp_f32 v43, v43
    v_exp_f32 v44, v44
    v_exp_f32 v45, v45
    v_exp_f32 v46, v46
    v_exp_f32 v47, v47
    v_exp_f32 v16, v16
    v_exp_f32 v17, v17
    v_exp_f32 v18, v18
    v_exp_f32 v19, v19
    v_exp_f32 v20, v20
    v_smfmac_f32_32x32x32_bf16 v[128:143], v[172:175], v[40:47], v176
    ds_read_b128 v[156:159], v80 offset:62464
    v_exp_f32 v21, v21
    v_exp_f32 v22, v22
    v_mfma_f32_32x32x16_bf16 v[32:47], v[152:155], v[148:151], 0
    s_waitcnt lgkmcnt(1)
    v_exp_f32 v23, v23
    v_exp_f32 v24, v24
    v_exp_f32 v25, v25
    v_smfmac_f32_32x32x32_bf16 v[64:79], v[160:163], v[16:23], v176
    ds_read_b128 v[168:171], v81 offset:2048
    v_exp_f32 v26, v26
    v_exp_f32 v27, v27
    v_exp_f32 v28, v28
    v_exp_f32 v29, v29
    v_exp_f32 v30, v30
    v_exp_f32 v31, v31
    v_exp_f32 v32, v32
    v_exp_f32 v33, v33
    v_exp_f32 v34, v34
    v_exp_f32 v35, v35
    v_exp_f32 v36, v36
    v_smfmac_f32_32x32x32_bf16 v[64:79], v[164:167], v[24:31], v176
    s_waitcnt lgkmcnt(1)
    ds_read_b128 v[172:175], v81 offset:2560
    v_exp_f32 v37, v37
    v_exp_f32 v38, v38
    v_mfma_f32_32x32x16_bf16 v[16:31], v[156:159], v[144:147], 0
    s_nop 0
    v_exp_f32 v39, v39
    v_exp_f32 v40, v40
    v_exp_f32 v41, v41
    v_smfmac_f32_32x32x32_bf16 v[128:143], v[160:163], v[32:39], v176
    s_nop 0
    v_exp_f32 v42, v42
    v_exp_f32 v43, v43
    v_exp_f32 v44, v44
    v_exp_f32 v45, v45
    v_exp_f32 v46, v46
    v_exp_f32 v47, v47
    v_exp_f32 v16, v16
    v_exp_f32 v17, v17
    v_exp_f32 v18, v18
    v_exp_f32 v19, v19
    v_exp_f32 v20, v20
    v_smfmac_f32_32x32x32_bf16 v[128:143], v[164:167], v[40:47], v176
    ds_read_b128 v[152:155], v80 offset:63488
    v_exp_f32 v21, v21
    v_exp_f32 v22, v22
    v_mfma_f32_32x32x16_bf16 v[32:47], v[156:159], v[148:151], 0
    s_waitcnt lgkmcnt(1)
    v_exp_f32 v23, v23
    v_exp_f32 v24, v24
    v_exp_f32 v25, v25
    v_smfmac_f32_32x32x32_bf16 v[64:79], v[168:171], v[16:23], v176
    ds_read_b128 v[160:163], v81 offset:1024
    v_exp_f32 v26, v26
    v_exp_f32 v27, v27
    v_exp_f32 v28, v28
    v_exp_f32 v29, v29
    v_exp_f32 v30, v30
    v_exp_f32 v31, v31
    v_exp_f32 v32, v32
    v_exp_f32 v33, v33
    v_exp_f32 v34, v34
    v_exp_f32 v35, v35
    v_exp_f32 v36, v36
    v_smfmac_f32_32x32x32_bf16 v[64:79], v[172:175], v[24:31], v176
    s_waitcnt lgkmcnt(1)
    ds_read_b128 v[164:167], v81 offset:1536
    v_exp_f32 v37, v37
    v_exp_f32 v38, v38
    v_mfma_f32_32x32x16_bf16 v[16:31], v[152:155], v[144:147], 0
    s_nop 0
    v_exp_f32 v39, v39
    v_exp_f32 v40, v40
    v_exp_f32 v41, v41
    v_smfmac_f32_32x32x32_bf16 v[128:143], v[168:171], v[32:39], v176
    s_nop 0
    v_exp_f32 v42, v42
    v_exp_f32 v43, v43
    v_exp_f32 v44, v44
    v_exp_f32 v45, v45
    v_exp_f32 v46, v46
    v_exp_f32 v47, v47
    v_exp_f32 v16, v16
    v_exp_f32 v17, v17
    v_exp_f32 v18, v18
    v_exp_f32 v19, v19
    v_exp_f32 v20, v20
    v_smfmac_f32_32x32x32_bf16 v[128:143], v[172:175], v[40:47], v176
    ds_read_b128 v[156:159], v80 offset:64512
    v_exp_f32 v21, v21
    v_exp_f32 v22, v22
    v_mfma_f32_32x32x16_bf16 v[32:47], v[152:155], v[148:151], 0
    s_waitcnt lgkmcnt(1)
    v_exp_f32 v23, v23
    v_exp_f32 v24, v24
    v_exp_f32 v25, v25
    v_smfmac_f32_32x32x32_bf16 v[64:79], v[160:163], v[16:23], v176
    ds_read_b128 v[168:171], v81 offset:0
    v_exp_f32 v26, v26
    v_exp_f32 v27, v27
    v_exp_f32 v28, v28
    v_exp_f32 v29, v29
    v_exp_f32 v30, v30
    v_exp_f32 v31, v31
    v_exp_f32 v32, v32
    v_exp_f32 v33, v33
    v_exp_f32 v34, v34
    v_exp_f32 v35, v35
    v_exp_f32 v36, v36
    v_smfmac_f32_32x32x32_bf16 v[64:79], v[164:167], v[24:31], v176
    s_waitcnt lgkmcnt(1)
    ds_read_b128 v[172:175], v81 offset:512
    v_exp_f32 v37, v37
    v_exp_f32 v38, v38
    v_mfma_f32_32x32x16_bf16 v[16:31], v[156:159], v[144:147], 0
    s_nop 0
    v_exp_f32 v39, v39
    v_exp_f32 v40, v40
    v_exp_f32 v41, v41
    v_smfmac_f32_32x32x32_bf16 v[128:143], v[160:163], v[32:39], v176
    s_nop 0
    v_exp_f32 v42, v42
    v_exp_f32 v43, v43
    v_exp_f32 v44, v44
    v_exp_f32 v45, v45
    v_exp_f32 v46, v46
    v_exp_f32 v47, v47
    v_exp_f32 v16, v16
    v_exp_f32 v17, v17
    v_exp_f32 v18, v18
    v_exp_f32 v19, v19
    v_exp_f32 v20, v20
    v_smfmac_f32_32x32x32_bf16 v[128:143], v[164:167], v[40:47], v176
    v_exp_f32 v21, v21
    v_exp_f32 v22, v22
    v_mfma_f32_32x32x16_bf16 v[32:47], v[156:159], v[148:151], 0
    s_waitcnt lgkmcnt(0)
    v_exp_f32 v23, v23
    v_exp_f32 v24, v24
    v_exp_f32 v25, v25
    v_smfmac_f32_32x32x32_bf16 v[64:79], v[168:171], v[16:23], v176
    s_nop 0
    v_exp_f32 v26, v26
    v_exp_f32 v27, v27
    v_exp_f32 v28, v28
    v_exp_f32 v29, v29
    v_exp_f32 v30, v30
    v_exp_f32 v31, v31
    v_exp_f32 v32, v32
    v_exp_f32 v33, v33
    v_exp_f32 v34, v34
    v_exp_f32 v35, v35
    v_exp_f32 v36, v36
    v_smfmac_f32_32x32x32_bf16 v[64:79], v[172:175], v[24:31], v176
    v_exp_f32 v37, v37
    v_exp_f32 v38, v38
    v_exp_f32 v39, v39
    v_exp_f32 v40, v40
    v_exp_f32 v41, v41
    v_smfmac_f32_32x32x32_bf16 v[128:143], v[168:171], v[32:39], v176
    s_nop 0
    v_exp_f32 v42, v42
    v_exp_f32 v43, v43
    v_exp_f32 v44, v44
    v_exp_f32 v45, v45
    v_exp_f32 v46, v46
    v_exp_f32 v47, v47
    s_nop 1
    v_smfmac_f32_32x32x32_bf16 v[128:143], v[172:175], v[40:47], v176
L_norm:
    v_rcp_f32 v180, v72
    s_lshl_b32 s52, s58, 2
    s_add_u32 s52, s52, s3
    s_lshl_b32 s50, s52, 6
    s_add_u32 s50, s50, s57
    s_lshl_b32 s50, s50, 10
    s_add_u32 s50, s50, 6291456
    s_add_u32 s51, s50, 32768
    v_mul_f32 v16, v64, v180
    v_mul_f32 v17, v65, v180
    v_mul_f32 v18, v66, v180
    v_mul_f32 v19, v67, v180
    v_mul_f32 v20, v68, v180
    v_mul_f32 v21, v69, v180
    v_mul_f32 v22, v70, v180
    v_mul_f32 v23, v71, v180
    v_rcp_f32 v181, v136
    v_cvt_pk_bf16_f32 v16, v16, v17
    v_cvt_pk_bf16_f32 v17, v18, v19
    v_cvt_pk_bf16_f32 v18, v20, v21
    v_cvt_pk_bf16_f32 v19, v22, v23
    buffer_store_dwordx4 v[16:19], v2, s[20:23], s50 offen sc1
    v_mul_f32 v24, v128, v181
    v_mul_f32 v25, v129, v181
    v_mul_f32 v26, v130, v181
    v_mul_f32 v27, v131, v181
    v_mul_f32 v28, v132, v181
    v_mul_f32 v29, v133, v181
    v_mul_f32 v30, v134, v181
    v_mul_f32 v31, v135, v181
    v_cvt_pk_bf16_f32 v24, v24, v25
    v_cvt_pk_bf16_f32 v25, v26, v27
    v_cvt_pk_bf16_f32 v26, v28, v29
    v_cvt_pk_bf16_f32 v27, v30, v31
    buffer_store_dwordx4 v[24:27], v2, s[20:23], s51 offen sc1
    s_cmp_eq_u32 s62, 2
    s_cbranch_scc1 L_safe
    v_mov_b32 v180, 0
    v_fma_f32 v180, v64, 0, v180
    v_fma_f32 v180, v65, 0, v180
    v_fma_f32 v180, v66, 0, v180
    v_fma_f32 v180, v67, 0, v180
    v_fma_f32 v180, v68, 0, v180
    v_fma_f32 v180, v69, 0, v180
    v_fma_f32 v180, v70, 0, v180
    v_fma_f32 v180, v71, 0, v180
    v_fma_f32 v180, v128, 0, v180
    v_fma_f32 v180, v129, 0, v180
    v_fma_f32 v180, v130, 0, v180
    v_fma_f32 v180, v131, 0, v180
    v_fma_f32 v180, v132, 0, v180
    v_fma_f32 v180, v133, 0, v180
    v_fma_f32 v180, v134, 0, v180
    v_fma_f32 v180, v135, 0, v180
    v_min_f32 v181, v72, v136
    v_max_f32 v182, v72, v136
    v_add_f32 v181, v181, v180
    v_add_f32 v182, v182, v180
    v_cmp_u_f32 s[4:5], v72, v136
    v_cmp_nle_f32 vcc, 0x17800000, v181
    s_or_b64 s[4:5], s[4:5], vcc
    v_cmp_nge_f32 vcc, 0x67800000, v182
    s_or_b64 s[4:5], s[4:5], vcc
    s_cmp_lg_u64 s[4:5], 0
    s_cbranch_scc1 L_slow
L_safe:
    s_add_u32 s52, s52, 32
    s_waitcnt vmcnt(0)
    s_lshl_b32 s50, s52, 7
    s_add_u32 s50, s50, 17825792
    v_mov_b32 v180, 1
    v_mov_b32 v181, 0
    s_mov_b64 exec, 1
    buffer_atomic_add v180, v181, s[20:23], s50 offen sc1
    s_mov_b64 exec, -1
    s_barrier
    s_barrier
    s_cmp_lg_u32 s3, 0
    s_cbranch_scc1 L_a6
    s_add_u32 s50, s57, 32
    s_lshl_b32 s50, s50, 7
    s_add_u32 s50, s50, 17825792
    v_mov_b32 v180, s50
    s_mov_b32 s60, 200000
    s_mov_b64 exec, 1
L_pl4:
    buffer_load_dword v181, v180, s[20:23], 0 offen sc1
    s_waitcnt vmcnt(0)
    v_cmp_ne_u32 vcc, 32, v181
    s_cbranch_vccz L_pd4
    s_sleep 1
    s_sub_u32 s60, s60, 1
    s_cbranch_scc0 L_pl4
L_pd4:
    s_mov_b64 exec, -1
L_a6:
    s_barrier
    s_lshl_b32 s51, s57, 16
    s_lshl_b32 s52, s3, 10
    s_add_u32 s51, s51, s52
    s_add_u32 s51, s51, 6291456
    s_add_u32 m0, s52, 32768
    s_add_u32 s50, s51, 0
    buffer_load_dwordx4 v2, s[20:23], s50 offen sc1 lds
    s_add_u32 m0, s52, 65536
    s_add_u32 s50, s51, 32768
    buffer_load_dwordx4 v2, s[20:23], s50 offen sc1 lds
    s_add_u32 m0, s52, 40960
    s_add_u32 s50, s51, 8192
    buffer_load_dwordx4 v2, s[20:23], s50 offen sc1 lds
    s_add_u32 m0, s52, 73728
    s_add_u32 s50, s51, 40960
    buffer_load_dwordx4 v2, s[20:23], s50 offen sc1 lds
    s_add_u32 m0, s52, 49152
    s_add_u32 s50, s51, 16384
    buffer_load_dwordx4 v2, s[20:23], s50 offen sc1 lds
    s_add_u32 m0, s52, 81920
    s_add_u32 s50, s51, 49152
    buffer_load_dwordx4 v2, s[20:23], s50 offen sc1 lds
    s_add_u32 m0, s52, 57344
    s_add_u32 s50, s51, 24576
    buffer_load_dwordx4 v2, s[20:23], s50 offen sc1 lds
    s_add_u32 m0, s52, 90112
    s_add_u32 s50, s51, 57344
    buffer_load_dwordx4 v2, s[20:23], s50 offen sc1 lds
    s_waitcnt vmcnt(6)
    s_barrier
    s_waitcnt vmcnt(4)
    s_barrier
    s_waitcnt vmcnt(2)
    s_barrier
    s_waitcnt vmcnt(0)
    s_barrier
    s_branch L_fin
L_slow:
    s_mov_b32 s62, 2
    s_waitcnt vmcnt(0)
    s_lshl_b32 s63, s57, 16
    s_add_u32 s50, s63, 2097152
    s_mov_b32 s60, 0
    v_mov_b32 v184, 0xff800000
    v_mov_b32 v185, 0xff800000
L_mx:
    buffer_load_dwordx4 v[152:155], v80, s[20:23], s50 offen sc1
    s_waitcnt vmcnt(0)
    v_mfma_f32_32x32x16_bf16 v[16:31], v[152:155], v[144:147], 0
    v_mfma_f32_32x32x16_bf16 v[32:47], v[152:155], v[148:151], 0
    s_nop 7
    s_nop 3
    v_max3_f32 v184, v16, v17, v184
    v_max3_f32 v184, v18, v19, v184
    v_max3_f32 v184, v20, v21, v184
    v_max3_f32 v184, v22, v23, v184
    v_max3_f32 v184, v24, v25, v184
    v_max3_f32 v184, v26, v27, v184
    v_max3_f32 v184, v28, v29, v184
    v_max3_f32 v184, v30, v31, v184
    v_max3_f32 v185, v32, v33, v185
    v_max3_f32 v185, v34, v35, v185
    v_max3_f32 v185, v36, v37, v185
    v_max3_f32 v185, v38, v39, v185
    v_max3_f32 v185, v40, v41, v185
    v_max3_f32 v185, v42, v43, v185
    v_max3_f32 v185, v44, v45, v185
    v_max3_f32 v185, v46, v47, v185
    s_add_u32 s50, s50, 1024
    s_add_u32 s60, s60, 1
    s_cmp_lt_u32 s60, 64
    s_cbranch_scc1 L_mx
    v_mov_b32 v186, v184
    v_mov_b32 v187, v185
    s_nop 1
    v_permlane32_swap_b32 v184, v186
    v_permlane32_swap_b32 v185, v187
    s_nop 1
    v_max_f32 v184, v184, v186
    v_max_f32 v185, v185, v187
    v_sub_f32 v192, 0, v184
    v_sub_f32 v208, 0, v185
    v_mov_b32 v64, 0
    v_mov_b32 v128, 0
    v_sub_f32 v193, 0, v184
    v_sub_f32 v209, 0, v185
    v_mov_b32 v65, 0
    v_mov_b32 v129, 0
    v_sub_f32 v194, 0, v184
    v_sub_f32 v210, 0, v185
    v_mov_b32 v66, 0
    v_mov_b32 v130, 0
    v_sub_f32 v195, 0, v184
    v_sub_f32 v211, 0, v185
    v_mov_b32 v67, 0
    v_mov_b32 v131, 0
    v_sub_f32 v196, 0, v184
    v_sub_f32 v212, 0, v185
    v_mov_b32 v68, 0
    v_mov_b32 v132, 0
    v_sub_f32 v197, 0, v184
    v_sub_f32 v213, 0, v185
    v_mov_b32 v69, 0
    v_mov_b32 v133, 0
    v_sub_f32 v198, 0, v184
    v_sub_f32 v214, 0, v185
    v_mov_b32 v70, 0
    v_mov_b32 v134, 0
    v_sub_f32 v199, 0, v184
    v_sub_f32 v215, 0, v185
    v_mov_b32 v71, 0
    v_mov_b32 v135, 0
    v_sub_f32 v200, 0, v184
    v_sub_f32 v216, 0, v185
    v_mov_b32 v72, 0
    v_mov_b32 v136, 0
    v_sub_f32 v201, 0, v184
    v_sub_f32 v217, 0, v185
    v_mov_b32 v73, 0
    v_mov_b32 v137, 0
    v_sub_f32 v202, 0, v184
    v_sub_f32 v218, 0, v185
    v_mov_b32 v74, 0
    v_mov_b32 v138, 0
    v_sub_f32 v203, 0, v184
    v_sub_f32 v219, 0, v185
    v_mov_b32 v75, 0
    v_mov_b32 v139, 0
    v_sub_f32 v204, 0, v184
    v_sub_f32 v220, 0, v185
    v_mov_b32 v76, 0
    v_mov_b32 v140, 0
    v_sub_f32 v205, 0, v184
    v_sub_f32 v221, 0, v185
    v_mov_b32 v77, 0
    v_mov_b32 v141, 0
    v_sub_f32 v206, 0, v184
    v_sub_f32 v222, 0, v185
    v_mov_b32 v78, 0
    v_mov_b32 v142, 0
    v_sub_f32 v207, 0, v184
    v_sub_f32 v223, 0, v185
    v_mov_b32 v79, 0
    v_mov_b32 v143, 0
    v_and_b32 v180, 15, v1
    v_lshlrev_b32 v180, 4, v180
    v_lshrrev_b32 v181, 5, v1
    v_lshl_add_u32 v180, v181, 8, v180
    v_and_b32 v181, 27, v1
    v_cmp_eq_u32 vcc, 16, v181
    v_mov_b32 v181, 0x3f803f80
    s_mov_b32 s60, 0
    s_mov_b32 s4, 0xffff
    s_mov_b32 s5, 0xffff
    v_cndmask_b32 v160, 0, v181, vcc
    v_cndmask_b32 v161, 0, v181, vcc
    v_cndmask_b32 v162, 0, v181, vcc
    v_cndmask_b32 v163, 0, v181, vcc
    v_cndmask_b32 v164, 0, v181, vcc
    v_cndmask_b32 v165, 0, v181, vcc
    v_cndmask_b32 v166, 0, v181, vcc
    v_cndmask_b32 v167, 0, v181, vcc
L_sl:
    s_add_u32 s50, s63, 2097152
    s_add_u32 s51, s63, 4194304
    buffer_load_dwordx4 v[152:155], v80, s[20:23], s50 offen sc1
    s_mov_b64 exec, s[4:5]
    buffer_load_dwordx4 v[160:163], v180, s[20:23], s51 offen sc1
    buffer_load_dwordx4 v[164:167], v180, s[20:23], s51 offen offset:512 sc1
    s_mov_b64 exec, -1
    s_waitcnt vmcnt(0)
    v_mfma_f32_32x32x16_bf16 v[16:31], v[152:155], v[144:147], v[192:207]
    v_mfma_f32_32x32x16_bf16 v[32:47], v[152:155], v[148:151], v[208:223]
    s_nop 7
    s_nop 3
    v_exp_f32 v16, v16
    v_exp_f32 v17, v17
    v_exp_f32 v18, v18
    v_exp_f32 v19, v19
    v_exp_f32 v20, v20
    v_exp_f32 v21, v21
    v_exp_f32 v22, v22
    v_exp_f32 v23, v23
    v_exp_f32 v24, v24
    v_exp_f32 v25, v25
    v_exp_f32 v26, v26
    v_exp_f32 v27, v27
    v_exp_f32 v28, v28
    v_exp_f32 v29, v29
    v_exp_f32 v30, v30
    v_exp_f32 v31, v31
    v_exp_f32 v32, v32
    v_exp_f32 v33, v33
    v_exp_f32 v34, v34
    v_exp_f32 v35, v35
    v_exp_f32 v36, v36
    v_exp_f32 v37, v37
    v_exp_f32 v38, v38
    v_exp_f32 v39, v39
    v_exp_f32 v40, v40
    v_exp_f32 v41, v41
    v_exp_f32 v42, v42
    v_exp_f32 v43, v43
    v_exp_f32 v44, v44
    v_exp_f32 v45, v45
    v_exp_f32 v46, v46
    v_exp_f32 v47, v47
    s_nop 1
    v_smfmac_f32_32x32x32_bf16 v[64:79], v[160:163], v[16:23], v176
    v_smfmac_f32_32x32x32_bf16 v[128:143], v[160:163], v[32:39], v176
    v_smfmac_f32_32x32x32_bf16 v[64:79], v[164:167], v[24:31], v176
    v_smfmac_f32_32x32x32_bf16 v[128:143], v[164:167], v[40:47], v176
    s_add_u32 s63, s63, 1024
    s_add_u32 s60, s60, 1
    s_cmp_lt_u32 s60, 64
    s_nop 7
    s_nop 7
    s_cbranch_scc1 L_sl
    s_branch L_norm
L_r1:
    v_bfe_u32 v80, v1, 1, 3
    v_lshrrev_b32 v81, 4, v1
    v_xor_b32 v80, v80, v81
    v_lshlrev_b32 v80, 4, v80
    v_lshl_add_u32 v80, v120, 7, v80
    v_add_u32 v80, s49, v80
    v_xor_b32 v81, 64, v80
    v_lshrrev_b32 v118, 3, v1
    v_lshlrev_b32 v118, 10, v118
    v_bfe_u32 v121, v1, 4, 1
    v_lshlrev_b32 v122, 2, v121
    v_and_b32 v120, 7, v1
    v_xor_b32 v122, v122, v120
    v_lshl_add_u32 v124, v122, 4, v118
    v_bfe_u32 v118, v1, 2, 2
    v_lshl_add_u32 v125, v119, 2, v118
    v_lshlrev_b32 v125, 7, v125
    v_lshrrev_b32 v118, 1, v118
    s_lshr_b32 s50, s44, 1
    v_xor_b32 v118, s50, v118
    v_lshl_add_u32 v125, v118, 6, v125
    v_lshl_add_u32 v125, v121, 5, v125
    v_and_b32 v118, 1, v1
    v_lshl_add_u32 v125, v118, 4, v125
    v_bfe_u32 v118, v1, 1, 1
    v_lshl_add_u32 v125, v118, 3, v125
    v_lshlrev_b32 v118, 4, v119
    v_lshl_add_u32 v126, v0, 10, v118
    s_xor_b32 s51, s56, 2
    s_mul_i32 s51, s51, 196608
    s_add_u32 m0, s59, 90112
    s_add_u32 s51, s47, s51
    buffer_load_dwordx4 v72, s[12:15], s51 offen offset:0 lds
    buffer_load_dwordx4 v73, s[12:15], s51 offen offset:1024 lds
    buffer_load_dwordx4 v74, s[12:15], s51 offen offset:2048 lds
    s_waitcnt vmcnt(6)
    s_barrier
    ds_read_b128 v[128:131], v64 offset:8192
    ds_read_b64_tr_b16 v[48:49], v68 offset:24576
    ds_read_b64_tr_b16 v[50:51], v68 offset:25344
    ds_read_b128 v[60:63], v80 offset:8192
    ds_read_b128 v[132:135], v65 offset:8192
    ds_read_b64_tr_b16 v[52:53], v69 offset:24576
    ds_read_b64_tr_b16 v[54:55], v69 offset:25344
    ds_read_b128 v[8:11], v80 offset:10240
    s_cmp_ge_u32 s43, 10
    s_cbranch_scc1 L_p1n1
    s_setprio 1
    s_waitcnt lgkmcnt(4)
    v_mfma_f32_32x32x16_bf16 v[16:31], v[48:51], v[128:131], 0
    ds_read_b128 v[136:139], v66 offset:8192
    ds_read_b64_tr_b16 v[56:57], v70 offset:24576
    ds_read_b64_tr_b16 v[58:59], v70 offset:25344
    v_mfma_f32_16x16x32_bf16 v[84:87], v[96:99], v[128:131], 0
    ds_read_b128 v[12:15], v81 offset:8192
    v_mfma_f32_16x16x32_bf16 v[4:7], v[60:63], v[60:63], 0
    s_xor_b32 s51, s56, 3
    s_mul_i32 s51, s51, 196608
    s_add_u32 m0, s59, 122880
    s_add_u32 s51, s47, s51
    buffer_load_dwordx4 v72, s[12:15], s51 offen offset:0 lds
    s_waitcnt lgkmcnt(4)
    v_mfma_f32_32x32x16_bf16 v[16:31], v[52:55], v[132:135], v[16:31]
    ds_read_b128 v[140:143], v67 offset:8192
    ds_read_b64_tr_b16 v[48:49], v71 offset:24576
    ds_read_b64_tr_b16 v[50:51], v71 offset:25344
    v_mfma_f32_16x16x32_bf16 v[84:87], v[96:99], v[132:135], v[84:87]
    ds_read_b128 v[60:63], v81 offset:10240
    v_mfma_f32_16x16x32_bf16 v[92:95], v[8:11], v[8:11], 0
    buffer_load_dwordx4 v73, s[12:15], s51 offen offset:1024 lds
    s_waitcnt vmcnt(5)
    s_barrier
    s_waitcnt lgkmcnt(4)
    v_mfma_f32_32x32x16_bf16 v[16:31], v[56:59], v[136:139], v[16:31]
    ds_read_b128 v[144:147], v64 offset:40960
    ds_read_b64_tr_b16 v[52:53], v68 offset:57344
    ds_read_b64_tr_b16 v[54:55], v68 offset:58112
    v_mfma_f32_16x16x32_bf16 v[84:87], v[96:99], v[136:139], v[84:87]
    ds_read_b128 v[8:11], v80 offset:40960
    v_mfma_f32_16x16x32_bf16 v[4:7], v[12:15], v[12:15], v[4:7]
    buffer_load_dwordx4 v74, s[12:15], s51 offen offset:2048 lds
    s_waitcnt lgkmcnt(4)
    v_mfma_f32_32x32x16_bf16 v[16:31], v[48:51], v[140:143], v[16:31]
    ds_read_b128 v[148:151], v65 offset:40960
    ds_read_b64_tr_b16 v[56:57], v69 offset:57344
    ds_read_b64_tr_b16 v[58:59], v69 offset:58112
    v_mfma_f32_16x16x32_bf16 v[84:87], v[96:99], v[140:143], v[84:87]
    ds_read_b128 v[12:15], v80 offset:43008
    v_mfma_f32_16x16x32_bf16 v[92:95], v[60:63], v[60:63], v[92:95]
    global_load_dword v117, v116, s[16:17]
    v_mfma_f32_16x16x32_bf16 v[88:91], v[96:99], v[48:51], 0
    s_waitcnt lgkmcnt(4)
    v_mfma_f32_32x32x16_bf16 v[16:31], v[52:55], v[144:147], v[16:31]
    ds_read_b128 v[152:155], v66 offset:40960
    ds_read_b64_tr_b16 v[48:49], v70 offset:57344
    ds_read_b64_tr_b16 v[50:51], v70 offset:58112
    v_mfma_f32_16x16x32_bf16 v[84:87], v[96:99], v[144:147], v[84:87]
    ds_read_b128 v[60:63], v81 offset:40960
    v_mfma_f32_16x16x32_bf16 v[4:7], v[8:11], v[8:11], v[4:7]
    global_load_ushort v108, v109, s[36:37]
    global_load_ushort v109, v109, s[36:37] offset:64
    s_waitcnt lgkmcnt(4)
    v_mfma_f32_32x32x16_bf16 v[16:31], v[56:59], v[148:151], v[16:31]
    ds_read_b128 v[156:159], v67 offset:40960
    ds_read_b64_tr_b16 v[52:53], v71 offset:57344
    ds_read_b64_tr_b16 v[54:55], v71 offset:58112
    v_mfma_f32_16x16x32_bf16 v[84:87], v[96:99], v[148:151], v[84:87]
    ds_read_b128 v[8:11], v81 offset:43008
    v_mfma_f32_16x16x32_bf16 v[92:95], v[12:15], v[12:15], v[92:95]
    v_xor_b32 v64, 0x10000, v64
    v_xor_b32 v68, 0x10000, v68
    v_xor_b32 v80, 0x10000, v80
    s_waitcnt vmcnt(6)
    s_barrier
    s_waitcnt lgkmcnt(4)
    v_mfma_f32_32x32x16_bf16 v[16:31], v[48:51], v[152:155], v[16:31]
    ds_read_b128 v[160:163], v64 offset:8192
    ds_read_b64_tr_b16 v[56:57], v68 offset:24576
    ds_read_b64_tr_b16 v[58:59], v68 offset:25344
    v_mfma_f32_16x16x32_bf16 v[84:87], v[96:99], v[152:155], v[84:87]
    ds_read_b128 v[12:15], v80 offset:8192
    v_mfma_f32_16x16x32_bf16 v[4:7], v[60:63], v[60:63], v[4:7]
    s_xor_b32 s51, s56, 4
    s_mul_i32 s51, s51, 196608
    s_add_u32 m0, s59, 24576
    s_add_u32 s51, s47, s51
    buffer_load_dwordx4 v72, s[12:15], s51 offen offset:0 lds
    v_xor_b32 v65, 0x10000, v65
    v_xor_b32 v69, 0x10000, v69
    s_waitcnt lgkmcnt(4)
    v_mfma_f32_32x32x16_bf16 v[16:31], v[52:55], v[156:159], v[16:31]
    ds_read_b128 v[164:167], v65 offset:8192
    ds_read_b64_tr_b16 v[48:49], v69 offset:24576
    ds_read_b64_tr_b16 v[50:51], v69 offset:25344
    v_mfma_f32_16x16x32_bf16 v[84:87], v[96:99], v[156:159], v[84:87]
    ds_read_b128 v[60:63], v80 offset:10240
    v_mfma_f32_16x16x32_bf16 v[92:95], v[8:11], v[8:11], v[92:95]
    buffer_load_dwordx4 v73, s[12:15], s51 offen offset:1024 lds
    v_mfma_f32_16x16x32_bf16 v[88:91], v[96:99], v[52:55], v[88:91]
    v_xor_b32 v66, 0x10000, v66
    v_xor_b32 v70, 0x10000, v70
    v_xor_b32 v81, 0x10000, v81
    s_waitcnt lgkmcnt(4)
    v_mfma_f32_32x32x16_bf16 v[16:31], v[56:59], v[160:163], v[16:31]
    ds_read_b128 v[168:171], v66 offset:8192
    ds_read_b64_tr_b16 v[52:53], v70 offset:24576
    ds_read_b64_tr_b16 v[54:55], v70 offset:25344
    v_mfma_f32_16x16x32_bf16 v[84:87], v[96:99], v[160:163], v[84:87]
    ds_read_b128 v[8:11], v81 offset:8192
    v_mfma_f32_16x16x32_bf16 v[4:7], v[12:15], v[12:15], v[4:7]
    buffer_load_dwordx4 v74, s[12:15], s51 offen offset:2048 lds
    v_xor_b32 v67, 0x10000, v67
    v_xor_b32 v71, 0x10000, v71
    s_waitcnt lgkmcnt(4)
    v_mfma_f32_32x32x16_bf16 v[16:31], v[48:51], v[164:167], v[16:31]
    ds_read_b128 v[172:175], v67 offset:8192
    ds_read_b64_tr_b16 v[56:57], v71 offset:24576
    ds_read_b64_tr_b16 v[58:59], v71 offset:25344
    v_mfma_f32_16x16x32_bf16 v[84:87], v[96:99], v[164:167], v[84:87]
    ds_read_b128 v[12:15], v81 offset:10240
    v_mfma_f32_16x16x32_bf16 v[92:95], v[60:63], v[60:63], v[92:95]
    s_waitcnt vmcnt(6)
    s_barrier
    s_waitcnt lgkmcnt(4)
    v_mfma_f32_32x32x16_bf16 v[16:31], v[52:55], v[168:171], v[16:31]
    ds_read_b128 v[176:179], v64 offset:40960
    ds_read_b64_tr_b16 v[48:49], v68 offset:57344
    ds_read_b64_tr_b16 v[50:51], v68 offset:58112
    v_mfma_f32_16x16x32_bf16 v[84:87], v[96:99], v[168:171], v[84:87]
    ds_read_b128 v[60:63], v80 offset:40960
    v_mfma_f32_16x16x32_bf16 v[4:7], v[8:11], v[8:11], v[4:7]
    s_xor_b32 s51, s56, 5
    s_mul_i32 s51, s51, 196608
    s_add_u32 m0, s59, 57344
    s_add_u32 s51, s47, s51
    buffer_load_dwordx4 v72, s[12:15], s51 offen offset:0 lds
    s_waitcnt lgkmcnt(4)
    v_mfma_f32_32x32x16_bf16 v[16:31], v[56:59], v[172:175], v[16:31]
    ds_read_b128 v[180:183], v65 offset:40960
    ds_read_b64_tr_b16 v[52:53], v69 offset:57344
    ds_read_b64_tr_b16 v[54:55], v69 offset:58112
    v_mfma_f32_16x16x32_bf16 v[84:87], v[96:99], v[172:175], v[84:87]
    ds_read_b128 v[8:11], v80 offset:43008
    v_mfma_f32_16x16x32_bf16 v[92:95], v[12:15], v[12:15], v[92:95]
    buffer_load_dwordx4 v73, s[12:15], s51 offen offset:1024 lds
    v_mfma_f32_16x16x32_bf16 v[88:91], v[96:99], v[56:59], v[88:91]
    s_waitcnt lgkmcnt(4)
    v_mfma_f32_32x32x16_bf16 v[16:31], v[48:51], v[176:179], v[16:31]
    ds_read_b128 v[184:187], v66 offset:40960
    ds_read_b64_tr_b16 v[56:57], v70 offset:57344
    ds_read_b64_tr_b16 v[58:59], v70 offset:58112
    v_mfma_f32_16x16x32_bf16 v[84:87], v[96:99], v[176:179], v[84:87]
    ds_read_b128 v[12:15], v81 offset:40960
    v_mfma_f32_16x16x32_bf16 v[4:7], v[60:63], v[60:63], v[4:7]
    buffer_load_dwordx4 v74, s[12:15], s51 offen offset:2048 lds
    s_waitcnt lgkmcnt(4)
    v_mfma_f32_32x32x16_bf16 v[16:31], v[52:55], v[180:183], v[16:31]
    ds_read_b128 v[188:191], v67 offset:40960
    ds_read_b64_tr_b16 v[48:49], v71 offset:57344
    ds_read_b64_tr_b16 v[50:51], v71 offset:58112
    v_mfma_f32_16x16x32_bf16 v[84:87], v[96:99], v[180:183], v[84:87]
    ds_read_b128 v[60:63], v81 offset:43008
    v_mfma_f32_16x16x32_bf16 v[92:95], v[8:11], v[8:11], v[92:95]
    v_xor_b32 v64, 0x10000, v64
    v_xor_b32 v68, 0x10000, v68
    v_xor_b32 v80, 0x10000, v80
    s_waitcnt vmcnt(3)
    s_barrier
    s_waitcnt lgkmcnt(4)
    v_mfma_f32_32x32x16_bf16 v[16:31], v[56:59], v[184:187], v[16:31]
    ds_read_b128 v[192:195], v64 offset:8192
    ds_read_b64_tr_b16 v[52:53], v68 offset:24576
    ds_read_b64_tr_b16 v[54:55], v68 offset:25344
    v_mfma_f32_16x16x32_bf16 v[84:87], v[96:99], v[184:187], v[84:87]
    ds_read_b128 v[8:11], v80 offset:8192
    v_mfma_f32_16x16x32_bf16 v[4:7], v[12:15], v[12:15], v[4:7]
    s_xor_b32 s51, s56, 6
    s_mul_i32 s51, s51, 196608
    s_add_u32 m0, s59, 90112
    s_add_u32 s51, s47, s51
    buffer_load_dwordx4 v72, s[12:15], s51 offen offset:0 lds
    v_xor_b32 v65, 0x10000, v65
    v_xor_b32 v69, 0x10000, v69
    s_waitcnt lgkmcnt(4)
    v_mfma_f32_32x32x16_bf16 v[16:31], v[48:51], v[188:191], v[16:31]
    ds_read_b128 v[196:199], v65 offset:8192
    ds_read_b64_tr_b16 v[56:57], v69 offset:24576
    ds_read_b64_tr_b16 v[58:59], v69 offset:25344
    v_mfma_f32_16x16x32_bf16 v[84:87], v[96:99], v[188:191], v[84:87]
    ds_read_b128 v[12:15], v80 offset:10240
    v_mfma_f32_16x16x32_bf16 v[92:95], v[60:63], v[60:63], v[92:95]
    buffer_load_dwordx4 v73, s[12:15], s51 offen offset:1024 lds
    v_mfma_f32_16x16x32_bf16 v[88:91], v[96:99], v[48:51], v[88:91]
    v_xor_b32 v66, 0x10000, v66
    v_xor_b32 v70, 0x10000, v70
    v_xor_b32 v81, 0x10000, v81
    s_waitcnt lgkmcnt(4)
    v_mfma_f32_32x32x16_bf16 v[16:31], v[52:55], v[192:195], v[16:31]
    ds_read_b128 v[200:203], v66 offset:8192
    ds_read_b64_tr_b16 v[48:49], v70 offset:24576
    ds_read_b64_tr_b16 v[50:51], v70 offset:25344
    v_mfma_f32_16x16x32_bf16 v[84:87], v[96:99], v[192:195], v[84:87]
    ds_read_b128 v[60:63], v81 offset:8192
    v_mfma_f32_16x16x32_bf16 v[4:7], v[8:11], v[8:11], v[4:7]
    buffer_load_dwordx4 v74, s[12:15], s51 offen offset:2048 lds
    v_xor_b32 v67, 0x10000, v67
    v_xor_b32 v71, 0x10000, v71
    s_waitcnt lgkmcnt(4)
    v_mfma_f32_32x32x16_bf16 v[16:31], v[56:59], v[196:199], v[16:31]
    ds_read_b128 v[204:207], v67 offset:8192
    ds_read_b64_tr_b16 v[52:53], v71 offset:24576
    ds_read_b64_tr_b16 v[54:55], v71 offset:25344
    v_mfma_f32_16x16x32_bf16 v[84:87], v[96:99], v[196:199], v[84:87]
    ds_read_b128 v[8:11], v81 offset:10240
    v_mfma_f32_16x16x32_bf16 v[92:95], v[12:15], v[12:15], v[92:95]
    s_waitcnt vmcnt(3)
    s_barrier
    s_waitcnt lgkmcnt(4)
    v_mfma_f32_32x32x16_bf16 v[16:31], v[48:51], v[200:203], v[16:31]
    ds_read_b128 v[208:211], v64 offset:40960
    ds_read_b64_tr_b16 v[56:57], v68 offset:57344
    ds_read_b64_tr_b16 v[58:59], v68 offset:58112
    v_mfma_f32_16x16x32_bf16 v[84:87], v[96:99], v[200:203], v[84:87]
    ds_read_b128 v[12:15], v80 offset:40960
    v_mfma_f32_16x16x32_bf16 v[4:7], v[60:63], v[60:63], v[4:7]
    s_xor_b32 s51, s56, 7
    s_mul_i32 s51, s51, 196608
    s_add_u32 m0, s59, 147456
    s_add_u32 s51, s47, s51
    buffer_load_dwordx4 v72, s[12:15], s51 offen offset:0 lds
    buffer_load_dwordx4 v73, s[12:15], s51 offen offset:1024 lds
    s_waitcnt lgkmcnt(4)
    v_mfma_f32_32x32x16_bf16 v[16:31], v[52:55], v[204:207], v[16:31]
    ds_read_b128 v[212:215], v65 offset:40960
    ds_read_b64_tr_b16 v[48:49], v69 offset:57344
    ds_read_b64_tr_b16 v[50:51], v69 offset:58112
    v_mfma_f32_16x16x32_bf16 v[84:87], v[96:99], v[204:207], v[84:87]
    ds_read_b128 v[60:63], v80 offset:43008
    v_mfma_f32_16x16x32_bf16 v[92:95], v[8:11], v[8:11], v[92:95]
    buffer_load_dwordx4 v74, s[12:15], s51 offen offset:2048 lds
    v_mfma_f32_16x16x32_bf16 v[88:91], v[96:99], v[52:55], v[88:91]
    s_waitcnt lgkmcnt(4)
    v_mfma_f32_32x32x16_bf16 v[16:31], v[56:59], v[208:211], v[16:31]
    ds_read_b128 v[216:219], v66 offset:40960
    ds_read_b64_tr_b16 v[52:53], v70 offset:57344
    ds_read_b64_tr_b16 v[54:55], v70 offset:58112
    v_mfma_f32_16x16x32_bf16 v[84:87], v[96:99], v[208:211], v[84:87]
    ds_read_b128 v[8:11], v81 offset:40960
    v_mfma_f32_16x16x32_bf16 v[4:7], v[12:15], v[12:15], v[4:7]
    s_xor_b32 s51, s56, 0
    s_mul_i32 s51, s51, 229376
    s_add_u32 m0, s100, 106496
    s_add_u32 s51, s101, s51
    buffer_load_dwordx4 v76, s[16:19], s51 offen offset:0 lds
    s_waitcnt lgkmcnt(4)
    v_mfma_f32_32x32x16_bf16 v[16:31], v[48:51], v[212:215], v[16:31]
    ds_read_b128 v[220:223], v67 offset:40960
    ds_read_b64_tr_b16 v[56:57], v71 offset:57344
    ds_read_b64_tr_b16 v[58:59], v71 offset:58112
    v_mfma_f32_16x16x32_bf16 v[84:87], v[96:99], v[212:215], v[84:87]
    ds_read_b128 v[12:15], v81 offset:43008
    v_mfma_f32_16x16x32_bf16 v[92:95], v[60:63], v[60:63], v[92:95]
    buffer_load_dwordx4 v77, s[16:19], s51 offen offset:1024 lds
    v_xor_b32 v64, 0x10000, v64
    v_xor_b32 v68, 0x10000, v68
    v_xor_b32 v80, 0x10000, v80
    s_waitcnt vmcnt(5)
    s_barrier
    s_waitcnt lgkmcnt(4)
    v_mfma_f32_32x32x16_bf16 v[16:31], v[52:55], v[216:219], v[16:31]
    ds_read_b128 v[224:227], v64 offset:8192
    ds_read_b64_tr_b16 v[48:49], v68 offset:24576
    ds_read_b64_tr_b16 v[50:51], v68 offset:25344
    v_mfma_f32_16x16x32_bf16 v[84:87], v[96:99], v[216:219], v[84:87]
    ds_read_b128 v[60:63], v80 offset:8192
    v_mfma_f32_16x16x32_bf16 v[4:7], v[8:11], v[8:11], v[4:7]
    buffer_load_dwordx4 v78, s[16:19], s51 offen offset:2048 lds
    buffer_load_dwordx4 v79, s[16:19], s51 offen offset:3072 lds
    v_xor_b32 v65, 0x10000, v65
    v_xor_b32 v69, 0x10000, v69
    s_waitcnt lgkmcnt(4)
    v_mfma_f32_32x32x16_bf16 v[16:31], v[56:59], v[220:223], v[16:31]
    ds_read_b128 v[228:231], v65 offset:8192
    ds_read_b64_tr_b16 v[52:53], v69 offset:24576
    ds_read_b64_tr_b16 v[54:55], v69 offset:25344
    v_mfma_f32_16x16x32_bf16 v[84:87], v[96:99], v[220:223], v[84:87]
    ds_read_b128 v[8:11], v80 offset:10240
    v_mfma_f32_16x16x32_bf16 v[92:95], v[12:15], v[12:15], v[92:95]
    s_xor_b32 s51, s56, 2
    s_mul_i32 s51, s51, 229376
    s_add_u32 m0, s100, 8192
    s_add_u32 s51, s101, s51
    buffer_load_dwordx4 v76, s[16:19], s51 offen offset:0 lds
    v_mfma_f32_16x16x32_bf16 v[88:91], v[96:99], v[56:59], v[88:91]
    v_xor_b32 v66, 0x10000, v66
    v_xor_b32 v70, 0x10000, v70
    v_xor_b32 v81, 0x10000, v81
    s_waitcnt lgkmcnt(4)
    v_mfma_f32_32x32x16_bf16 v[16:31], v[48:51], v[224:227], v[16:31]
    ds_read_b128 v[232:235], v66 offset:8192
    ds_read_b64_tr_b16 v[56:57], v70 offset:24576
    ds_read_b64_tr_b16 v[58:59], v70 offset:25344
    v_mfma_f32_16x16x32_bf16 v[84:87], v[96:99], v[224:227], v[84:87]
    ds_read_b128 v[12:15], v81 offset:8192
    v_mfma_f32_16x16x32_bf16 v[4:7], v[60:63], v[60:63], v[4:7]
    buffer_load_dwordx4 v77, s[16:19], s51 offen offset:1024 lds
    v_xor_b32 v67, 0x10000, v67
    v_xor_b32 v71, 0x10000, v71
    s_waitcnt lgkmcnt(4)
    v_mfma_f32_32x32x16_bf16 v[16:31], v[52:55], v[228:231], v[16:31]
    ds_read_b128 v[236:239], v67 offset:8192
    ds_read_b64_tr_b16 v[48:49], v71 offset:24576
    ds_read_b64_tr_b16 v[50:51], v71 offset:25344
    v_mfma_f32_16x16x32_bf16 v[84:87], v[96:99], v[228:231], v[84:87]
    ds_read_b128 v[60:63], v81 offset:10240
    v_mfma_f32_16x16x32_bf16 v[92:95], v[8:11], v[8:11], v[92:95]
    buffer_load_dwordx4 v78, s[16:19], s51 offen offset:2048 lds
    v_add_u32 v64, s52, v64
    v_add_u32 v68, 81920, v68
    v_add_u32 v80, s52, v80
    s_waitcnt vmcnt(7)
    s_barrier
    s_waitcnt lgkmcnt(4)
    v_mfma_f32_32x32x16_bf16 v[16:31], v[56:59], v[232:235], v[16:31]
    ds_read_b128 v[240:243], v64 offset:0
    ds_read_b64_tr_b16 v[52:53], v68 offset:0
    ds_read_b64_tr_b16 v[54:55], v68 offset:768
    v_mfma_f32_16x16x32_bf16 v[84:87], v[96:99], v[232:235], v[84:87]
    ds_read_b128 v[8:11], v80 offset:0
    v_mfma_f32_16x16x32_bf16 v[4:7], v[12:15], v[12:15], v[4:7]
    buffer_load_dwordx4 v79, s[16:19], s51 offen offset:3072 lds
    s_xor_b32 s51, s56, 4
    s_mul_i32 s51, s51, 229376
    s_add_u32 m0, s100, 40960
    s_add_u32 s51, s101, s51
    buffer_load_dwordx4 v76, s[16:19], s51 offen offset:0 lds
    v_add_u32 v65, s52, v65
    v_add_u32 v69, 81920, v69
    s_waitcnt lgkmcnt(4)
    v_mfma_f32_32x32x16_bf16 v[16:31], v[48:51], v[236:239], v[16:31]
    ds_read_b128 v[244:247], v65 offset:0
    ds_read_b64_tr_b16 v[56:57], v69 offset:0
    ds_read_b64_tr_b16 v[58:59], v69 offset:768
    v_mfma_f32_16x16x32_bf16 v[84:87], v[96:99], v[236:239], v[84:87]
    ds_read_b128 v[12:15], v80 offset:2048
    v_mfma_f32_16x16x32_bf16 v[92:95], v[60:63], v[60:63], v[92:95]
    buffer_load_dwordx4 v77, s[16:19], s51 offen offset:1024 lds
    v_mfma_f32_16x16x32_bf16 v[88:91], v[96:99], v[48:51], v[88:91]
    v_add_u32 v66, s52, v66
    v_add_u32 v70, 81920, v70
    v_add_u32 v81, s52, v81
    s_waitcnt lgkmcnt(4)
    v_mfma_f32_32x32x16_bf16 v[16:31], v[52:55], v[240:243], v[16:31]
    ds_read_b128 v[248:251], v66 offset:0
    ds_read_b64_tr_b16 v[48:49], v70 offset:0
    ds_read_b64_tr_b16 v[50:51], v70 offset:768
    v_mfma_f32_16x16x32_bf16 v[84:87], v[96:99], v[240:243], v[84:87]
    ds_read_b128 v[60:63], v81 offset:0
    v_mfma_f32_16x16x32_bf16 v[4:7], v[8:11], v[8:11], v[4:7]
    buffer_load_dwordx4 v78, s[16:19], s51 offen offset:2048 lds
    v_add_u32 v67, s52, v67
    v_add_u32 v71, 81920, v71
    s_waitcnt lgkmcnt(4)
    v_mfma_f32_32x32x16_bf16 v[16:31], v[56:59], v[244:247], v[16:31]
    ds_read_b128 v[252:255], v67 offset:0
    ds_read_b64_tr_b16 v[52:53], v71 offset:0
    ds_read_b64_tr_b16 v[54:55], v71 offset:768
    v_mfma_f32_16x16x32_bf16 v[84:87], v[96:99], v[244:247], v[84:87]
    ds_read_b128 v[8:11], v81 offset:2048
    v_mfma_f32_16x16x32_bf16 v[92:95], v[12:15], v[12:15], v[92:95]
    buffer_load_dwordx4 v79, s[16:19], s51 offen offset:3072 lds
    s_barrier
    s_waitcnt lgkmcnt(4)
    v_mfma_f32_32x32x16_bf16 v[16:31], v[48:51], v[248:251], v[16:31]
    v_mfma_f32_16x16x32_bf16 v[84:87], v[96:99], v[248:251], v[84:87]
    v_mfma_f32_16x16x32_bf16 v[4:7], v[60:63], v[60:63], v[4:7]
    global_load_dword v3, v110, s[40:41] sc1
    s_xor_b32 s51, s56, 6
    s_mul_i32 s51, s51, 229376
    s_add_u32 m0, s100, 73728
    s_add_u32 s51, s101, s51
    buffer_load_dwordx4 v76, s[16:19], s51 offen offset:0 lds
    s_waitcnt lgkmcnt(0)
    v_mfma_f32_32x32x16_bf16 v[16:31], v[52:55], v[252:255], v[16:31]
    v_mfma_f32_16x16x32_bf16 v[84:87], v[96:99], v[252:255], v[84:87]
    v_mfma_f32_16x16x32_bf16 v[92:95], v[8:11], v[8:11], v[92:95]
    buffer_load_dwordx4 v77, s[16:19], s51 offen offset:1024 lds
    buffer_load_dwordx4 v78, s[16:19], s51 offen offset:2048 lds
    v_mfma_f32_16x16x32_bf16 v[88:91], v[96:99], v[52:55], v[88:91]
    buffer_load_dwordx4 v79, s[16:19], s51 offen offset:3072 lds
    s_lshl_b32 s50, s44, 8
    s_add_u32 s51, s50, 159744
    v_lshl_add_u32 v116, v0, 3, s51
    v_lshlrev_b32 v117, 4, v0
    v_add_u32 v117, 161792, v117
    s_lshl_b32 s50, s44, 2
    v_add_u32 v118, s50, v117
    s_mul_i32 s52, s43, 3
    s_add_u32 s52, s52, 2
    s_lshl_b32 s55, s52, 17
    s_lshl_b32 s50, s42, 2
    s_add_u32 s50, s50, s44
    s_mul_i32 s54, s50, 114688
    s_lshl_b32 s50, s50, 10
    s_add_u32 s55, s55, s50
    ds_write_b32 v118, v88
    ds_write_b32 v116, v84
    s_mov_b32 vcc_lo, 0xaaaaaaaa
    s_mov_b32 vcc_hi, 0xaaaaaaaa
    s_mov_b32 s4, 0xcccccccc
    s_mov_b32 s5, 0xcccccccc
    v_and_b32 v119, 15, v1
    v_lshl_add_u32 v119, v119, 3, s51
    v_cndmask_b32 v4, v4, v5, vcc
    v_cndmask_b32 v6, v6, v7, vcc
    v_cndmask_b32 v4, v4, v6, s[4:5]
    v_cndmask_b32 v92, v92, v93, vcc
    v_cndmask_b32 v94, v94, v95, vcc
    v_cndmask_b32 v92, v92, v94, s[4:5]
    s_mov_b32 exec_lo, 0x00f0000f
    s_mov_b32 exec_hi, 0xf0000f00
    ds_write_b32 v119, v4 offset:4
    ds_write_b32 v119, v92 offset:132
    s_mov_b64 exec, -1
    s_lshl_b32 s50, s48, 5
    s_add_u32 s54, s54, s50
    s_add_u32 s54, s54, 10489856
    s_waitcnt vmcnt(9) lgkmcnt(0)
    s_barrier
    ds_read_b64 v[8:9], v116
    ds_read_b128 v[88:91], v117
    s_setprio 3
    s_waitcnt lgkmcnt(0)
    v_mul_f32 v8, 0xbb000000, v8
    v_mul_f32 v9, 0x3b000000, v9
    v_add_f32 v88, v88, v89
    v_fma_f32 v9, -v8, v8, v9
    v_add_f32 v90, v90, v91
    v_max_f32 v82, 0, v9
    v_add_f32 v13, v88, v90
    v_add_f32 v9, 0x3727c5ac, v82
    v_rsq_f32 v111, v9
    v_cvt_pk_bf16_f32 v10, v8, v8
    v_and_b32 v10, 0xffff0000, v10
    v_sub_f32 v11, v8, v10
    v_cvt_pk_bf16_f32 v12, v10, v11
    v_cndmask_b32 v100, 0, v12, s[6:7]
    v_cndmask_b32 v101, 0, v12, s[6:7]
    v_cvt_pk_bf16_f32 v104, v13, v13
    v_and_b32 v10, 0xffff0000, v104
    v_sub_f32 v10, v13, v10
    v_cvt_pk_bf16_f32 v105, v10, v10
    s_cmp_lt_u32 s52, 16
    s_cselect_b32 s50, 0x3eb8aa3b, 1.0
    v_mfma_f32_32x32x16_bf16 v[16:31], v[104:107], v[100:103], v[16:31]
    v_mul_f32 v13, s50, v111
    s_nop 7
    s_nop 3
    v_mul_f32 v16, v16, v13
    v_mul_f32 v17, v17, v13
    v_mul_f32 v18, v18, v13
    v_mul_f32 v19, v19, v13
    v_mul_f32 v20, v20, v13
    v_mul_f32 v21, v21, v13
    v_mul_f32 v22, v22, v13
    v_mul_f32 v23, v23, v13
    v_mul_f32 v24, v24, v13
    v_mul_f32 v25, v25, v13
    v_mul_f32 v26, v26, v13
    v_mul_f32 v27, v27, v13
    v_mul_f32 v28, v28, v13
    v_mul_f32 v29, v29, v13
    v_mul_f32 v30, v30, v13
    v_mul_f32 v31, v31, v13
    v_cvt_pk_bf16_f32 v16, v16, v17
    v_cvt_pk_bf16_f32 v17, v18, v19
    v_cvt_pk_bf16_f32 v18, v20, v21
    v_cvt_pk_bf16_f32 v19, v22, v23
    v_cvt_pk_bf16_f32 v20, v24, v25
    v_cvt_pk_bf16_f32 v21, v26, v27
    v_cvt_pk_bf16_f32 v22, v28, v29
    v_cvt_pk_bf16_f32 v23, v30, v31
    s_add_u32 s50, s55, 0
    buffer_store_dwordx4 v[16:19], v2, s[20:23], s50 offen sc1
    s_add_u32 s50, s55, 65536
    buffer_store_dwordx4 v[20:23], v2, s[20:23], s50 offen sc1
    s_waitcnt vmcnt(2)
    s_barrier
    s_branch L_f1
L_p1n1:
    s_setprio 1
    s_waitcnt lgkmcnt(4)
    v_mfma_f32_32x32x16_bf16 v[16:31], v[128:131], v[48:51], 0
    ds_read_b128 v[136:139], v66 offset:8192
    ds_read_b64_tr_b16 v[56:57], v70 offset:24576
    ds_read_b64_tr_b16 v[58:59], v70 offset:25344
    v_mfma_f32_16x16x32_bf16 v[84:87], v[96:99], v[128:131], 0
    ds_read_b128 v[12:15], v81 offset:8192
    v_mfma_f32_16x16x32_bf16 v[4:7], v[60:63], v[60:63], 0
    s_xor_b32 s51, s56, 3
    s_mul_i32 s51, s51, 196608
    s_add_u32 m0, s59, 122880
    s_add_u32 s51, s47, s51
    buffer_load_dwordx4 v72, s[12:15], s51 offen offset:0 lds
    s_waitcnt lgkmcnt(4)
    v_mfma_f32_32x32x16_bf16 v[16:31], v[132:135], v[52:55], v[16:31]
    ds_read_b128 v[140:143], v67 offset:8192
    ds_read_b64_tr_b16 v[48:49], v71 offset:24576
    ds_read_b64_tr_b16 v[50:51], v71 offset:25344
    v_mfma_f32_16x16x32_bf16 v[84:87], v[96:99], v[132:135], v[84:87]
    ds_read_b128 v[60:63], v81 offset:10240
    v_mfma_f32_16x16x32_bf16 v[92:95], v[8:11], v[8:11], 0
    buffer_load_dwordx4 v73, s[12:15], s51 offen offset:1024 lds
    s_waitcnt vmcnt(5)
    s_barrier
    s_waitcnt lgkmcnt(4)
    v_mfma_f32_32x32x16_bf16 v[16:31], v[136:139], v[56:59], v[16:31]
    ds_read_b128 v[144:147], v64 offset:40960
    ds_read_b64_tr_b16 v[52:53], v68 offset:57344
    ds_read_b64_tr_b16 v[54:55], v68 offset:58112
    v_mfma_f32_16x16x32_bf16 v[84:87], v[96:99], v[136:139], v[84:87]
    ds_read_b128 v[8:11], v80 offset:40960
    v_mfma_f32_16x16x32_bf16 v[4:7], v[12:15], v[12:15], v[4:7]
    buffer_load_dwordx4 v74, s[12:15], s51 offen offset:2048 lds
    s_waitcnt lgkmcnt(4)
    v_mfma_f32_32x32x16_bf16 v[16:31], v[140:143], v[48:51], v[16:31]
    ds_read_b128 v[148:151], v65 offset:40960
    ds_read_b64_tr_b16 v[56:57], v69 offset:57344
    ds_read_b64_tr_b16 v[58:59], v69 offset:58112
    v_mfma_f32_16x16x32_bf16 v[84:87], v[96:99], v[140:143], v[84:87]
    ds_read_b128 v[12:15], v80 offset:43008
    v_mfma_f32_16x16x32_bf16 v[92:95], v[60:63], v[60:63], v[92:95]
    global_load_dword v117, v116, s[16:17]
    v_mfma_f32_16x16x32_bf16 v[88:91], v[96:99], v[48:51], 0
    s_waitcnt lgkmcnt(4)
    v_mfma_f32_32x32x16_bf16 v[16:31], v[144:147], v[52:55], v[16:31]
    ds_read_b128 v[152:155], v66 offset:40960
    ds_read_b64_tr_b16 v[48:49], v70 offset:57344
    ds_read_b64_tr_b16 v[50:51], v70 offset:58112
    v_mfma_f32_16x16x32_bf16 v[84:87], v[96:99], v[144:147], v[84:87]
    ds_read_b128 v[60:63], v81 offset:40960
    v_mfma_f32_16x16x32_bf16 v[4:7], v[8:11], v[8:11], v[4:7]
    global_load_ushort v108, v109, s[36:37]
    global_load_ushort v109, v109, s[36:37] offset:64
    s_waitcnt lgkmcnt(4)
    v_mfma_f32_32x32x16_bf16 v[16:31], v[148:151], v[56:59], v[16:31]
    ds_read_b128 v[156:159], v67 offset:40960
    ds_read_b64_tr_b16 v[52:53], v71 offset:57344
    ds_read_b64_tr_b16 v[54:55], v71 offset:58112
    v_mfma_f32_16x16x32_bf16 v[84:87], v[96:99], v[148:151], v[84:87]
    ds_read_b128 v[8:11], v81 offset:43008
    v_mfma_f32_16x16x32_bf16 v[92:95], v[12:15], v[12:15], v[92:95]
    v_xor_b32 v64, 0x10000, v64
    v_xor_b32 v68, 0x10000, v68
    v_xor_b32 v80, 0x10000, v80
    s_waitcnt vmcnt(6)
    s_barrier
    s_waitcnt lgkmcnt(4)
    v_mfma_f32_32x32x16_bf16 v[16:31], v[152:155], v[48:51], v[16:31]
    ds_read_b128 v[160:163], v64 offset:8192
    ds_read_b64_tr_b16 v[56:57], v68 offset:24576
    ds_read_b64_tr_b16 v[58:59], v68 offset:25344
    v_mfma_f32_16x16x32_bf16 v[84:87], v[96:99], v[152:155], v[84:87]
    ds_read_b128 v[12:15], v80 offset:8192
    v_mfma_f32_16x16x32_bf16 v[4:7], v[60:63], v[60:63], v[4:7]
    s_xor_b32 s51, s56, 4
    s_mul_i32 s51, s51, 196608
    s_add_u32 m0, s59, 24576
    s_add_u32 s51, s47, s51
    buffer_load_dwordx4 v72, s[12:15], s51 offen offset:0 lds
    v_xor_b32 v65, 0x10000, v65
    v_xor_b32 v69, 0x10000, v69
    s_waitcnt lgkmcnt(4)
    v_mfma_f32_32x32x16_bf16 v[16:31], v[156:159], v[52:55], v[16:31]
    ds_read_b128 v[164:167], v65 offset:8192
    ds_read_b64_tr_b16 v[48:49], v69 offset:24576
    ds_read_b64_tr_b16 v[50:51], v69 offset:25344
    v_mfma_f32_16x16x32_bf16 v[84:87], v[96:99], v[156:159], v[84:87]
    ds_read_b128 v[60:63], v80 offset:10240
    v_mfma_f32_16x16x32_bf16 v[92:95], v[8:11], v[8:11], v[92:95]
    buffer_load_dwordx4 v73, s[12:15], s51 offen offset:1024 lds
    v_mfma_f32_16x16x32_bf16 v[88:91], v[96:99], v[52:55], v[88:91]
    v_xor_b32 v66, 0x10000, v66
    v_xor_b32 v70, 0x10000, v70
    v_xor_b32 v81, 0x10000, v81
    s_waitcnt lgkmcnt(4)
    v_mfma_f32_32x32x16_bf16 v[16:31], v[160:163], v[56:59], v[16:31]
    ds_read_b128 v[168:171], v66 offset:8192
    ds_read_b64_tr_b16 v[52:53], v70 offset:24576
    ds_read_b64_tr_b16 v[54:55], v70 offset:25344
    v_mfma_f32_16x16x32_bf16 v[84:87], v[96:99], v[160:163], v[84:87]
    ds_read_b128 v[8:11], v81 offset:8192
    v_mfma_f32_16x16x32_bf16 v[4:7], v[12:15], v[12:15], v[4:7]
    buffer_load_dwordx4 v74, s[12:15], s51 offen offset:2048 lds
    v_xor_b32 v67, 0x10000, v67
    v_xor_b32 v71, 0x10000, v71
    s_waitcnt lgkmcnt(4)
    v_mfma_f32_32x32x16_bf16 v[16:31], v[164:167], v[48:51], v[16:31]
    ds_read_b128 v[172:175], v67 offset:8192
    ds_read_b64_tr_b16 v[56:57], v71 offset:24576
    ds_read_b64_tr_b16 v[58:59], v71 offset:25344
    v_mfma_f32_16x16x32_bf16 v[84:87], v[96:99], v[164:167], v[84:87]
    ds_read_b128 v[12:15], v81 offset:10240
    v_mfma_f32_16x16x32_bf16 v[92:95], v[60:63], v[60:63], v[92:95]
    s_waitcnt vmcnt(6)
    s_barrier
    s_waitcnt lgkmcnt(4)
    v_mfma_f32_32x32x16_bf16 v[16:31], v[168:171], v[52:55], v[16:31]
    ds_read_b128 v[176:179], v64 offset:40960
    ds_read_b64_tr_b16 v[48:49], v68 offset:57344
    ds_read_b64_tr_b16 v[50:51], v68 offset:58112
    v_mfma_f32_16x16x32_bf16 v[84:87], v[96:99], v[168:171], v[84:87]
    ds_read_b128 v[60:63], v80 offset:40960
    v_mfma_f32_16x16x32_bf16 v[4:7], v[8:11], v[8:11], v[4:7]
    s_xor_b32 s51, s56, 5
    s_mul_i32 s51, s51, 196608
    s_add_u32 m0, s59, 57344
    s_add_u32 s51, s47, s51
    buffer_load_dwordx4 v72, s[12:15], s51 offen offset:0 lds
    s_waitcnt lgkmcnt(4)
    v_mfma_f32_32x32x16_bf16 v[16:31], v[172:175], v[56:59], v[16:31]
    ds_read_b128 v[180:183], v65 offset:40960
    ds_read_b64_tr_b16 v[52:53], v69 offset:57344
    ds_read_b64_tr_b16 v[54:55], v69 offset:58112
    v_mfma_f32_16x16x32_bf16 v[84:87], v[96:99], v[172:175], v[84:87]
    ds_read_b128 v[8:11], v80 offset:43008
    v_mfma_f32_16x16x32_bf16 v[92:95], v[12:15], v[12:15], v[92:95]
    buffer_load_dwordx4 v73, s[12:15], s51 offen offset:1024 lds
    v_mfma_f32_16x16x32_bf16 v[88:91], v[96:99], v[56:59], v[88:91]
    s_waitcnt lgkmcnt(4)
    v_mfma_f32_32x32x16_bf16 v[16:31], v[176:179], v[48:51], v[16:31]
    ds_read_b128 v[184:187], v66 offset:40960
    ds_read_b64_tr_b16 v[56:57], v70 offset:57344
    ds_read_b64_tr_b16 v[58:59], v70 offset:58112
    v_mfma_f32_16x16x32_bf16 v[84:87], v[96:99], v[176:179], v[84:87]
    ds_read_b128 v[12:15], v81 offset:40960
    v_mfma_f32_16x16x32_bf16 v[4:7], v[60:63], v[60:63], v[4:7]
    buffer_load_dwordx4 v74, s[12:15], s51 offen offset:2048 lds
    s_waitcnt lgkmcnt(4)
    v_mfma_f32_32x32x16_bf16 v[16:31], v[180:183], v[52:55], v[16:31]
    ds_read_b128 v[188:191], v67 offset:40960
    ds_read_b64_tr_b16 v[48:49], v71 offset:57344
    ds_read_b64_tr_b16 v[50:51], v71 offset:58112
    v_mfma_f32_16x16x32_bf16 v[84:87], v[96:99], v[180:183], v[84:87]
    ds_read_b128 v[60:63], v81 offset:43008
    v_mfma_f32_16x16x32_bf16 v[92:95], v[8:11], v[8:11], v[92:95]
    v_xor_b32 v64, 0x10000, v64
    v_xor_b32 v68, 0x10000, v68
    v_xor_b32 v80, 0x10000, v80
    s_waitcnt vmcnt(3)
    s_barrier
    s_waitcnt lgkmcnt(4)
    v_mfma_f32_32x32x16_bf16 v[16:31], v[184:187], v[56:59], v[16:31]
    ds_read_b128 v[192:195], v64 offset:8192
    ds_read_b64_tr_b16 v[52:53], v68 offset:24576
    ds_read_b64_tr_b16 v[54:55], v68 offset:25344
    v_mfma_f32_16x16x32_bf16 v[84:87], v[96:99], v[184:187], v[84:87]
    ds_read_b128 v[8:11], v80 offset:8192
    v_mfma_f32_16x16x32_bf16 v[4:7], v[12:15], v[12:15], v[4:7]
    s_xor_b32 s51, s56, 6
    s_mul_i32 s51, s51, 196608
    s_add_u32 m0, s59, 90112
    s_add_u32 s51, s47, s51
    buffer_load_dwordx4 v72, s[12:15], s51 offen offset:0 lds
    v_xor_b32 v65, 0x10000, v65
    v_xor_b32 v69, 0x10000, v69
    s_waitcnt lgkmcnt(4)
    v_mfma_f32_32x32x16_bf16 v[16:31], v[188:191], v[48:51], v[16:31]
    ds_read_b128 v[196:199], v65 offset:8192
    ds_read_b64_tr_b16 v[56:57], v69 offset:24576
    ds_read_b64_tr_b16 v[58:59], v69 offset:25344
    v_mfma_f32_16x16x32_bf16 v[84:87], v[96:99], v[188:191], v[84:87]
    ds_read_b128 v[12:15], v80 offset:10240
    v_mfma_f32_16x16x32_bf16 v[92:95], v[60:63], v[60:63], v[92:95]
    buffer_load_dwordx4 v73, s[12:15], s51 offen offset:1024 lds
    v_mfma_f32_16x16x32_bf16 v[88:91], v[96:99], v[48:51], v[88:91]
    v_xor_b32 v66, 0x10000, v66
    v_xor_b32 v70, 0x10000, v70
    v_xor_b32 v81, 0x10000, v81
    s_waitcnt lgkmcnt(4)
    v_mfma_f32_32x32x16_bf16 v[16:31], v[192:195], v[52:55], v[16:31]
    ds_read_b128 v[200:203], v66 offset:8192
    ds_read_b64_tr_b16 v[48:49], v70 offset:24576
    ds_read_b64_tr_b16 v[50:51], v70 offset:25344
    v_mfma_f32_16x16x32_bf16 v[84:87], v[96:99], v[192:195], v[84:87]
    ds_read_b128 v[60:63], v81 offset:8192
    v_mfma_f32_16x16x32_bf16 v[4:7], v[8:11], v[8:11], v[4:7]
    buffer_load_dwordx4 v74, s[12:15], s51 offen offset:2048 lds
    v_xor_b32 v67, 0x10000, v67
    v_xor_b32 v71, 0x10000, v71
    s_waitcnt lgkmcnt(4)
    v_mfma_f32_32x32x16_bf16 v[16:31], v[196:199], v[56:59], v[16:31]
    ds_read_b128 v[204:207], v67 offset:8192
    ds_read_b64_tr_b16 v[52:53], v71 offset:24576
    ds_read_b64_tr_b16 v[54:55], v71 offset:25344
    v_mfma_f32_16x16x32_bf16 v[84:87], v[96:99], v[196:199], v[84:87]
    ds_read_b128 v[8:11], v81 offset:10240
    v_mfma_f32_16x16x32_bf16 v[92:95], v[12:15], v[12:15], v[92:95]
    s_waitcnt vmcnt(3)
    s_barrier
    s_waitcnt lgkmcnt(4)
    v_mfma_f32_32x32x16_bf16 v[16:31], v[200:203], v[48:51], v[16:31]
    ds_read_b128 v[208:211], v64 offset:40960
    ds_read_b64_tr_b16 v[56:57], v68 offset:57344
    ds_read_b64_tr_b16 v[58:59], v68 offset:58112
    v_mfma_f32_16x16x32_bf16 v[84:87], v[96:99], v[200:203], v[84:87]
    ds_read_b128 v[12:15], v80 offset:40960
    v_mfma_f32_16x16x32_bf16 v[4:7], v[60:63], v[60:63], v[4:7]
    s_xor_b32 s51, s56, 7
    s_mul_i32 s51, s51, 196608
    s_add_u32 m0, s59, 147456
    s_add_u32 s51, s47, s51
    buffer_load_dwordx4 v72, s[12:15], s51 offen offset:0 lds
    buffer_load_dwordx4 v73, s[12:15], s51 offen offset:1024 lds
    s_waitcnt lgkmcnt(4)
    v_mfma_f32_32x32x16_bf16 v[16:31], v[204:207], v[52:55], v[16:31]
    ds_read_b128 v[212:215], v65 offset:40960
    ds_read_b64_tr_b16 v[48:49], v69 offset:57344
    ds_read_b64_tr_b16 v[50:51], v69 offset:58112
    v_mfma_f32_16x16x32_bf16 v[84:87], v[96:99], v[204:207], v[84:87]
    ds_read_b128 v[60:63], v80 offset:43008
    v_mfma_f32_16x16x32_bf16 v[92:95], v[8:11], v[8:11], v[92:95]
    buffer_load_dwordx4 v74, s[12:15], s51 offen offset:2048 lds
    v_mfma_f32_16x16x32_bf16 v[88:91], v[96:99], v[52:55], v[88:91]
    s_waitcnt lgkmcnt(4)
    v_mfma_f32_32x32x16_bf16 v[16:31], v[208:211], v[56:59], v[16:31]
    ds_read_b128 v[216:219], v66 offset:40960
    ds_read_b64_tr_b16 v[52:53], v70 offset:57344
    ds_read_b64_tr_b16 v[54:55], v70 offset:58112
    v_mfma_f32_16x16x32_bf16 v[84:87], v[96:99], v[208:211], v[84:87]
    ds_read_b128 v[8:11], v81 offset:40960
    v_mfma_f32_16x16x32_bf16 v[4:7], v[12:15], v[12:15], v[4:7]
    s_xor_b32 s51, s56, 0
    s_mul_i32 s51, s51, 229376
    s_add_u32 m0, s100, 106496
    s_add_u32 s51, s101, s51
    buffer_load_dwordx4 v76, s[16:19], s51 offen offset:0 lds
    s_waitcnt lgkmcnt(4)
    v_mfma_f32_32x32x16_bf16 v[16:31], v[212:215], v[48:51], v[16:31]
    ds_read_b128 v[220:223], v67 offset:40960
    ds_read_b64_tr_b16 v[56:57], v71 offset:57344
    ds_read_b64_tr_b16 v[58:59], v71 offset:58112
    v_mfma_f32_16x16x32_bf16 v[84:87], v[96:99], v[212:215], v[84:87]
    ds_read_b128 v[12:15], v81 offset:43008
    v_mfma_f32_16x16x32_bf16 v[92:95], v[60:63], v[60:63], v[92:95]
    buffer_load_dwordx4 v77, s[16:19], s51 offen offset:1024 lds
    v_xor_b32 v64, 0x10000, v64
    v_xor_b32 v68, 0x10000, v68
    v_xor_b32 v80, 0x10000, v80
    s_waitcnt vmcnt(5)
    s_barrier
    s_waitcnt lgkmcnt(4)
    v_mfma_f32_32x32x16_bf16 v[16:31], v[216:219], v[52:55], v[16:31]
    ds_read_b128 v[224:227], v64 offset:8192
    ds_read_b64_tr_b16 v[48:49], v68 offset:24576
    ds_read_b64_tr_b16 v[50:51], v68 offset:25344
    v_mfma_f32_16x16x32_bf16 v[84:87], v[96:99], v[216:219], v[84:87]
    ds_read_b128 v[60:63], v80 offset:8192
    v_mfma_f32_16x16x32_bf16 v[4:7], v[8:11], v[8:11], v[4:7]
    buffer_load_dwordx4 v78, s[16:19], s51 offen offset:2048 lds
    buffer_load_dwordx4 v79, s[16:19], s51 offen offset:3072 lds
    v_xor_b32 v65, 0x10000, v65
    v_xor_b32 v69, 0x10000, v69
    s_waitcnt lgkmcnt(4)
    v_mfma_f32_32x32x16_bf16 v[16:31], v[220:223], v[56:59], v[16:31]
    ds_read_b128 v[228:231], v65 offset:8192
    ds_read_b64_tr_b16 v[52:53], v69 offset:24576
    ds_read_b64_tr_b16 v[54:55], v69 offset:25344
    v_mfma_f32_16x16x32_bf16 v[84:87], v[96:99], v[220:223], v[84:87]
    ds_read_b128 v[8:11], v80 offset:10240
    v_mfma_f32_16x16x32_bf16 v[92:95], v[12:15], v[12:15], v[92:95]
    s_xor_b32 s51, s56, 2
    s_mul_i32 s51, s51, 229376
    s_add_u32 m0, s100, 8192
    s_add_u32 s51, s101, s51
    buffer_load_dwordx4 v76, s[16:19], s51 offen offset:0 lds
    v_mfma_f32_16x16x32_bf16 v[88:91], v[96:99], v[56:59], v[88:91]
    v_xor_b32 v66, 0x10000, v66
    v_xor_b32 v70, 0x10000, v70
    v_xor_b32 v81, 0x10000, v81
    s_waitcnt lgkmcnt(4)
    v_mfma_f32_32x32x16_bf16 v[16:31], v[224:227], v[48:51], v[16:31]
    ds_read_b128 v[232:235], v66 offset:8192
    ds_read_b64_tr_b16 v[56:57], v70 offset:24576
    ds_read_b64_tr_b16 v[58:59], v70 offset:25344
    v_mfma_f32_16x16x32_bf16 v[84:87], v[96:99], v[224:227], v[84:87]
    ds_read_b128 v[12:15], v81 offset:8192
    v_mfma_f32_16x16x32_bf16 v[4:7], v[60:63], v[60:63], v[4:7]
    buffer_load_dwordx4 v77, s[16:19], s51 offen offset:1024 lds
    v_xor_b32 v67, 0x10000, v67
    v_xor_b32 v71, 0x10000, v71
    s_waitcnt lgkmcnt(4)
    v_mfma_f32_32x32x16_bf16 v[16:31], v[228:231], v[52:55], v[16:31]
    ds_read_b128 v[236:239], v67 offset:8192
    ds_read_b64_tr_b16 v[48:49], v71 offset:24576
    ds_read_b64_tr_b16 v[50:51], v71 offset:25344
    v_mfma_f32_16x16x32_bf16 v[84:87], v[96:99], v[228:231], v[84:87]
    ds_read_b128 v[60:63], v81 offset:10240
    v_mfma_f32_16x16x32_bf16 v[92:95], v[8:11], v[8:11], v[92:95]
    buffer_load_dwordx4 v78, s[16:19], s51 offen offset:2048 lds
    v_add_u32 v64, s52, v64
    v_add_u32 v68, 81920, v68
    v_add_u32 v80, s52, v80
    s_waitcnt vmcnt(7)
    s_barrier
    s_waitcnt lgkmcnt(4)
    v_mfma_f32_32x32x16_bf16 v[16:31], v[232:235], v[56:59], v[16:31]
    ds_read_b128 v[240:243], v64 offset:0
    ds_read_b64_tr_b16 v[52:53], v68 offset:0
    ds_read_b64_tr_b16 v[54:55], v68 offset:768
    v_mfma_f32_16x16x32_bf16 v[84:87], v[96:99], v[232:235], v[84:87]
    ds_read_b128 v[8:11], v80 offset:0
    v_mfma_f32_16x16x32_bf16 v[4:7], v[12:15], v[12:15], v[4:7]
    buffer_load_dwordx4 v79, s[16:19], s51 offen offset:3072 lds
    s_xor_b32 s51, s56, 4
    s_mul_i32 s51, s51, 229376
    s_add_u32 m0, s100, 40960
    s_add_u32 s51, s101, s51
    buffer_load_dwordx4 v76, s[16:19], s51 offen offset:0 lds
    v_add_u32 v65, s52, v65
    v_add_u32 v69, 81920, v69
    s_waitcnt lgkmcnt(4)
    v_mfma_f32_32x32x16_bf16 v[16:31], v[236:239], v[48:51], v[16:31]
    ds_read_b128 v[244:247], v65 offset:0
    ds_read_b64_tr_b16 v[56:57], v69 offset:0
    ds_read_b64_tr_b16 v[58:59], v69 offset:768
    v_mfma_f32_16x16x32_bf16 v[84:87], v[96:99], v[236:239], v[84:87]
    ds_read_b128 v[12:15], v80 offset:2048
    v_mfma_f32_16x16x32_bf16 v[92:95], v[60:63], v[60:63], v[92:95]
    buffer_load_dwordx4 v77, s[16:19], s51 offen offset:1024 lds
    v_mfma_f32_16x16x32_bf16 v[88:91], v[96:99], v[48:51], v[88:91]
    v_add_u32 v66, s52, v66
    v_add_u32 v70, 81920, v70
    v_add_u32 v81, s52, v81
    s_waitcnt lgkmcnt(4)
    v_mfma_f32_32x32x16_bf16 v[16:31], v[240:243], v[52:55], v[16:31]
    ds_read_b128 v[248:251], v66 offset:0
    ds_read_b64_tr_b16 v[48:49], v70 offset:0
    ds_read_b64_tr_b16 v[50:51], v70 offset:768
    v_mfma_f32_16x16x32_bf16 v[84:87], v[96:99], v[240:243], v[84:87]
    ds_read_b128 v[60:63], v81 offset:0
    v_mfma_f32_16x16x32_bf16 v[4:7], v[8:11], v[8:11], v[4:7]
    buffer_load_dwordx4 v78, s[16:19], s51 offen offset:2048 lds
    v_add_u32 v67, s52, v67
    v_add_u32 v71, 81920, v71
    s_waitcnt lgkmcnt(4)
    v_mfma_f32_32x32x16_bf16 v[16:31], v[244:247], v[56:59], v[16:31]
    ds_read_b128 v[252:255], v67 offset:0
    ds_read_b64_tr_b16 v[52:53], v71 offset:0
    ds_read_b64_tr_b16 v[54:55], v71 offset:768
    v_mfma_f32_16x16x32_bf16 v[84:87], v[96:99], v[244:247], v[84:87]
    ds_read_b128 v[8:11], v81 offset:2048
    v_mfma_f32_16x16x32_bf16 v[92:95], v[12:15], v[12:15], v[92:95]
    buffer_load_dwordx4 v79, s[16:19], s51 offen offset:3072 lds
    s_barrier
    s_waitcnt lgkmcnt(4)
    v_mfma_f32_32x32x16_bf16 v[16:31], v[248:251], v[48:51], v[16:31]
    v_mfma_f32_16x16x32_bf16 v[84:87], v[96:99], v[248:251], v[84:87]
    v_mfma_f32_16x16x32_bf16 v[4:7], v[60:63], v[60:63], v[4:7]
    global_load_dword v3, v110, s[40:41] sc1
    s_xor_b32 s51, s56, 6
    s_mul_i32 s51, s51, 229376
    s_add_u32 m0, s100, 73728
    s_add_u32 s51, s101, s51
    buffer_load_dwordx4 v76, s[16:19], s51 offen offset:0 lds
    s_waitcnt lgkmcnt(0)
    v_mfma_f32_32x32x16_bf16 v[16:31], v[252:255], v[52:55], v[16:31]
    v_mfma_f32_16x16x32_bf16 v[84:87], v[96:99], v[252:255], v[84:87]
    v_mfma_f32_16x16x32_bf16 v[92:95], v[8:11], v[8:11], v[92:95]
    buffer_load_dwordx4 v77, s[16:19], s51 offen offset:1024 lds
    buffer_load_dwordx4 v78, s[16:19], s51 offen offset:2048 lds
    v_mfma_f32_16x16x32_bf16 v[88:91], v[96:99], v[52:55], v[88:91]
    buffer_load_dwordx4 v79, s[16:19], s51 offen offset:3072 lds
    s_lshl_b32 s50, s44, 8
    s_add_u32 s51, s50, 159744
    v_lshl_add_u32 v116, v0, 3, s51
    v_lshlrev_b32 v117, 4, v0
    v_add_u32 v117, 161792, v117
    s_lshl_b32 s50, s44, 2
    v_add_u32 v118, s50, v117
    s_mul_i32 s52, s43, 3
    s_add_u32 s52, s52, 2
    s_lshl_b32 s55, s52, 17
    s_lshl_b32 s50, s42, 2
    s_add_u32 s50, s50, s44
    s_mul_i32 s54, s50, 114688
    s_lshl_b32 s50, s50, 10
    s_add_u32 s55, s55, s50
    ds_write_b32 v118, v88
    ds_write_b32 v116, v84
    s_mov_b32 vcc_lo, 0xaaaaaaaa
    s_mov_b32 vcc_hi, 0xaaaaaaaa
    s_mov_b32 s4, 0xcccccccc
    s_mov_b32 s5, 0xcccccccc
    v_and_b32 v119, 15, v1
    v_lshl_add_u32 v119, v119, 3, s51
    v_cndmask_b32 v4, v4, v5, vcc
    v_cndmask_b32 v6, v6, v7, vcc
    v_cndmask_b32 v4, v4, v6, s[4:5]
    v_cndmask_b32 v92, v92, v93, vcc
    v_cndmask_b32 v94, v94, v95, vcc
    v_cndmask_b32 v92, v92, v94, s[4:5]
    s_mov_b32 exec_lo, 0x00f0000f
    s_mov_b32 exec_hi, 0xf0000f00
    ds_write_b32 v119, v4 offset:4
    ds_write_b32 v119, v92 offset:132
    s_mov_b64 exec, -1
    s_lshl_b32 s50, s48, 5
    s_add_u32 s54, s54, s50
    s_add_u32 s54, s54, 10489856
    s_waitcnt vmcnt(9) lgkmcnt(0)
    s_barrier
    ds_read_b64 v[8:9], v116
    ds_read_b128 v[88:91], v117
    s_setprio 3
    s_waitcnt lgkmcnt(0)
    v_mul_f32 v8, 0xbb000000, v8
    v_mul_f32 v9, 0x3b000000, v9
    v_add_f32 v88, v88, v89
    v_fma_f32 v9, -v8, v8, v9
    v_add_f32 v90, v90, v91
    v_max_f32 v82, 0, v9
    v_add_f32 v13, v88, v90
    v_add_f32 v9, 0x3727c5ac, v82
    v_rsq_f32 v111, v9
    v_cvt_pk_bf16_f32 v10, v8, v8
    v_and_b32 v10, 0xffff0000, v10
    v_sub_f32 v11, v8, v10
    v_cvt_pk_bf16_f32 v12, v10, v11
    s_lshl_b32 s50, s3, 7
    s_add_u32 s50, s50, 162304
    v_lshl_add_u32 v10, v0, 2, s50
    ds_write_b32 v10, v111
    v_lshrrev_b32 v11, 5, v1
    v_lshl_add_u32 v11, v11, 4, s50
    ds_read_b128 v[88:91], v11 offset:0
    ds_read_b128 v[92:95], v11 offset:32
    ds_read_b128 v[116:119], v11 offset:64
    ds_read_b128 v[120:123], v11 offset:96
    v_cndmask_b32 v100, 0, v12, s[6:7]
    v_cndmask_b32 v101, 0, v12, s[6:7]
    v_cvt_pk_bf16_f32 v104, v13, v13
    v_and_b32 v10, 0xffff0000, v104
    v_sub_f32 v10, v13, v10
    v_cvt_pk_bf16_f32 v105, v10, v10
    s_nop 1
    v_mfma_f32_32x32x16_bf16 v[16:31], v[100:103], v[104:107], v[16:31]
    s_nop 7
    s_nop 3
    s_waitcnt lgkmcnt(0)
    v_mul_f32 v16, v16, v88
    v_mul_f32 v17, v17, v89
    v_mul_f32 v18, v18, v90
    v_mul_f32 v19, v19, v91
    v_mul_f32 v20, v20, v92
    v_mul_f32 v21, v21, v93
    v_mul_f32 v22, v22, v94
    v_mul_f32 v23, v23, v95
    v_mul_f32 v24, v24, v116
    v_mul_f32 v25, v25, v117
    v_mul_f32 v26, v26, v118
    v_mul_f32 v27, v27, v119
    v_mul_f32 v28, v28, v120
    v_mul_f32 v29, v29, v121
    v_mul_f32 v30, v30, v122
    v_mul_f32 v31, v31, v123
    v_cvt_pk_bf16_f32 v16, v16, v17
    v_cvt_pk_bf16_f32 v17, v18, v19
    v_cvt_pk_bf16_f32 v18, v20, v21
    v_cvt_pk_bf16_f32 v19, v22, v23
    v_cvt_pk_bf16_f32 v20, v24, v25
    v_cvt_pk_bf16_f32 v21, v26, v27
    v_cvt_pk_bf16_f32 v22, v28, v29
    v_cvt_pk_bf16_f32 v23, v30, v31
    s_add_u32 s50, s55, 0
    buffer_store_dwordx4 v[16:19], v33, s[20:23], s50 offen sc1
    s_add_u32 s50, s55, 512
    buffer_store_dwordx4 v[20:23], v33, s[20:23], s50 offen sc1
    s_waitcnt vmcnt(2)
    s_barrier
L_f1:
    v_mov_b32 v116, 0x3f803f80
    s_mov_b32 vcc_lo, 0x00110011
    s_mov_b32 vcc_hi, 0x00110011
    s_lshl_b32 s50, s44, 10
    s_add_u32 s50, s50, 155648
    v_add_u32 v117, s50, v2
    v_cndmask_b32 v12, 0, v116, vcc
    v_cndmask_b32 v13, 0, v116, vcc
    v_cndmask_b32 v14, 0, v116, vcc
    v_cndmask_b32 v15, 0, v116, vcc
    ds_write_b128 v117, v[12:15]
    v_mov_b32 v4, v32
    v_xor_b32 v5, 4096, v4
    v_xor_b32 v6, 8192, v4
    v_xor_b32 v7, 12288, v4
    s_xor_b32 s50, s44, 2
    s_lshl_b32 s50, s50, 6
    v_xor_b32 v8, s50, v4
    v_xor_b32 v9, s50, v5
    v_xor_b32 v10, s50, v6
    v_xor_b32 v11, s50, v7
    s_cmp_eq_u32 s53, 0
    s_cbranch_scc1 L_ncs
    ds_read_b64_tr_b16 v[48:49], v8 offset:40960
    ds_read_b64_tr_b16 v[50:51], v8 offset:41984
    ds_read_b64_tr_b16 v[52:53], v9 offset:40960
    ds_read_b64_tr_b16 v[54:55], v9 offset:41984
    ds_read_b64_tr_b16 v[56:57], v10 offset:40960
    ds_read_b64_tr_b16 v[58:59], v10 offset:41984
    ds_read_b64_tr_b16 v[60:61], v11 offset:40960
    ds_read_b64_tr_b16 v[62:63], v11 offset:41984
    s_waitcnt lgkmcnt(6)
    v_mfma_f32_16x16x32_bf16 v[88:91], v[96:99], v[48:51], 0
    ds_read_b64_tr_b16 v[48:49], v8 offset:57344
    ds_read_b64_tr_b16 v[50:51], v8 offset:58368
    s_waitcnt lgkmcnt(6)
    v_mfma_f32_16x16x32_bf16 v[88:91], v[96:99], v[52:55], v[88:91]
    ds_read_b64_tr_b16 v[52:53], v9 offset:57344
    ds_read_b64_tr_b16 v[54:55], v9 offset:58368
    s_waitcnt lgkmcnt(6)
    v_mfma_f32_16x16x32_bf16 v[88:91], v[96:99], v[56:59], v[88:91]
    ds_read_b64_tr_b16 v[56:57], v10 offset:57344
    ds_read_b64_tr_b16 v[58:59], v10 offset:58368
    s_waitcnt lgkmcnt(6)
    v_mfma_f32_16x16x32_bf16 v[88:91], v[96:99], v[60:63], v[88:91]
    ds_read_b64_tr_b16 v[60:61], v11 offset:57344
    ds_read_b64_tr_b16 v[62:63], v11 offset:58368
    s_waitcnt lgkmcnt(6)
    v_mfma_f32_16x16x32_bf16 v[88:91], v[96:99], v[48:51], v[88:91]
    v_xor_b32 v8, 0x10000, v8
    ds_read_b64_tr_b16 v[48:49], v8 offset:8192
    ds_read_b64_tr_b16 v[50:51], v8 offset:9216
    s_waitcnt lgkmcnt(6)
    v_mfma_f32_16x16x32_bf16 v[88:91], v[96:99], v[52:55], v[88:91]
    v_xor_b32 v9, 0x10000, v9
    ds_read_b64_tr_b16 v[52:53], v9 offset:8192
    ds_read_b64_tr_b16 v[54:55], v9 offset:9216
    s_waitcnt lgkmcnt(6)
    v_mfma_f32_16x16x32_bf16 v[88:91], v[96:99], v[56:59], v[88:91]
    v_xor_b32 v10, 0x10000, v10
    ds_read_b64_tr_b16 v[56:57], v10 offset:8192
    ds_read_b64_tr_b16 v[58:59], v10 offset:9216
    s_waitcnt lgkmcnt(6)
    v_mfma_f32_16x16x32_bf16 v[88:91], v[96:99], v[60:63], v[88:91]
    v_xor_b32 v11, 0x10000, v11
    ds_read_b64_tr_b16 v[60:61], v11 offset:8192
    ds_read_b64_tr_b16 v[62:63], v11 offset:9216
    s_waitcnt lgkmcnt(6)
    v_mfma_f32_16x16x32_bf16 v[88:91], v[96:99], v[48:51], v[88:91]
    ds_read_b64_tr_b16 v[48:49], v8 offset:24576
    ds_read_b64_tr_b16 v[50:51], v8 offset:25600
    s_waitcnt lgkmcnt(6)
    v_mfma_f32_16x16x32_bf16 v[88:91], v[96:99], v[52:55], v[88:91]
    ds_read_b64_tr_b16 v[52:53], v9 offset:24576
    ds_read_b64_tr_b16 v[54:55], v9 offset:25600
    s_waitcnt lgkmcnt(6)
    v_mfma_f32_16x16x32_bf16 v[88:91], v[96:99], v[56:59], v[88:91]
    ds_read_b64_tr_b16 v[56:57], v10 offset:24576
    ds_read_b64_tr_b16 v[58:59], v10 offset:25600
    s_waitcnt lgkmcnt(6)
    v_mfma_f32_16x16x32_bf16 v[88:91], v[96:99], v[60:63], v[88:91]
    ds_read_b64_tr_b16 v[60:61], v11 offset:24576
    ds_read_b64_tr_b16 v[62:63], v11 offset:25600
    s_waitcnt lgkmcnt(6)
    v_mfma_f32_16x16x32_bf16 v[88:91], v[96:99], v[48:51], v[88:91]
    ds_read_b64_tr_b16 v[48:49], v8 offset:40960
    ds_read_b64_tr_b16 v[50:51], v8 offset:41984
    s_waitcnt lgkmcnt(6)
    v_mfma_f32_16x16x32_bf16 v[88:91], v[96:99], v[52:55], v[88:91]
    ds_read_b64_tr_b16 v[52:53], v9 offset:40960
    ds_read_b64_tr_b16 v[54:55], v9 offset:41984
    s_waitcnt lgkmcnt(6)
    v_mfma_f32_16x16x32_bf16 v[88:91], v[96:99], v[56:59], v[88:91]
    ds_read_b64_tr_b16 v[56:57], v10 offset:40960
    ds_read_b64_tr_b16 v[58:59], v10 offset:41984
    s_waitcnt lgkmcnt(6)
    v_mfma_f32_16x16x32_bf16 v[88:91], v[96:99], v[60:63], v[88:91]
    ds_read_b64_tr_b16 v[60:61], v11 offset:40960
    ds_read_b64_tr_b16 v[62:63], v11 offset:41984
    s_waitcnt lgkmcnt(6)
    v_mfma_f32_16x16x32_bf16 v[88:91], v[96:99], v[48:51], v[88:91]
    ds_read_b64_tr_b16 v[48:49], v8 offset:57344
    ds_read_b64_tr_b16 v[50:51], v8 offset:58368
    s_waitcnt lgkmcnt(6)
    v_mfma_f32_16x16x32_bf16 v[88:91], v[96:99], v[52:55], v[88:91]
    ds_read_b64_tr_b16 v[52:53], v9 offset:57344
    ds_read_b64_tr_b16 v[54:55], v9 offset:58368
    s_waitcnt lgkmcnt(6)
    v_mfma_f32_16x16x32_bf16 v[88:91], v[96:99], v[56:59], v[88:91]
    ds_read_b64_tr_b16 v[56:57], v10 offset:57344
    ds_read_b64_tr_b16 v[58:59], v10 offset:58368
    s_waitcnt lgkmcnt(6)
    v_mfma_f32_16x16x32_bf16 v[88:91], v[96:99], v[60:63], v[88:91]
    ds_read_b64_tr_b16 v[60:61], v11 offset:57344
    ds_read_b64_tr_b16 v[62:63], v11 offset:58368
    s_waitcnt lgkmcnt(6)
    v_mfma_f32_16x16x32_bf16 v[88:91], v[96:99], v[48:51], v[88:91]
    v_xor_b32 v8, 0x10000, v8
    ds_read_b64_tr_b16 v[48:49], v8 offset:8192
    ds_read_b64_tr_b16 v[50:51], v8 offset:9216
    s_waitcnt lgkmcnt(6)
    v_mfma_f32_16x16x32_bf16 v[88:91], v[96:99], v[52:55], v[88:91]
    v_xor_b32 v9, 0x10000, v9
    ds_read_b64_tr_b16 v[52:53], v9 offset:8192
    ds_read_b64_tr_b16 v[54:55], v9 offset:9216
    s_waitcnt lgkmcnt(6)
    v_mfma_f32_16x16x32_bf16 v[88:91], v[96:99], v[56:59], v[88:91]
    v_xor_b32 v10, 0x10000, v10
    ds_read_b64_tr_b16 v[56:57], v10 offset:8192
    ds_read_b64_tr_b16 v[58:59], v10 offset:9216
    s_waitcnt lgkmcnt(6)
    v_mfma_f32_16x16x32_bf16 v[88:91], v[96:99], v[60:63], v[88:91]
    v_xor_b32 v11, 0x10000, v11
    ds_read_b64_tr_b16 v[60:61], v11 offset:8192
    ds_read_b64_tr_b16 v[62:63], v11 offset:9216
    s_waitcnt lgkmcnt(6)
    v_mfma_f32_16x16x32_bf16 v[88:91], v[96:99], v[48:51], v[88:91]
    ds_read_b64_tr_b16 v[48:49], v8 offset:24576
    ds_read_b64_tr_b16 v[50:51], v8 offset:25600
    s_waitcnt lgkmcnt(6)
    v_mfma_f32_16x16x32_bf16 v[88:91], v[96:99], v[52:55], v[88:91]
    ds_read_b64_tr_b16 v[52:53], v9 offset:24576
    ds_read_b64_tr_b16 v[54:55], v9 offset:25600
    s_waitcnt lgkmcnt(6)
    v_mfma_f32_16x16x32_bf16 v[88:91], v[96:99], v[56:59], v[88:91]
    ds_read_b64_tr_b16 v[56:57], v10 offset:24576
    ds_read_b64_tr_b16 v[58:59], v10 offset:25600
    s_waitcnt lgkmcnt(6)
    v_mfma_f32_16x16x32_bf16 v[88:91], v[96:99], v[60:63], v[88:91]
    ds_read_b64_tr_b16 v[60:61], v11 offset:24576
    ds_read_b64_tr_b16 v[62:63], v11 offset:25600
    s_waitcnt lgkmcnt(6)
    v_mfma_f32_16x16x32_bf16 v[88:91], v[96:99], v[48:51], v[88:91]
    s_waitcnt lgkmcnt(4)
    v_mfma_f32_16x16x32_bf16 v[88:91], v[96:99], v[52:55], v[88:91]
    s_waitcnt lgkmcnt(2)
    v_mfma_f32_16x16x32_bf16 v[88:91], v[96:99], v[56:59], v[88:91]
    s_waitcnt lgkmcnt(0)
    v_mfma_f32_16x16x32_bf16 v[88:91], v[96:99], v[60:63], v[88:91]
L_ncs:
    s_lshl_b32 s50, s44, 7
    s_add_u32 s50, s50, 163328
    v_lshl_add_u32 v116, v0, 2, s50
    v_lshlrev_b32 v11, 2, v0
    v_add_u32 v11, 163584, v11
    s_lshl_b32 s63, s57, 16
    s_lshl_b32 s59, s44, 10
    s_add_u32 s63, s63, s59
    ds_write_b32 v116, v88
    s_waitcnt vmcnt(0) lgkmcnt(0)
    s_cmp_lg_u32 s3, 4
    s_cbranch_scc1 L_zd5
    s_mov_b32 s60, 200000
L_zp5:
    v_readfirstlane_b32 s50, v3
    s_cmp_lg_u32 s50, 0
    s_cbranch_scc1 L_zd5
    s_sleep 3
    global_load_dword v3, v110, s[40:41] sc1
    s_waitcnt vmcnt(0)
    s_sub_u32 s60, s60, 1
    s_cbranch_scc0 L_zp5
L_zd5:
    s_barrier
    s_cmp_lg_u32 s3, 4
    s_cbranch_scc1 L_nsig
    s_lshl_b32 s50, s43, 7
    s_add_u32 s50, s50, 17825792
    v_mov_b32 v116, 1
    v_mov_b32 v117, 0
    s_mov_b64 exec, 1
    buffer_atomic_add v116, v117, s[20:23], s50 offen sc1
    s_mov_b64 exec, -1
L_nsig:
    s_cmp_eq_u32 s53, 0
    s_cbranch_scc1 L_gb1
    s_setprio 2
    ds_read_b64_tr_b16 v[48:49], v4 offset:40960
    ds_read_b64_tr_b16 v[50:51], v4 offset:41984
    ds_read_b64_tr_b16 v[52:53], v5 offset:40960
    ds_read_b64_tr_b16 v[54:55], v5 offset:41984
    ds_read_b64_tr_b16 v[56:57], v6 offset:40960
    ds_read_b64_tr_b16 v[58:59], v6 offset:41984
    ds_read_b64_tr_b16 v[60:61], v7 offset:40960
    ds_read_b64_tr_b16 v[62:63], v7 offset:41984
    s_waitcnt lgkmcnt(6)
    v_mfma_f32_32x32x16_bf16 v[16:31], v[48:51], v[128:131], 0
    ds_read_b64_tr_b16 v[48:49], v4 offset:57344
    ds_read_b64_tr_b16 v[50:51], v4 offset:58368
    s_waitcnt lgkmcnt(6)
    v_mfma_f32_32x32x16_bf16 v[16:31], v[52:55], v[132:135], v[16:31]
    ds_read_b64_tr_b16 v[52:53], v5 offset:57344
    ds_read_b64_tr_b16 v[54:55], v5 offset:58368
    s_waitcnt lgkmcnt(6)
    v_mfma_f32_32x32x16_bf16 v[16:31], v[56:59], v[136:139], v[16:31]
    ds_read_b64_tr_b16 v[56:57], v6 offset:57344
    ds_read_b64_tr_b16 v[58:59], v6 offset:58368
    v_add_f32 v8, 0x3727c5ac, v82
    v_fmamk_f32 v8, v8, 0x3727c5ac, v82
    s_waitcnt lgkmcnt(6)
    v_mfma_f32_32x32x16_bf16 v[16:31], v[60:63], v[140:143], v[16:31]
    ds_read_b64_tr_b16 v[60:61], v7 offset:57344
    ds_read_b64_tr_b16 v[62:63], v7 offset:58368
    v_rsq_f32 v9, v8
    s_nop 0
    s_waitcnt lgkmcnt(6)
    v_mfma_f32_32x32x16_bf16 v[16:31], v[48:51], v[144:147], v[16:31]
    v_xor_b32 v4, 0x10000, v4
    ds_read_b64_tr_b16 v[48:49], v4 offset:8192
    ds_read_b64_tr_b16 v[50:51], v4 offset:9216
    v_mul_f32 v114, v8, v9
    v_mul_f32 v112, 0xc0135761, v9
    s_waitcnt lgkmcnt(6)
    v_mfma_f32_32x32x16_bf16 v[16:31], v[52:55], v[148:151], v[16:31]
    v_xor_b32 v5, 0x10000, v5
    ds_read_b64_tr_b16 v[52:53], v5 offset:8192
    ds_read_b64_tr_b16 v[54:55], v5 offset:9216
    v_mul_f32 v9, v9, v9
    v_mul_f32 v9, 0x3d372713, v9
    s_waitcnt lgkmcnt(6)
    v_mfma_f32_32x32x16_bf16 v[16:31], v[56:59], v[152:155], v[16:31]
    v_xor_b32 v6, 0x10000, v6
    ds_read_b64_tr_b16 v[56:57], v6 offset:8192
    ds_read_b64_tr_b16 v[58:59], v6 offset:9216
    v_mul_f32 v113, v112, v9
    v_cvt_pk_bf16_f32 v8, v114, v114
    s_waitcnt lgkmcnt(6)
    v_mfma_f32_32x32x16_bf16 v[16:31], v[60:63], v[156:159], v[16:31]
    v_xor_b32 v7, 0x10000, v7
    ds_read_b64_tr_b16 v[60:61], v7 offset:8192
    ds_read_b64_tr_b16 v[62:63], v7 offset:9216
    v_and_b32 v8, 0xffff0000, v8
    v_sub_f32 v9, v114, v8
    s_waitcnt lgkmcnt(6)
    v_mfma_f32_32x32x16_bf16 v[16:31], v[48:51], v[160:163], v[16:31]
    ds_read_b64_tr_b16 v[48:49], v4 offset:24576
    ds_read_b64_tr_b16 v[50:51], v4 offset:25600
    v_cvt_pk_bf16_f32 v8, v8, v9
    v_cndmask_b32 v102, 0, v8, s[6:7]
    s_waitcnt lgkmcnt(6)
    v_mfma_f32_32x32x16_bf16 v[16:31], v[52:55], v[164:167], v[16:31]
    ds_read_b64_tr_b16 v[52:53], v5 offset:24576
    ds_read_b64_tr_b16 v[54:55], v5 offset:25600
    s_waitcnt lgkmcnt(6)
    v_mfma_f32_32x32x16_bf16 v[16:31], v[56:59], v[168:171], v[16:31]
    ds_read_b64_tr_b16 v[56:57], v6 offset:24576
    ds_read_b64_tr_b16 v[58:59], v6 offset:25600
    s_waitcnt lgkmcnt(6)
    v_mfma_f32_32x32x16_bf16 v[16:31], v[60:63], v[172:175], v[16:31]
    ds_read_b64_tr_b16 v[60:61], v7 offset:24576
    ds_read_b64_tr_b16 v[62:63], v7 offset:25600
    s_waitcnt lgkmcnt(6)
    v_mfma_f32_32x32x16_bf16 v[16:31], v[48:51], v[176:179], v[16:31]
    ds_read_b64_tr_b16 v[48:49], v4 offset:40960
    ds_read_b64_tr_b16 v[50:51], v4 offset:41984
    s_waitcnt lgkmcnt(6)
    v_mfma_f32_32x32x16_bf16 v[16:31], v[52:55], v[180:183], v[16:31]
    ds_read_b64_tr_b16 v[52:53], v5 offset:40960
    ds_read_b64_tr_b16 v[54:55], v5 offset:41984
    s_waitcnt lgkmcnt(6)
    v_mfma_f32_32x32x16_bf16 v[16:31], v[56:59], v[184:187], v[16:31]
    ds_read_b64_tr_b16 v[56:57], v6 offset:40960
    ds_read_b64_tr_b16 v[58:59], v6 offset:41984
    s_waitcnt lgkmcnt(6)
    v_mfma_f32_32x32x16_bf16 v[16:31], v[60:63], v[188:191], v[16:31]
    ds_read_b64_tr_b16 v[60:61], v7 offset:40960
    ds_read_b64_tr_b16 v[62:63], v7 offset:41984
    s_waitcnt lgkmcnt(6)
    v_mfma_f32_32x32x16_bf16 v[16:31], v[48:51], v[192:195], v[16:31]
    ds_read_b64_tr_b16 v[48:49], v4 offset:57344
    ds_read_b64_tr_b16 v[50:51], v4 offset:58368
    s_waitcnt lgkmcnt(6)
    v_mfma_f32_32x32x16_bf16 v[16:31], v[52:55], v[196:199], v[16:31]
    ds_read_b64_tr_b16 v[52:53], v5 offset:57344
    ds_read_b64_tr_b16 v[54:55], v5 offset:58368
    s_waitcnt lgkmcnt(6)
    v_mfma_f32_32x32x16_bf16 v[16:31], v[56:59], v[200:203], v[16:31]
    ds_read_b64_tr_b16 v[56:57], v6 offset:57344
    ds_read_b64_tr_b16 v[58:59], v6 offset:58368
    s_waitcnt lgkmcnt(6)
    v_mfma_f32_32x32x16_bf16 v[16:31], v[60:63], v[204:207], v[16:31]
    ds_read_b64_tr_b16 v[60:61], v7 offset:57344
    ds_read_b64_tr_b16 v[62:63], v7 offset:58368
    s_waitcnt lgkmcnt(6)
    v_mfma_f32_32x32x16_bf16 v[16:31], v[48:51], v[208:211], v[16:31]
    v_xor_b32 v4, 0x10000, v4
    ds_read_b64_tr_b16 v[48:49], v4 offset:8192
    ds_read_b64_tr_b16 v[50:51], v4 offset:9216
    s_waitcnt lgkmcnt(6)
    v_mfma_f32_32x32x16_bf16 v[16:31], v[52:55], v[212:215], v[16:31]
    ds_read_b32 v10, v11 offset:0
    v_xor_b32 v5, 0x10000, v5
    ds_read_b64_tr_b16 v[52:53], v5 offset:8192
    ds_read_b64_tr_b16 v[54:55], v5 offset:9216
    s_waitcnt lgkmcnt(7)
    v_mfma_f32_32x32x16_bf16 v[16:31], v[56:59], v[216:219], v[16:31]
    v_xor_b32 v6, 0x10000, v6
    ds_read_b64_tr_b16 v[56:57], v6 offset:8192
    ds_read_b64_tr_b16 v[58:59], v6 offset:9216
    s_waitcnt lgkmcnt(7)
    v_mfma_f32_32x32x16_bf16 v[16:31], v[60:63], v[220:223], v[16:31]
    v_xor_b32 v7, 0x10000, v7
    ds_read_b64_tr_b16 v[60:61], v7 offset:8192
    ds_read_b64_tr_b16 v[62:63], v7 offset:9216
    s_waitcnt lgkmcnt(7)
    v_mfma_f32_32x32x16_bf16 v[16:31], v[48:51], v[224:227], v[16:31]
    ds_read_b64_tr_b16 v[48:49], v4 offset:24576
    ds_read_b64_tr_b16 v[50:51], v4 offset:25600
    s_waitcnt lgkmcnt(6)
    v_mfma_f32_32x32x16_bf16 v[16:31], v[52:55], v[228:231], v[16:31]
    ds_read_b64_tr_b16 v[52:53], v5 offset:24576
    ds_read_b64_tr_b16 v[54:55], v5 offset:25600
    s_waitcnt lgkmcnt(6)
    v_mfma_f32_32x32x16_bf16 v[16:31], v[56:59], v[232:235], v[16:31]
    ds_read_b64_tr_b16 v[56:57], v6 offset:24576
    ds_read_b64_tr_b16 v[58:59], v6 offset:25600
    s_waitcnt lgkmcnt(6)
    v_mfma_f32_32x32x16_bf16 v[16:31], v[60:63], v[236:239], v[16:31]
    ds_read_b64_tr_b16 v[60:61], v7 offset:24576
    ds_read_b64_tr_b16 v[62:63], v7 offset:25600
    v_cvt_pk_bf16_f32 v104, v10, v10
    v_lshl_or_b32 v106, v108, 16, v108
    s_waitcnt lgkmcnt(6)
    v_mfma_f32_32x32x16_bf16 v[16:31], v[48:51], v[240:243], v[16:31]
    v_and_b32 v8, 0xffff0000, v104
    v_sub_f32 v8, v10, v8
    s_waitcnt lgkmcnt(4)
    v_mfma_f32_32x32x16_bf16 v[16:31], v[52:55], v[244:247], v[16:31]
    v_cvt_pk_bf16_f32 v105, v8, v8
    s_waitcnt lgkmcnt(2)
    v_mfma_f32_32x32x16_bf16 v[16:31], v[56:59], v[248:251], v[16:31]
    s_waitcnt lgkmcnt(0)
    v_mfma_f32_32x32x16_bf16 v[16:31], v[60:63], v[252:255], v[16:31]
    v_mfma_f32_32x32x16_bf16 v[16:31], v[104:107], v[100:103], v[16:31]
    s_setprio 0
    v_xor_b32 v4, 64, v4
    v_xor_b32 v5, 64, v5
    v_xor_b32 v6, 64, v6
    v_xor_b32 v7, 64, v7
    s_nop 6
    v_mul_f32 v32, v16, v16
    v_mul_f32 v33, v17, v17
    v_mul_f32 v34, v18, v18
    v_mul_f32 v35, v19, v19
    v_mul_f32 v36, v20, v20
    v_mul_f32 v37, v21, v21
    v_mul_f32 v38, v22, v22
    v_mul_f32 v39, v23, v23
    v_mul_f32 v40, v24, v24
    v_mul_f32 v41, v25, v25
    v_mul_f32 v42, v26, v26
    v_mul_f32 v43, v27, v27
    v_mul_f32 v44, v28, v28
    v_mul_f32 v45, v29, v29
    v_mul_f32 v46, v30, v30
    v_mul_f32 v47, v31, v31
    v_fma_f32 v32, v32, v113, v112
    v_fma_f32 v33, v33, v113, v112
    v_fma_f32 v34, v34, v113, v112
    v_fma_f32 v35, v35, v113, v112
    v_fma_f32 v36, v36, v113, v112
    v_fma_f32 v37, v37, v113, v112
    v_fma_f32 v38, v38, v113, v112
    v_fma_f32 v39, v39, v113, v112
    v_fma_f32 v40, v40, v113, v112
    v_fma_f32 v41, v41, v113, v112
    v_fma_f32 v42, v42, v113, v112
    v_fma_f32 v43, v43, v113, v112
    v_fma_f32 v44, v44, v113, v112
    v_fma_f32 v45, v45, v113, v112
    v_fma_f32 v46, v46, v113, v112
    v_fma_f32 v47, v47, v113, v112
    v_mul_f32 v32, v32, v16
    v_mul_f32 v33, v33, v17
    v_mul_f32 v34, v34, v18
    v_mul_f32 v35, v35, v19
    v_mul_f32 v36, v36, v20
    v_mul_f32 v37, v37, v21
    v_mul_f32 v38, v38, v22
    v_mul_f32 v39, v39, v23
    v_mul_f32 v40, v40, v24
    v_mul_f32 v41, v41, v25
    v_mul_f32 v42, v42, v26
    v_mul_f32 v43, v43, v27
    v_mul_f32 v44, v44, v28
    v_mul_f32 v45, v45, v29
    v_mul_f32 v46, v46, v30
    v_mul_f32 v47, v47, v31
    v_exp_f32 v32, v32
    v_exp_f32 v33, v33
    v_exp_f32 v34, v34
    v_exp_f32 v35, v35
    v_exp_f32 v36, v36
    v_exp_f32 v37, v37
    v_exp_f32 v38, v38
    v_exp_f32 v39, v39
    v_exp_f32 v40, v40
    v_exp_f32 v41, v41
    v_exp_f32 v42, v42
    v_exp_f32 v43, v43
    v_exp_f32 v44, v44
    v_exp_f32 v45, v45
    v_exp_f32 v46, v46
    v_exp_f32 v47, v47
    v_fma_f32 v32, v32, v114, v114
    v_fma_f32 v33, v33, v114, v114
    v_fma_f32 v34, v34, v114, v114
    v_fma_f32 v35, v35, v114, v114
    v_fma_f32 v36, v36, v114, v114
    v_fma_f32 v37, v37, v114, v114
    v_fma_f32 v38, v38, v114, v114
    v_fma_f32 v39, v39, v114, v114
    v_fma_f32 v40, v40, v114, v114
    v_fma_f32 v41, v41, v114, v114
    v_fma_f32 v42, v42, v114, v114
    v_fma_f32 v43, v43, v114, v114
    v_fma_f32 v44, v44, v114, v114
    v_fma_f32 v45, v45, v114, v114
    v_fma_f32 v46, v46, v114, v114
    v_fma_f32 v47, v47, v114, v114
    v_rcp_f32 v32, v32
    v_rcp_f32 v33, v33
    v_rcp_f32 v34, v34
    v_rcp_f32 v35, v35
    v_rcp_f32 v36, v36
    v_rcp_f32 v37, v37
    v_rcp_f32 v38, v38
    v_rcp_f32 v39, v39
    v_rcp_f32 v40, v40
    v_rcp_f32 v41, v41
    v_rcp_f32 v42, v42
    v_rcp_f32 v43, v43
    v_rcp_f32 v44, v44
    v_rcp_f32 v45, v45
    v_rcp_f32 v46, v46
    v_rcp_f32 v47, v47
    v_mul_f32 v32, v32, v16
    v_mul_f32 v33, v33, v17
    v_mul_f32 v34, v34, v18
    v_mul_f32 v35, v35, v19
    v_mul_f32 v36, v36, v20
    v_mul_f32 v37, v37, v21
    v_mul_f32 v38, v38, v22
    v_mul_f32 v39, v39, v23
    v_mul_f32 v40, v40, v24
    v_mul_f32 v41, v41, v25
    v_mul_f32 v42, v42, v26
    v_mul_f32 v43, v43, v27
    v_mul_f32 v44, v44, v28
    v_mul_f32 v45, v45, v29
    v_mul_f32 v46, v46, v30
    v_mul_f32 v47, v47, v31
    v_cvt_pk_bf16_f32 v116, v32, v33
    v_cvt_pk_bf16_f32 v117, v34, v35
    v_cvt_pk_bf16_f32 v118, v36, v37
    v_cvt_pk_bf16_f32 v119, v38, v39
    v_cvt_pk_bf16_f32 v120, v40, v41
    v_cvt_pk_bf16_f32 v121, v42, v43
    v_cvt_pk_bf16_f32 v122, v44, v45
    v_cvt_pk_bf16_f32 v123, v46, v47
    buffer_store_dwordx4 v[116:119], v2, s[20:23], s54 offen offset:0 sc1
    buffer_store_dwordx4 v[120:123], v2, s[20:23], s54 offen offset:1024 sc1
    s_setprio 2
    ds_read_b64_tr_b16 v[48:49], v4 offset:40960
    ds_read_b64_tr_b16 v[50:51], v4 offset:41984
    ds_read_b64_tr_b16 v[52:53], v5 offset:40960
    ds_read_b64_tr_b16 v[54:55], v5 offset:41984
    ds_read_b64_tr_b16 v[56:57], v6 offset:40960
    ds_read_b64_tr_b16 v[58:59], v6 offset:41984
    ds_read_b64_tr_b16 v[60:61], v7 offset:40960
    ds_read_b64_tr_b16 v[62:63], v7 offset:41984
    s_waitcnt lgkmcnt(6)
    v_mfma_f32_32x32x16_bf16 v[16:31], v[48:51], v[128:131], 0
    ds_read_b64_tr_b16 v[48:49], v4 offset:57344
    ds_read_b64_tr_b16 v[50:51], v4 offset:58368
    s_waitcnt lgkmcnt(6)
    v_mfma_f32_32x32x16_bf16 v[16:31], v[52:55], v[132:135], v[16:31]
    ds_read_b64_tr_b16 v[52:53], v5 offset:57344
    ds_read_b64_tr_b16 v[54:55], v5 offset:58368
    s_waitcnt lgkmcnt(6)
    v_mfma_f32_32x32x16_bf16 v[16:31], v[56:59], v[136:139], v[16:31]
    ds_read_b64_tr_b16 v[56:57], v6 offset:57344
    ds_read_b64_tr_b16 v[58:59], v6 offset:58368
    s_waitcnt lgkmcnt(6)
    v_mfma_f32_32x32x16_bf16 v[16:31], v[60:63], v[140:143], v[16:31]
    ds_read_b64_tr_b16 v[60:61], v7 offset:57344
    ds_read_b64_tr_b16 v[62:63], v7 offset:58368
    s_waitcnt lgkmcnt(6)
    v_mfma_f32_32x32x16_bf16 v[16:31], v[48:51], v[144:147], v[16:31]
    v_xor_b32 v4, 0x10000, v4
    ds_read_b64_tr_b16 v[48:49], v4 offset:8192
    ds_read_b64_tr_b16 v[50:51], v4 offset:9216
    s_waitcnt lgkmcnt(6)
    v_mfma_f32_32x32x16_bf16 v[16:31], v[52:55], v[148:151], v[16:31]
    v_xor_b32 v5, 0x10000, v5
    ds_read_b64_tr_b16 v[52:53], v5 offset:8192
    ds_read_b64_tr_b16 v[54:55], v5 offset:9216
    s_waitcnt lgkmcnt(6)
    v_mfma_f32_32x32x16_bf16 v[16:31], v[56:59], v[152:155], v[16:31]
    v_xor_b32 v6, 0x10000, v6
    ds_read_b64_tr_b16 v[56:57], v6 offset:8192
    ds_read_b64_tr_b16 v[58:59], v6 offset:9216
    s_waitcnt lgkmcnt(6)
    v_mfma_f32_32x32x16_bf16 v[16:31], v[60:63], v[156:159], v[16:31]
    v_xor_b32 v7, 0x10000, v7
    ds_read_b64_tr_b16 v[60:61], v7 offset:8192
    ds_read_b64_tr_b16 v[62:63], v7 offset:9216
    s_waitcnt lgkmcnt(6)
    v_mfma_f32_32x32x16_bf16 v[16:31], v[48:51], v[160:163], v[16:31]
    ds_read_b64_tr_b16 v[48:49], v4 offset:24576
    ds_read_b64_tr_b16 v[50:51], v4 offset:25600
    s_waitcnt lgkmcnt(6)
    v_mfma_f32_32x32x16_bf16 v[16:31], v[52:55], v[164:167], v[16:31]
    ds_read_b64_tr_b16 v[52:53], v5 offset:24576
    ds_read_b64_tr_b16 v[54:55], v5 offset:25600
    s_waitcnt lgkmcnt(6)
    v_mfma_f32_32x32x16_bf16 v[16:31], v[56:59], v[168:171], v[16:31]
    ds_read_b64_tr_b16 v[56:57], v6 offset:24576
    ds_read_b64_tr_b16 v[58:59], v6 offset:25600
    s_waitcnt lgkmcnt(6)
    v_mfma_f32_32x32x16_bf16 v[16:31], v[60:63], v[172:175], v[16:31]
    ds_read_b64_tr_b16 v[60:61], v7 offset:24576
    ds_read_b64_tr_b16 v[62:63], v7 offset:25600
    s_waitcnt lgkmcnt(6)
    v_mfma_f32_32x32x16_bf16 v[16:31], v[48:51], v[176:179], v[16:31]
    ds_read_b64_tr_b16 v[48:49], v4 offset:40960
    ds_read_b64_tr_b16 v[50:51], v4 offset:41984
    s_waitcnt lgkmcnt(6)
    v_mfma_f32_32x32x16_bf16 v[16:31], v[52:55], v[180:183], v[16:31]
    ds_read_b64_tr_b16 v[52:53], v5 offset:40960
    ds_read_b64_tr_b16 v[54:55], v5 offset:41984
    s_waitcnt lgkmcnt(6)
    v_mfma_f32_32x32x16_bf16 v[16:31], v[56:59], v[184:187], v[16:31]
    ds_read_b64_tr_b16 v[56:57], v6 offset:40960
    ds_read_b64_tr_b16 v[58:59], v6 offset:41984
    s_waitcnt lgkmcnt(6)
    v_mfma_f32_32x32x16_bf16 v[16:31], v[60:63], v[188:191], v[16:31]
    ds_read_b64_tr_b16 v[60:61], v7 offset:40960
    ds_read_b64_tr_b16 v[62:63], v7 offset:41984
    s_waitcnt lgkmcnt(6)
    v_mfma_f32_32x32x16_bf16 v[16:31], v[48:51], v[192:195], v[16:31]
    ds_read_b64_tr_b16 v[48:49], v4 offset:57344
    ds_read_b64_tr_b16 v[50:51], v4 offset:58368
    s_waitcnt lgkmcnt(6)
    v_mfma_f32_32x32x16_bf16 v[16:31], v[52:55], v[196:199], v[16:31]
    ds_read_b64_tr_b16 v[52:53], v5 offset:57344
    ds_read_b64_tr_b16 v[54:55], v5 offset:58368
    s_waitcnt lgkmcnt(6)
    v_mfma_f32_32x32x16_bf16 v[16:31], v[56:59], v[200:203], v[16:31]
    ds_read_b64_tr_b16 v[56:57], v6 offset:57344
    ds_read_b64_tr_b16 v[58:59], v6 offset:58368
    s_waitcnt lgkmcnt(6)
    v_mfma_f32_32x32x16_bf16 v[16:31], v[60:63], v[204:207], v[16:31]
    ds_read_b64_tr_b16 v[60:61], v7 offset:57344
    ds_read_b64_tr_b16 v[62:63], v7 offset:58368
    s_waitcnt lgkmcnt(6)
    v_mfma_f32_32x32x16_bf16 v[16:31], v[48:51], v[208:211], v[16:31]
    v_xor_b32 v4, 0x10000, v4
    ds_read_b64_tr_b16 v[48:49], v4 offset:8192
    ds_read_b64_tr_b16 v[50:51], v4 offset:9216
    s_waitcnt lgkmcnt(6)
    v_mfma_f32_32x32x16_bf16 v[16:31], v[52:55], v[212:215], v[16:31]
    ds_read_b32 v10, v11 offset:128
    v_xor_b32 v5, 0x10000, v5
    ds_read_b64_tr_b16 v[52:53], v5 offset:8192
    ds_read_b64_tr_b16 v[54:55], v5 offset:9216
    s_waitcnt lgkmcnt(7)
    v_mfma_f32_32x32x16_bf16 v[16:31], v[56:59], v[216:219], v[16:31]
    v_xor_b32 v6, 0x10000, v6
    ds_read_b64_tr_b16 v[56:57], v6 offset:8192
    ds_read_b64_tr_b16 v[58:59], v6 offset:9216
    s_waitcnt lgkmcnt(7)
    v_mfma_f32_32x32x16_bf16 v[16:31], v[60:63], v[220:223], v[16:31]
    v_xor_b32 v7, 0x10000, v7
    ds_read_b64_tr_b16 v[60:61], v7 offset:8192
    ds_read_b64_tr_b16 v[62:63], v7 offset:9216
    s_waitcnt lgkmcnt(7)
    v_mfma_f32_32x32x16_bf16 v[16:31], v[48:51], v[224:227], v[16:31]
    ds_read_b64_tr_b16 v[48:49], v4 offset:24576
    ds_read_b64_tr_b16 v[50:51], v4 offset:25600
    s_waitcnt lgkmcnt(6)
    v_mfma_f32_32x32x16_bf16 v[16:31], v[52:55], v[228:231], v[16:31]
    ds_read_b64_tr_b16 v[52:53], v5 offset:24576
    ds_read_b64_tr_b16 v[54:55], v5 offset:25600
    s_waitcnt lgkmcnt(6)
    v_mfma_f32_32x32x16_bf16 v[16:31], v[56:59], v[232:235], v[16:31]
    ds_read_b64_tr_b16 v[56:57], v6 offset:24576
    ds_read_b64_tr_b16 v[58:59], v6 offset:25600
    s_waitcnt lgkmcnt(6)
    v_mfma_f32_32x32x16_bf16 v[16:31], v[60:63], v[236:239], v[16:31]
    ds_read_b64_tr_b16 v[60:61], v7 offset:24576
    ds_read_b64_tr_b16 v[62:63], v7 offset:25600
    v_cvt_pk_bf16_f32 v104, v10, v10
    v_lshl_or_b32 v106, v109, 16, v109
    s_waitcnt lgkmcnt(6)
    v_mfma_f32_32x32x16_bf16 v[16:31], v[48:51], v[240:243], v[16:31]
    v_and_b32 v8, 0xffff0000, v104
    v_sub_f32 v8, v10, v8
    s_waitcnt lgkmcnt(4)
    v_mfma_f32_32x32x16_bf16 v[16:31], v[52:55], v[244:247], v[16:31]
    v_cvt_pk_bf16_f32 v105, v8, v8
    s_waitcnt lgkmcnt(2)
    v_mfma_f32_32x32x16_bf16 v[16:31], v[56:59], v[248:251], v[16:31]
    s_waitcnt lgkmcnt(0)
    v_mfma_f32_32x32x16_bf16 v[16:31], v[60:63], v[252:255], v[16:31]
    v_mfma_f32_32x32x16_bf16 v[16:31], v[104:107], v[100:103], v[16:31]
    s_barrier
    s_add_u32 m0, s59, 8192
    s_add_u32 s50, s63, 2105344
    buffer_load_dwordx4 v2, s[20:23], s50 offen sc1 lds
    s_sub_u32 m0, 138240, s59
    s_add_u32 s50, s63, 4202496
    buffer_load_dwordx4 v2, s[20:23], s50 offen sc1 lds
    s_add_u32 m0, s59, 12288
    s_add_u32 s50, s63, 2109440
    buffer_load_dwordx4 v2, s[20:23], s50 offen sc1 lds
    s_sub_u32 m0, 134144, s59
    s_add_u32 s50, s63, 4206592
    buffer_load_dwordx4 v2, s[20:23], s50 offen sc1 lds
    s_setprio 1
    v_mul_f32 v32, v16, v16
    v_mul_f32 v33, v17, v17
    v_mul_f32 v34, v18, v18
    v_mul_f32 v35, v19, v19
    v_mul_f32 v36, v20, v20
    v_mul_f32 v37, v21, v21
    v_mul_f32 v38, v22, v22
    v_mul_f32 v39, v23, v23
    v_mul_f32 v40, v24, v24
    v_mul_f32 v41, v25, v25
    v_mul_f32 v42, v26, v26
    v_mul_f32 v43, v27, v27
    v_mul_f32 v44, v28, v28
    v_mul_f32 v45, v29, v29
    v_mul_f32 v46, v30, v30
    v_mul_f32 v47, v31, v31
    v_fma_f32 v32, v32, v113, v112
    v_fma_f32 v33, v33, v113, v112
    v_fma_f32 v34, v34, v113, v112
    v_fma_f32 v35, v35, v113, v112
    v_fma_f32 v36, v36, v113, v112
    v_fma_f32 v37, v37, v113, v112
    v_fma_f32 v38, v38, v113, v112
    v_fma_f32 v39, v39, v113, v112
    v_fma_f32 v40, v40, v113, v112
    v_fma_f32 v41, v41, v113, v112
    v_fma_f32 v42, v42, v113, v112
    v_fma_f32 v43, v43, v113, v112
    v_fma_f32 v44, v44, v113, v112
    v_fma_f32 v45, v45, v113, v112
    v_fma_f32 v46, v46, v113, v112
    v_fma_f32 v47, v47, v113, v112
    v_mul_f32 v32, v32, v16
    v_mul_f32 v33, v33, v17
    v_mul_f32 v34, v34, v18
    v_mul_f32 v35, v35, v19
    v_mul_f32 v36, v36, v20
    v_mul_f32 v37, v37, v21
    v_mul_f32 v38, v38, v22
    v_mul_f32 v39, v39, v23
    v_mul_f32 v40, v40, v24
    v_mul_f32 v41, v41, v25
    v_mul_f32 v42, v42, v26
    v_mul_f32 v43, v43, v27
    v_mul_f32 v44, v44, v28
    v_mul_f32 v45, v45, v29
    v_mul_f32 v46, v46, v30
    v_mul_f32 v47, v47, v31
    v_exp_f32 v32, v32
    v_exp_f32 v33, v33
    v_exp_f32 v34, v34
    v_exp_f32 v35, v35
    v_exp_f32 v36, v36
    v_exp_f32 v37, v37
    v_exp_f32 v38, v38
    v_exp_f32 v39, v39
    v_exp_f32 v40, v40
    v_exp_f32 v41, v41
    v_exp_f32 v42, v42
    v_exp_f32 v43, v43
    v_exp_f32 v44, v44
    v_exp_f32 v45, v45
    v_exp_f32 v46, v46
    v_exp_f32 v47, v47
    v_fma_f32 v32, v32, v114, v114
    v_fma_f32 v33, v33, v114, v114
    v_fma_f32 v34, v34, v114, v114
    v_fma_f32 v35, v35, v114, v114
    v_fma_f32 v36, v36, v114, v114
    v_fma_f32 v37, v37, v114, v114
    v_fma_f32 v38, v38, v114, v114
    v_fma_f32 v39, v39, v114, v114
    v_fma_f32 v40, v40, v114, v114
    v_fma_f32 v41, v41, v114, v114
    v_fma_f32 v42, v42, v114, v114
    v_fma_f32 v43, v43, v114, v114
    v_fma_f32 v44, v44, v114, v114
    v_fma_f32 v45, v45, v114, v114
    v_fma_f32 v46, v46, v114, v114
    v_fma_f32 v47, v47, v114, v114
    v_rcp_f32 v32, v32
    v_rcp_f32 v33, v33
    v_rcp_f32 v34, v34
    v_rcp_f32 v35, v35
    v_rcp_f32 v36, v36
    v_rcp_f32 v37, v37
    v_rcp_f32 v38, v38
    v_rcp_f32 v39, v39
    v_rcp_f32 v40, v40
    v_rcp_f32 v41, v41
    v_rcp_f32 v42, v42
    v_rcp_f32 v43, v43
    v_rcp_f32 v44, v44
    v_rcp_f32 v45, v45
    v_rcp_f32 v46, v46
    v_rcp_f32 v47, v47
    v_mul_f32 v32, v32, v16
    v_mul_f32 v33, v33, v17
    v_mul_f32 v34, v34, v18
    v_mul_f32 v35, v35, v19
    v_mul_f32 v36, v36, v20
    v_mul_f32 v37, v37, v21
    v_mul_f32 v38, v38, v22
    v_mul_f32 v39, v39, v23
    v_mul_f32 v40, v40, v24
    v_mul_f32 v41, v41, v25
    v_mul_f32 v42, v42, v26
    v_mul_f32 v43, v43, v27
    v_mul_f32 v44, v44, v28
    v_mul_f32 v45, v45, v29
    v_mul_f32 v46, v46, v30
    v_mul_f32 v47, v47, v31
    v_cvt_pk_bf16_f32 v116, v32, v33
    v_cvt_pk_bf16_f32 v117, v34, v35
    v_cvt_pk_bf16_f32 v118, v36, v37
    v_cvt_pk_bf16_f32 v119, v38, v39
    v_cvt_pk_bf16_f32 v120, v40, v41
    v_cvt_pk_bf16_f32 v121, v42, v43
    v_cvt_pk_bf16_f32 v122, v44, v45
    v_cvt_pk_bf16_f32 v123, v46, v47
    buffer_store_dwordx4 v[116:119], v2, s[20:23], s54 offen offset:2048 sc1
    buffer_store_dwordx4 v[120:123], v2, s[20:23], s54 offen offset:3072 sc1
    s_branch L_g1
L_gb1:
    s_barrier
    s_add_u32 m0, s59, 8192
    s_add_u32 s50, s63, 2105344
    buffer_load_dwordx4 v2, s[20:23], s50 offen sc1 lds
    s_sub_u32 m0, 138240, s59
    s_add_u32 s50, s63, 4202496
    buffer_load_dwordx4 v2, s[20:23], s50 offen sc1 lds
    s_add_u32 m0, s59, 12288
    s_add_u32 s50, s63, 2109440
    buffer_load_dwordx4 v2, s[20:23], s50 offen sc1 lds
    s_sub_u32 m0, 134144, s59
    s_add_u32 s50, s63, 4206592
    buffer_load_dwordx4 v2, s[20:23], s50 offen sc1 lds
L_g1:
    s_setprio 1
    s_add_u32 m0, s59, 16384
    s_add_u32 s50, s63, 2113536
    buffer_load_dwordx4 v2, s[20:23], s50 offen sc1 lds
    s_sub_u32 m0, 130048, s59
    s_add_u32 s50, s63, 4210688
    buffer_load_dwordx4 v2, s[20:23], s50 offen sc1 lds
    s_add_u32 m0, s59, 20480
    s_add_u32 s50, s63, 2117632
    buffer_load_dwordx4 v2, s[20:23], s50 offen sc1 lds
    s_sub_u32 m0, 125952, s59
    s_add_u32 s50, s63, 4214784
    buffer_load_dwordx4 v2, s[20:23], s50 offen sc1 lds
    s_add_u32 m0, s59, 24576
    s_add_u32 s50, s63, 2121728
    buffer_load_dwordx4 v2, s[20:23], s50 offen sc1 lds
    s_sub_u32 m0, 121856, s59
    s_add_u32 s50, s63, 4218880
    buffer_load_dwordx4 v2, s[20:23], s50 offen sc1 lds
    s_add_u32 m0, s59, 28672
    s_add_u32 s50, s63, 2125824
    buffer_load_dwordx4 v2, s[20:23], s50 offen sc1 lds
    s_sub_u32 m0, 117760, s59
    s_add_u32 s50, s63, 4222976
    buffer_load_dwordx4 v2, s[20:23], s50 offen sc1 lds
    s_add_u32 m0, s59, 32768
    s_add_u32 s50, s63, 2129920
    buffer_load_dwordx4 v2, s[20:23], s50 offen sc1 lds
    s_sub_u32 m0, 113664, s59
    s_add_u32 s50, s63, 4227072
    buffer_load_dwordx4 v2, s[20:23], s50 offen sc1 lds
    s_add_u32 m0, s59, 36864
    s_add_u32 s50, s63, 2134016
    buffer_load_dwordx4 v2, s[20:23], s50 offen sc1 lds
    s_sub_u32 m0, 109568, s59
    s_add_u32 s50, s63, 4231168
    buffer_load_dwordx4 v2, s[20:23], s50 offen sc1 lds
    s_add_u32 m0, s59, 40960
    s_add_u32 s50, s63, 2138112
    buffer_load_dwordx4 v2, s[20:23], s50 offen sc1 lds
    s_sub_u32 m0, 105472, s59
    s_add_u32 s50, s63, 4235264
    buffer_load_dwordx4 v2, s[20:23], s50 offen sc1 lds
    s_add_u32 m0, s59, 45056
    s_add_u32 s50, s63, 2142208
    buffer_load_dwordx4 v2, s[20:23], s50 offen sc1 lds
    s_sub_u32 m0, 101376, s59
    s_add_u32 s50, s63, 4239360
    buffer_load_dwordx4 v2, s[20:23], s50 offen sc1 lds
    s_add_u32 m0, s59, 49152
    s_add_u32 s50, s63, 2146304
    buffer_load_dwordx4 v2, s[20:23], s50 offen sc1 lds
    s_sub_u32 m0, 97280, s59
    s_add_u32 s50, s63, 4243456
    buffer_load_dwordx4 v2, s[20:23], s50 offen sc1 lds
    s_add_u32 m0, s59, 53248
    s_add_u32 s50, s63, 2150400
    buffer_load_dwordx4 v2, s[20:23], s50 offen sc1 lds
    s_sub_u32 m0, 93184, s59
    s_add_u32 s50, s63, 4247552
    buffer_load_dwordx4 v2, s[20:23], s50 offen sc1 lds
    s_add_u32 m0, s59, 57344
    s_add_u32 s50, s63, 2154496
    buffer_load_dwordx4 v2, s[20:23], s50 offen sc1 lds
    s_sub_u32 m0, 89088, s59
    s_add_u32 s50, s63, 4251648
    buffer_load_dwordx4 v2, s[20:23], s50 offen sc1 lds
    s_add_u32 m0, s59, 61440
    s_add_u32 s50, s63, 2158592
    buffer_load_dwordx4 v2, s[20:23], s50 offen sc1 lds
    s_sub_u32 m0, 84992, s59
    s_add_u32 s50, s63, 4255744
    buffer_load_dwordx4 v2, s[20:23], s50 offen sc1 lds
    s_lshl_b32 s50, s2, 2
    s_add_u32 s50, s50, s44
    s_mul_i32 s51, s50, 1792
    s_lshl_b32 s50, s50, 9
    v_min_u32 v152, 13, v1
    v_lshlrev_b32 v152, 7, v152
    v_min_u32 v153, 384, v152
    buffer_load_dword v127, v152, s[24:27], s51 offen
    buffer_load_dword v127, v153, s[28:31], s50 offen
    v_mov_b32 v120, v124
    v_add_u32 v121, 7168, v124
    s_add_u32 s50, s49, 65536
    v_add_u32 v4, s50, v125
    v_xor_b32 v5, 64, v4
    s_lshl_b32 s59, s44, 11
    s_add_u32 s50, s59, 147456
    v_add_u32 v6, s50, v125
    v_xor_b32 v7, 64, v6
    v_mov_b32 v147, 163328
    s_lshr_b32 s52, s44, 1
    s_lshl_b32 s50, s58, 7
    s_lshl_b32 s51, s52, 6
    s_add_u32 s50, s50, s51
    v_and_b32 v154, 16, v126
    v_add_u32 v154, s50, v154
    s_lshl_b32 s55, s57, 1
    s_and_b32 s51, s44, 1
    s_add_u32 s55, s55, s51
    s_lshl_b32 s55, s55, 15
    s_add_u32 s55, s55, s50
    s_lshr_b32 s50, s57, 1
    s_add_u32 s50, s50, 16
    s_lshl_b32 s50, s50, 7
    s_add_u32 s50, s50, 17825792
    v_mov_b32 v155, s50
    s_lshl_b32 s97, s57, 1
    s_and_b32 s50, s44, 1
    s_add_u32 s51, s97, s50
    s_xor_b32 s98, s51, 1
    s_mul_i32 s97, s51, 114688
    s_mul_i32 s98, s98, 114688
    s_mul_i32 s50, s44, 28672
    s_add_u32 s50, s50, 10485760
    s_add_u32 s97, s97, s50
    s_add_u32 s98, s98, s50
    s_mul_i32 s99, s44, 458752
    s_lshl_b32 s50, s58, 7
    s_add_u32 s99, s99, s50
    s_waitcnt vmcnt(26)
    s_barrier
    s_cmp_lg_u32 s3, 4
    s_cbranch_scc1 L_g3
    s_cmp_eq_u32 s53, 0
    s_cbranch_scc1 L_g3
    s_add_u32 s52, s42, 16
    s_lshl_b32 s50, s52, 7
    s_add_u32 s50, s50, 17825792
    v_mov_b32 v156, 1
    v_mov_b32 v157, 0
    s_mov_b64 exec, 1
    buffer_atomic_add v156, v157, s[20:23], s50 offen sc1
    s_mov_b64 exec, -1
L_g3:
    s_waitcnt vmcnt(0)
    s_barrier
    global_load_dwordx4 v[128:131], v154, s[38:39]
    global_load_dwordx4 v[132:135], v154, s[38:39] offset:32
    buffer_load_dwordx4 v[136:139], v126, s[8:11], s55 offen
    buffer_load_dwordx4 v[140:143], v126, s[8:11], s55 offen offset:32
    s_mov_b32 s60, 200000
    s_mov_b64 exec, 1
L_pl6:
    buffer_load_dword v153, v155, s[20:23], 0 offen sc1
    s_waitcnt vmcnt(0)
    v_cmp_ne_u32 vcc, 14, v153
    s_cbranch_vccz L_pd6
    s_sleep 8
    s_sub_u32 s60, s60, 1
    s_cbranch_scc0 L_pl6
L_pd6:
    s_mov_b64 exec, -1
    s_setprio 0
    s_add_u32 m0, s49, 65536
    s_add_u32 s50, s99, 0
    buffer_load_dwordx4 v120, s[24:27], s50 offen lds
    buffer_load_dwordx4 v121, s[24:27], s50 offen offset:1024 lds
    s_add_u32 s50, s97, 0
    buffer_load_dwordx4 v[80:83], v2, s[20:23], s50 offen sc1
    s_add_u32 s50, s98, 0
    buffer_load_dwordx4 v[84:87], v2, s[20:23], s50 offen sc1
    s_add_u32 m0, s49, 67584
    s_add_u32 s50, s99, 16384
    buffer_load_dwordx4 v120, s[24:27], s50 offen lds
    buffer_load_dwordx4 v121, s[24:27], s50 offen offset:1024 lds
    s_add_u32 s50, s97, 1024
    buffer_load_dwordx4 v[88:91], v2, s[20:23], s50 offen sc1
    s_add_u32 s50, s98, 1024
    buffer_load_dwordx4 v[92:95], v2, s[20:23], s50 offen sc1
    s_add_u32 m0, s59, 147456
    s_add_u32 s50, s99, 32768
    buffer_load_dwordx4 v120, s[24:27], s50 offen lds
    buffer_load_dwordx4 v121, s[24:27], s50 offen offset:1024 lds
    s_add_u32 s50, s97, 2048
    buffer_load_dwordx4 v[96:99], v2, s[20:23], s50 offen sc1
    s_add_u32 s50, s98, 2048
    buffer_load_dwordx4 v[100:103], v2, s[20:23], s50 offen sc1
    s_waitcnt vmcnt(8)
    ds_read_b64_tr_b16 v[104:105], v4 offset:0
    ds_read_b64_tr_b16 v[106:107], v4 offset:1024
    ds_read_b64_tr_b16 v[108:109], v5 offset:0
    ds_read_b64_tr_b16 v[110:111], v5 offset:1024
    s_waitcnt vmcnt(4)
    ds_read_b64_tr_b16 v[112:113], v4 offset:2048
    ds_read_b64_tr_b16 v[114:115], v4 offset:3072
    ds_read_b64_tr_b16 v[116:117], v5 offset:2048
    ds_read_b64_tr_b16 v[118:119], v5 offset:3072
    s_waitcnt lgkmcnt(4)
    v_mfma_f32_32x32x16_bf16 v[16:31], v[104:107], v[80:83], 0
    v_mfma_f32_32x32x16_bf16 v[32:47], v[104:107], v[84:87], 0
    v_mfma_f32_32x32x16_bf16 v[48:63], v[108:111], v[80:83], 0
    v_mfma_f32_32x32x16_bf16 v[64:79], v[108:111], v[84:87], 0
    s_add_u32 m0, s49, 65536
    s_add_u32 s50, s99, 49152
    buffer_load_dwordx4 v120, s[24:27], s50 offen lds
    buffer_load_dwordx4 v121, s[24:27], s50 offen offset:1024 lds
    s_add_u32 s50, s97, 3072
    buffer_load_dwordx4 v[80:83], v2, s[20:23], s50 offen sc1
    s_add_u32 s50, s98, 3072
    buffer_load_dwordx4 v[84:87], v2, s[20:23], s50 offen sc1
    s_waitcnt vmcnt(4)
    ds_read_b64_tr_b16 v[104:105], v6 offset:0
    ds_read_b64_tr_b16 v[106:107], v6 offset:1024
    ds_read_b64_tr_b16 v[108:109], v7 offset:0
    ds_read_b64_tr_b16 v[110:111], v7 offset:1024
    s_waitcnt lgkmcnt(4)
    v_mfma_f32_32x32x16_bf16 v[16:31], v[112:115], v[88:91], v[16:31]
    v_mfma_f32_32x32x16_bf16 v[32:47], v[112:115], v[92:95], v[32:47]
    v_mfma_f32_32x32x16_bf16 v[48:63], v[116:119], v[88:91], v[48:63]
    v_mfma_f32_32x32x16_bf16 v[64:79], v[116:119], v[92:95], v[64:79]
    s_add_u32 m0, s49, 67584
    s_add_u32 s50, s99, 65536
    buffer_load_dwordx4 v120, s[24:27], s50 offen lds
    buffer_load_dwordx4 v121, s[24:27], s50 offen offset:1024 lds
    s_add_u32 s50, s97, 4096
    buffer_load_dwordx4 v[88:91], v2, s[20:23], s50 offen sc1
    s_add_u32 s50, s98, 4096
    buffer_load_dwordx4 v[92:95], v2, s[20:23], s50 offen sc1
    s_waitcnt vmcnt(4)
    ds_read_b64_tr_b16 v[112:113], v4 offset:0
    ds_read_b64_tr_b16 v[114:115], v4 offset:1024
    ds_read_b64_tr_b16 v[116:117], v5 offset:0
    ds_read_b64_tr_b16 v[118:119], v5 offset:1024
    s_waitcnt lgkmcnt(4)
    v_mfma_f32_32x32x16_bf16 v[16:31], v[104:107], v[96:99], v[16:31]
    v_mfma_f32_32x32x16_bf16 v[32:47], v[104:107], v[100:103], v[32:47]
    v_mfma_f32_32x32x16_bf16 v[48:63], v[108:111], v[96:99], v[48:63]
    v_mfma_f32_32x32x16_bf16 v[64:79], v[108:111], v[100:103], v[64:79]
    s_add_u32 m0, s59, 147456
    s_add_u32 s50, s99, 81920
    buffer_load_dwordx4 v120, s[24:27], s50 offen lds
    buffer_load_dwordx4 v121, s[24:27], s50 offen offset:1024 lds
    s_add_u32 s50, s97, 5120
    buffer_load_dwordx4 v[96:99], v2, s[20:23], s50 offen sc1
    s_add_u32 s50, s98, 5120
    buffer_load_dwordx4 v[100:103], v2, s[20:23], s50 offen sc1
    s_waitcnt vmcnt(4)
    ds_read_b64_tr_b16 v[104:105], v4 offset:2048
    ds_read_b64_tr_b16 v[106:107], v4 offset:3072
    ds_read_b64_tr_b16 v[108:109], v5 offset:2048
    ds_read_b64_tr_b16 v[110:111], v5 offset:3072
    s_waitcnt lgkmcnt(4)
    v_mfma_f32_32x32x16_bf16 v[16:31], v[112:115], v[80:83], v[16:31]
    v_mfma_f32_32x32x16_bf16 v[32:47], v[112:115], v[84:87], v[32:47]
    v_mfma_f32_32x32x16_bf16 v[48:63], v[116:119], v[80:83], v[48:63]
    v_mfma_f32_32x32x16_bf16 v[64:79], v[116:119], v[84:87], v[64:79]
    s_add_u32 m0, s49, 65536
    s_add_u32 s50, s99, 98304
    buffer_load_dwordx4 v120, s[24:27], s50 offen lds
    buffer_load_dwordx4 v121, s[24:27], s50 offen offset:1024 lds
    s_add_u32 s50, s97, 6144
    buffer_load_dwordx4 v[80:83], v2, s[20:23], s50 offen sc1
    s_add_u32 s50, s98, 6144
    buffer_load_dwordx4 v[84:87], v2, s[20:23], s50 offen sc1
    s_waitcnt vmcnt(4)
    ds_read_b64_tr_b16 v[112:113], v6 offset:0
    ds_read_b64_tr_b16 v[114:115], v6 offset:1024
    ds_read_b64_tr_b16 v[116:117], v7 offset:0
    ds_read_b64_tr_b16 v[118:119], v7 offset:1024
    s_waitcnt lgkmcnt(4)
    v_mfma_f32_32x32x16_bf16 v[16:31], v[104:107], v[88:91], v[16:31]
    v_mfma_f32_32x32x16_bf16 v[32:47], v[104:107], v[92:95], v[32:47]
    v_mfma_f32_32x32x16_bf16 v[48:63], v[108:111], v[88:91], v[48:63]
    v_mfma_f32_32x32x16_bf16 v[64:79], v[108:111], v[92:95], v[64:79]
    s_add_u32 m0, s49, 67584
    s_add_u32 s50, s99, 114688
    buffer_load_dwordx4 v120, s[24:27], s50 offen lds
    buffer_load_dwordx4 v121, s[24:27], s50 offen offset:1024 lds
    s_add_u32 s50, s97, 7168
    buffer_load_dwordx4 v[88:91], v2, s[20:23], s50 offen sc1
    s_add_u32 s50, s98, 7168
    buffer_load_dwordx4 v[92:95], v2, s[20:23], s50 offen sc1
    s_waitcnt vmcnt(4)
    ds_read_b64_tr_b16 v[104:105], v4 offset:0
    ds_read_b64_tr_b16 v[106:107], v4 offset:1024
    ds_read_b64_tr_b16 v[108:109], v5 offset:0
    ds_read_b64_tr_b16 v[110:111], v5 offset:1024
    s_waitcnt lgkmcnt(4)
    v_mfma_f32_32x32x16_bf16 v[16:31], v[112:115], v[96:99], v[16:31]
    v_mfma_f32_32x32x16_bf16 v[32:47], v[112:115], v[100:103], v[32:47]
    v_mfma_f32_32x32x16_bf16 v[48:63], v[116:119], v[96:99], v[48:63]
    v_mfma_f32_32x32x16_bf16 v[64:79], v[116:119], v[100:103], v[64:79]
    s_add_u32 m0, s59, 147456
    s_add_u32 s50, s99, 131072
    buffer_load_dwordx4 v120, s[24:27], s50 offen lds
    buffer_load_dwordx4 v121, s[24:27], s50 offen offset:1024 lds
    s_add_u32 s50, s97, 8192
    buffer_load_dwordx4 v[96:99], v2, s[20:23], s50 offen sc1
    s_add_u32 s50, s98, 8192
    buffer_load_dwordx4 v[100:103], v2, s[20:23], s50 offen sc1
    s_waitcnt vmcnt(4)
    ds_read_b64_tr_b16 v[112:113], v4 offset:2048
    ds_read_b64_tr_b16 v[114:115], v4 offset:3072
    ds_read_b64_tr_b16 v[116:117], v5 offset:2048
    ds_read_b64_tr_b16 v[118:119], v5 offset:3072
    s_waitcnt lgkmcnt(4)
    v_mfma_f32_32x32x16_bf16 v[16:31], v[104:107], v[80:83], v[16:31]
    v_mfma_f32_32x32x16_bf16 v[32:47], v[104:107], v[84:87], v[32:47]
    v_mfma_f32_32x32x16_bf16 v[48:63], v[108:111], v[80:83], v[48:63]
    v_mfma_f32_32x32x16_bf16 v[64:79], v[108:111], v[84:87], v[64:79]
    s_add_u32 m0, s49, 65536
    s_add_u32 s50, s99, 147456
    buffer_load_dwordx4 v120, s[24:27], s50 offen lds
    buffer_load_dwordx4 v121, s[24:27], s50 offen offset:1024 lds
    s_add_u32 s50, s97, 9216
    buffer_load_dwordx4 v[80:83], v2, s[20:23], s50 offen sc1
    s_add_u32 s50, s98, 9216
    buffer_load_dwordx4 v[84:87], v2, s[20:23], s50 offen sc1
    s_waitcnt vmcnt(4)
    ds_read_b64_tr_b16 v[104:105], v6 offset:0
    ds_read_b64_tr_b16 v[106:107], v6 offset:1024
    ds_read_b64_tr_b16 v[108:109], v7 offset:0
    ds_read_b64_tr_b16 v[110:111], v7 offset:1024
    s_waitcnt lgkmcnt(4)
    v_mfma_f32_32x32x16_bf16 v[16:31], v[112:115], v[88:91], v[16:31]
    v_mfma_f32_32x32x16_bf16 v[32:47], v[112:115], v[92:95], v[32:47]
    v_mfma_f32_32x32x16_bf16 v[48:63], v[116:119], v[88:91], v[48:63]
    v_mfma_f32_32x32x16_bf16 v[64:79], v[116:119], v[92:95], v[64:79]
    s_add_u32 m0, s49, 67584
    s_add_u32 s50, s99, 163840
    buffer_load_dwordx4 v120, s[24:27], s50 offen lds
    buffer_load_dwordx4 v121, s[24:27], s50 offen offset:1024 lds
    s_add_u32 s50, s97, 10240
    buffer_load_dwordx4 v[88:91], v2, s[20:23], s50 offen sc1
    s_add_u32 s50, s98, 10240
    buffer_load_dwordx4 v[92:95], v2, s[20:23], s50 offen sc1
    s_waitcnt vmcnt(4)
    ds_read_b64_tr_b16 v[112:113], v4 offset:0
    ds_read_b64_tr_b16 v[114:115], v4 offset:1024
    ds_read_b64_tr_b16 v[116:117], v5 offset:0
    ds_read_b64_tr_b16 v[118:119], v5 offset:1024
    s_waitcnt lgkmcnt(4)
    v_mfma_f32_32x32x16_bf16 v[16:31], v[104:107], v[96:99], v[16:31]
    v_mfma_f32_32x32x16_bf16 v[32:47], v[104:107], v[100:103], v[32:47]
    v_mfma_f32_32x32x16_bf16 v[48:63], v[108:111], v[96:99], v[48:63]
    v_mfma_f32_32x32x16_bf16 v[64:79], v[108:111], v[100:103], v[64:79]
    s_add_u32 m0, s59, 147456
    s_add_u32 s50, s99, 180224
    buffer_load_dwordx4 v120, s[24:27], s50 offen lds
    buffer_load_dwordx4 v121, s[24:27], s50 offen offset:1024 lds
    s_add_u32 s50, s97, 11264
    buffer_load_dwordx4 v[96:99], v2, s[20:23], s50 offen sc1
    s_add_u32 s50, s98, 11264
    buffer_load_dwordx4 v[100:103], v2, s[20:23], s50 offen sc1
    s_waitcnt vmcnt(4)
    ds_read_b64_tr_b16 v[104:105], v4 offset:2048
    ds_read_b64_tr_b16 v[106:107], v4 offset:3072
    ds_read_b64_tr_b16 v[108:109], v5 offset:2048
    ds_read_b64_tr_b16 v[110:111], v5 offset:3072
    s_waitcnt lgkmcnt(4)
    v_mfma_f32_32x32x16_bf16 v[16:31], v[112:115], v[80:83], v[16:31]
    v_mfma_f32_32x32x16_bf16 v[32:47], v[112:115], v[84:87], v[32:47]
    v_mfma_f32_32x32x16_bf16 v[48:63], v[116:119], v[80:83], v[48:63]
    v_mfma_f32_32x32x16_bf16 v[64:79], v[116:119], v[84:87], v[64:79]
    s_add_u32 m0, s49, 65536
    s_add_u32 s50, s99, 196608
    buffer_load_dwordx4 v120, s[24:27], s50 offen lds
    buffer_load_dwordx4 v121, s[24:27], s50 offen offset:1024 lds
    s_add_u32 s50, s97, 12288
    buffer_load_dwordx4 v[80:83], v2, s[20:23], s50 offen sc1
    s_add_u32 s50, s98, 12288
    buffer_load_dwordx4 v[84:87], v2, s[20:23], s50 offen sc1
    s_waitcnt vmcnt(4)
    ds_read_b64_tr_b16 v[112:113], v6 offset:0
    ds_read_b64_tr_b16 v[114:115], v6 offset:1024
    ds_read_b64_tr_b16 v[116:117], v7 offset:0
    ds_read_b64_tr_b16 v[118:119], v7 offset:1024
    s_waitcnt lgkmcnt(4)
    v_mfma_f32_32x32x16_bf16 v[16:31], v[104:107], v[88:91], v[16:31]
    v_mfma_f32_32x32x16_bf16 v[32:47], v[104:107], v[92:95], v[32:47]
    v_mfma_f32_32x32x16_bf16 v[48:63], v[108:111], v[88:91], v[48:63]
    v_mfma_f32_32x32x16_bf16 v[64:79], v[108:111], v[92:95], v[64:79]
    s_add_u32 m0, s49, 67584
    s_add_u32 s50, s99, 212992
    buffer_load_dwordx4 v120, s[24:27], s50 offen lds
    buffer_load_dwordx4 v121, s[24:27], s50 offen offset:1024 lds
    s_add_u32 s50, s97, 13312
    buffer_load_dwordx4 v[88:91], v2, s[20:23], s50 offen sc1
    s_add_u32 s50, s98, 13312
    buffer_load_dwordx4 v[92:95], v2, s[20:23], s50 offen sc1
    s_waitcnt vmcnt(4)
    ds_read_b64_tr_b16 v[104:105], v4 offset:0
    ds_read_b64_tr_b16 v[106:107], v4 offset:1024
    ds_read_b64_tr_b16 v[108:109], v5 offset:0
    ds_read_b64_tr_b16 v[110:111], v5 offset:1024
    s_waitcnt lgkmcnt(4)
    v_mfma_f32_32x32x16_bf16 v[16:31], v[112:115], v[96:99], v[16:31]
    v_mfma_f32_32x32x16_bf16 v[32:47], v[112:115], v[100:103], v[32:47]
    v_mfma_f32_32x32x16_bf16 v[48:63], v[116:119], v[96:99], v[48:63]
    v_mfma_f32_32x32x16_bf16 v[64:79], v[116:119], v[100:103], v[64:79]
    s_add_u32 m0, s59, 147456
    s_add_u32 s50, s99, 229376
    buffer_load_dwordx4 v120, s[24:27], s50 offen lds
    buffer_load_dwordx4 v121, s[24:27], s50 offen offset:1024 lds
    s_add_u32 s50, s97, 14336
    buffer_load_dwordx4 v[96:99], v2, s[20:23], s50 offen sc1
    s_add_u32 s50, s98, 14336
    buffer_load_dwordx4 v[100:103], v2, s[20:23], s50 offen sc1
    s_waitcnt vmcnt(4)
    ds_read_b64_tr_b16 v[112:113], v4 offset:2048
    ds_read_b64_tr_b16 v[114:115], v4 offset:3072
    ds_read_b64_tr_b16 v[116:117], v5 offset:2048
    ds_read_b64_tr_b16 v[118:119], v5 offset:3072
    s_waitcnt lgkmcnt(4)
    v_mfma_f32_32x32x16_bf16 v[16:31], v[104:107], v[80:83], v[16:31]
    v_mfma_f32_32x32x16_bf16 v[32:47], v[104:107], v[84:87], v[32:47]
    v_mfma_f32_32x32x16_bf16 v[48:63], v[108:111], v[80:83], v[48:63]
    v_mfma_f32_32x32x16_bf16 v[64:79], v[108:111], v[84:87], v[64:79]
    s_add_u32 m0, s49, 65536
    s_add_u32 s50, s99, 245760
    buffer_load_dwordx4 v120, s[24:27], s50 offen lds
    buffer_load_dwordx4 v121, s[24:27], s50 offen offset:1024 lds
    s_add_u32 s50, s97, 15360
    buffer_load_dwordx4 v[80:83], v2, s[20:23], s50 offen sc1
    s_add_u32 s50, s98, 15360
    buffer_load_dwordx4 v[84:87], v2, s[20:23], s50 offen sc1
    s_waitcnt vmcnt(4)
    ds_read_b64_tr_b16 v[104:105], v6 offset:0
    ds_read_b64_tr_b16 v[106:107], v6 offset:1024
    ds_read_b64_tr_b16 v[108:109], v7 offset:0
    ds_read_b64_tr_b16 v[110:111], v7 offset:1024
    s_waitcnt lgkmcnt(4)
    v_mfma_f32_32x32x16_bf16 v[16:31], v[112:115], v[88:91], v[16:31]
    v_mfma_f32_32x32x16_bf16 v[32:47], v[112:115], v[92:95], v[32:47]
    v_mfma_f32_32x32x16_bf16 v[48:63], v[116:119], v[88:91], v[48:63]
    v_mfma_f32_32x32x16_bf16 v[64:79], v[116:119], v[92:95], v[64:79]
    s_add_u32 m0, s49, 67584
    s_add_u32 s50, s99, 262144
    buffer_load_dwordx4 v120, s[24:27], s50 offen lds
    buffer_load_dwordx4 v121, s[24:27], s50 offen offset:1024 lds
    s_add_u32 s50, s97, 16384
    buffer_load_dwordx4 v[88:91], v2, s[20:23], s50 offen sc1
    s_add_u32 s50, s98, 16384
    buffer_load_dwordx4 v[92:95], v2, s[20:23], s50 offen sc1
    s_waitcnt vmcnt(4)
    ds_read_b64_tr_b16 v[112:113], v4 offset:0
    ds_read_b64_tr_b16 v[114:115], v4 offset:1024
    ds_read_b64_tr_b16 v[116:117], v5 offset:0
    ds_read_b64_tr_b16 v[118:119], v5 offset:1024
    s_waitcnt lgkmcnt(4)
    v_mfma_f32_32x32x16_bf16 v[16:31], v[104:107], v[96:99], v[16:31]
    v_mfma_f32_32x32x16_bf16 v[32:47], v[104:107], v[100:103], v[32:47]
    v_mfma_f32_32x32x16_bf16 v[48:63], v[108:111], v[96:99], v[48:63]
    v_mfma_f32_32x32x16_bf16 v[64:79], v[108:111], v[100:103], v[64:79]
    s_add_u32 m0, s59, 147456
    s_add_u32 s50, s99, 278528
    buffer_load_dwordx4 v120, s[24:27], s50 offen lds
    buffer_load_dwordx4 v121, s[24:27], s50 offen offset:1024 lds
    s_add_u32 s50, s97, 17408
    buffer_load_dwordx4 v[96:99], v2, s[20:23], s50 offen sc1
    s_add_u32 s50, s98, 17408
    buffer_load_dwordx4 v[100:103], v2, s[20:23], s50 offen sc1
    s_waitcnt vmcnt(4)
    ds_read_b64_tr_b16 v[104:105], v4 offset:2048
    ds_read_b64_tr_b16 v[106:107], v4 offset:3072
    ds_read_b64_tr_b16 v[108:109], v5 offset:2048
    ds_read_b64_tr_b16 v[110:111], v5 offset:3072
    s_waitcnt lgkmcnt(4)
    v_mfma_f32_32x32x16_bf16 v[16:31], v[112:115], v[80:83], v[16:31]
    v_mfma_f32_32x32x16_bf16 v[32:47], v[112:115], v[84:87], v[32:47]
    v_mfma_f32_32x32x16_bf16 v[48:63], v[116:119], v[80:83], v[48:63]
    v_mfma_f32_32x32x16_bf16 v[64:79], v[116:119], v[84:87], v[64:79]
    s_add_u32 m0, s49, 65536
    s_add_u32 s50, s99, 294912
    buffer_load_dwordx4 v120, s[24:27], s50 offen lds
    buffer_load_dwordx4 v121, s[24:27], s50 offen offset:1024 lds
    s_add_u32 s50, s97, 18432
    buffer_load_dwordx4 v[80:83], v2, s[20:23], s50 offen sc1
    s_add_u32 s50, s98, 18432
    buffer_load_dwordx4 v[84:87], v2, s[20:23], s50 offen sc1
    s_waitcnt vmcnt(4)
    ds_read_b64_tr_b16 v[112:113], v6 offset:0
    ds_read_b64_tr_b16 v[114:115], v6 offset:1024
    ds_read_b64_tr_b16 v[116:117], v7 offset:0
    ds_read_b64_tr_b16 v[118:119], v7 offset:1024
    s_waitcnt lgkmcnt(4)
    v_mfma_f32_32x32x16_bf16 v[16:31], v[104:107], v[88:91], v[16:31]
    v_mfma_f32_32x32x16_bf16 v[32:47], v[104:107], v[92:95], v[32:47]
    v_mfma_f32_32x32x16_bf16 v[48:63], v[108:111], v[88:91], v[48:63]
    v_mfma_f32_32x32x16_bf16 v[64:79], v[108:111], v[92:95], v[64:79]
    s_add_u32 m0, s49, 67584
    s_add_u32 s50, s99, 311296
    buffer_load_dwordx4 v120, s[24:27], s50 offen lds
    buffer_load_dwordx4 v121, s[24:27], s50 offen offset:1024 lds
    s_add_u32 s50, s97, 19456
    buffer_load_dwordx4 v[88:91], v2, s[20:23], s50 offen sc1
    s_add_u32 s50, s98, 19456
    buffer_load_dwordx4 v[92:95], v2, s[20:23], s50 offen sc1
    s_waitcnt vmcnt(4)
    ds_read_b64_tr_b16 v[104:105], v4 offset:0
    ds_read_b64_tr_b16 v[106:107], v4 offset:1024
    ds_read_b64_tr_b16 v[108:109], v5 offset:0
    ds_read_b64_tr_b16 v[110:111], v5 offset:1024
    s_waitcnt lgkmcnt(4)
    v_mfma_f32_32x32x16_bf16 v[16:31], v[112:115], v[96:99], v[16:31]
    v_mfma_f32_32x32x16_bf16 v[32:47], v[112:115], v[100:103], v[32:47]
    v_mfma_f32_32x32x16_bf16 v[48:63], v[116:119], v[96:99], v[48:63]
    v_mfma_f32_32x32x16_bf16 v[64:79], v[116:119], v[100:103], v[64:79]
    s_add_u32 m0, s59, 147456
    s_add_u32 s50, s99, 327680
    buffer_load_dwordx4 v120, s[24:27], s50 offen lds
    buffer_load_dwordx4 v121, s[24:27], s50 offen offset:1024 lds
    s_add_u32 s50, s97, 20480
    buffer_load_dwordx4 v[96:99], v2, s[20:23], s50 offen sc1
    s_add_u32 s50, s98, 20480
    buffer_load_dwordx4 v[100:103], v2, s[20:23], s50 offen sc1
    s_waitcnt vmcnt(4)
    ds_read_b64_tr_b16 v[112:113], v4 offset:2048
    ds_read_b64_tr_b16 v[114:115], v4 offset:3072
    ds_read_b64_tr_b16 v[116:117], v5 offset:2048
    ds_read_b64_tr_b16 v[118:119], v5 offset:3072
    s_waitcnt lgkmcnt(4)
    v_mfma_f32_32x32x16_bf16 v[16:31], v[104:107], v[80:83], v[16:31]
    v_mfma_f32_32x32x16_bf16 v[32:47], v[104:107], v[84:87], v[32:47]
    v_mfma_f32_32x32x16_bf16 v[48:63], v[108:111], v[80:83], v[48:63]
    v_mfma_f32_32x32x16_bf16 v[64:79], v[108:111], v[84:87], v[64:79]
    s_add_u32 m0, s49, 65536
    s_add_u32 s50, s99, 344064
    buffer_load_dwordx4 v120, s[24:27], s50 offen lds
    buffer_load_dwordx4 v121, s[24:27], s50 offen offset:1024 lds
    s_add_u32 s50, s97, 21504
    buffer_load_dwordx4 v[80:83], v2, s[20:23], s50 offen sc1
    s_add_u32 s50, s98, 21504
    buffer_load_dwordx4 v[84:87], v2, s[20:23], s50 offen sc1
    s_waitcnt vmcnt(4)
    ds_read_b64_tr_b16 v[104:105], v6 offset:0
    ds_read_b64_tr_b16 v[106:107], v6 offset:1024
    ds_read_b64_tr_b16 v[108:109], v7 offset:0
    ds_read_b64_tr_b16 v[110:111], v7 offset:1024
    s_waitcnt lgkmcnt(4)
    v_mfma_f32_32x32x16_bf16 v[16:31], v[112:115], v[88:91], v[16:31]
    v_mfma_f32_32x32x16_bf16 v[32:47], v[112:115], v[92:95], v[32:47]
    v_mfma_f32_32x32x16_bf16 v[48:63], v[116:119], v[88:91], v[48:63]
    v_mfma_f32_32x32x16_bf16 v[64:79], v[116:119], v[92:95], v[64:79]
    s_add_u32 m0, s49, 67584
    s_add_u32 s50, s99, 360448
    buffer_load_dwordx4 v120, s[24:27], s50 offen lds
    buffer_load_dwordx4 v121, s[24:27], s50 offen offset:1024 lds
    s_add_u32 s50, s97, 22528
    buffer_load_dwordx4 v[88:91], v2, s[20:23], s50 offen sc1
    s_add_u32 s50, s98, 22528
    buffer_load_dwordx4 v[92:95], v2, s[20:23], s50 offen sc1
    s_waitcnt vmcnt(4)
    ds_read_b64_tr_b16 v[112:113], v4 offset:0
    ds_read_b64_tr_b16 v[114:115], v4 offset:1024
    ds_read_b64_tr_b16 v[116:117], v5 offset:0
    ds_read_b64_tr_b16 v[118:119], v5 offset:1024
    s_waitcnt lgkmcnt(4)
    v_mfma_f32_32x32x16_bf16 v[16:31], v[104:107], v[96:99], v[16:31]
    v_mfma_f32_32x32x16_bf16 v[32:47], v[104:107], v[100:103], v[32:47]
    v_mfma_f32_32x32x16_bf16 v[48:63], v[108:111], v[96:99], v[48:63]
    v_mfma_f32_32x32x16_bf16 v[64:79], v[108:111], v[100:103], v[64:79]
    s_add_u32 m0, s59, 147456
    s_add_u32 s50, s99, 376832
    buffer_load_dwordx4 v120, s[24:27], s50 offen lds
    buffer_load_dwordx4 v121, s[24:27], s50 offen offset:1024 lds
    s_add_u32 s50, s97, 23552
    buffer_load_dwordx4 v[96:99], v2, s[20:23], s50 offen sc1
    s_add_u32 s50, s98, 23552
    buffer_load_dwordx4 v[100:103], v2, s[20:23], s50 offen sc1
    s_waitcnt vmcnt(4)
    ds_read_b64_tr_b16 v[104:105], v4 offset:2048
    ds_read_b64_tr_b16 v[106:107], v4 offset:3072
    ds_read_b64_tr_b16 v[108:109], v5 offset:2048
    ds_read_b64_tr_b16 v[110:111], v5 offset:3072
    s_waitcnt lgkmcnt(4)
    v_mfma_f32_32x32x16_bf16 v[16:31], v[112:115], v[80:83], v[16:31]
    v_mfma_f32_32x32x16_bf16 v[32:47], v[112:115], v[84:87], v[32:47]
    v_mfma_f32_32x32x16_bf16 v[48:63], v[116:119], v[80:83], v[48:63]
    v_mfma_f32_32x32x16_bf16 v[64:79], v[116:119], v[84:87], v[64:79]
    s_add_u32 m0, s49, 65536
    s_add_u32 s50, s99, 393216
    buffer_load_dwordx4 v120, s[24:27], s50 offen lds
    buffer_load_dwordx4 v121, s[24:27], s50 offen offset:1024 lds
    s_add_u32 s50, s97, 24576
    buffer_load_dwordx4 v[80:83], v2, s[20:23], s50 offen sc1
    s_add_u32 s50, s98, 24576
    buffer_load_dwordx4 v[84:87], v2, s[20:23], s50 offen sc1
    s_waitcnt vmcnt(4)
    ds_read_b64_tr_b16 v[112:113], v6 offset:0
    ds_read_b64_tr_b16 v[114:115], v6 offset:1024
    ds_read_b64_tr_b16 v[116:117], v7 offset:0
    ds_read_b64_tr_b16 v[118:119], v7 offset:1024
    s_waitcnt lgkmcnt(4)
    v_mfma_f32_32x32x16_bf16 v[16:31], v[104:107], v[88:91], v[16:31]
    v_mfma_f32_32x32x16_bf16 v[32:47], v[104:107], v[92:95], v[32:47]
    v_mfma_f32_32x32x16_bf16 v[48:63], v[108:111], v[88:91], v[48:63]
    v_mfma_f32_32x32x16_bf16 v[64:79], v[108:111], v[92:95], v[64:79]
    s_add_u32 m0, s49, 67584
    s_add_u32 s50, s99, 409600
    buffer_load_dwordx4 v120, s[24:27], s50 offen lds
    buffer_load_dwordx4 v121, s[24:27], s50 offen offset:1024 lds
    s_add_u32 s50, s97, 25600
    buffer_load_dwordx4 v[88:91], v2, s[20:23], s50 offen sc1
    s_add_u32 s50, s98, 25600
    buffer_load_dwordx4 v[92:95], v2, s[20:23], s50 offen sc1
    s_waitcnt vmcnt(4)
    ds_read_b64_tr_b16 v[104:105], v4 offset:0
    ds_read_b64_tr_b16 v[106:107], v4 offset:1024
    ds_read_b64_tr_b16 v[108:109], v5 offset:0
    ds_read_b64_tr_b16 v[110:111], v5 offset:1024
    s_waitcnt lgkmcnt(4)
    v_mfma_f32_32x32x16_bf16 v[16:31], v[112:115], v[96:99], v[16:31]
    v_mfma_f32_32x32x16_bf16 v[32:47], v[112:115], v[100:103], v[32:47]
    v_mfma_f32_32x32x16_bf16 v[48:63], v[116:119], v[96:99], v[48:63]
    v_mfma_f32_32x32x16_bf16 v[64:79], v[116:119], v[100:103], v[64:79]
    s_add_u32 m0, s59, 147456
    s_add_u32 s50, s99, 425984
    buffer_load_dwordx4 v120, s[24:27], s50 offen lds
    buffer_load_dwordx4 v121, s[24:27], s50 offen offset:1024 lds
    s_add_u32 s50, s97, 26624
    buffer_load_dwordx4 v[96:99], v2, s[20:23], s50 offen sc1
    s_add_u32 s50, s98, 26624
    buffer_load_dwordx4 v[100:103], v2, s[20:23], s50 offen sc1
    s_waitcnt vmcnt(4)
    ds_read_b64_tr_b16 v[112:113], v4 offset:2048
    ds_read_b64_tr_b16 v[114:115], v4 offset:3072
    ds_read_b64_tr_b16 v[116:117], v5 offset:2048
    ds_read_b64_tr_b16 v[118:119], v5 offset:3072
    s_waitcnt lgkmcnt(4)
    v_mfma_f32_32x32x16_bf16 v[16:31], v[104:107], v[80:83], v[16:31]
    v_mfma_f32_32x32x16_bf16 v[32:47], v[104:107], v[84:87], v[32:47]
    v_mfma_f32_32x32x16_bf16 v[48:63], v[108:111], v[80:83], v[48:63]
    v_mfma_f32_32x32x16_bf16 v[64:79], v[108:111], v[84:87], v[64:79]
    s_add_u32 m0, s49, 65536
    s_add_u32 s50, s99, 442368
    buffer_load_dwordx4 v120, s[24:27], s50 offen lds
    buffer_load_dwordx4 v121, s[24:27], s50 offen offset:1024 lds
    s_add_u32 s50, s97, 27648
    buffer_load_dwordx4 v[80:83], v2, s[20:23], s50 offen sc1
    s_add_u32 s50, s98, 27648
    buffer_load_dwordx4 v[84:87], v2, s[20:23], s50 offen sc1
    s_waitcnt vmcnt(4)
    ds_read_b64_tr_b16 v[104:105], v6 offset:0
    ds_read_b64_tr_b16 v[106:107], v6 offset:1024
    ds_read_b64_tr_b16 v[108:109], v7 offset:0
    ds_read_b64_tr_b16 v[110:111], v7 offset:1024
    s_waitcnt lgkmcnt(4)
    v_mfma_f32_32x32x16_bf16 v[16:31], v[112:115], v[88:91], v[16:31]
    v_mfma_f32_32x32x16_bf16 v[32:47], v[112:115], v[92:95], v[32:47]
    v_mfma_f32_32x32x16_bf16 v[48:63], v[116:119], v[88:91], v[48:63]
    v_mfma_f32_32x32x16_bf16 v[64:79], v[116:119], v[92:95], v[64:79]
    s_waitcnt vmcnt(0)
    ds_read_b64_tr_b16 v[112:113], v4 offset:0
    ds_read_b64_tr_b16 v[114:115], v4 offset:1024
    ds_read_b64_tr_b16 v[116:117], v5 offset:0
    ds_read_b64_tr_b16 v[118:119], v5 offset:1024
    s_waitcnt lgkmcnt(4)
    v_mfma_f32_32x32x16_bf16 v[16:31], v[104:107], v[96:99], v[16:31]
    v_mfma_f32_32x32x16_bf16 v[32:47], v[104:107], v[100:103], v[32:47]
    v_mfma_f32_32x32x16_bf16 v[48:63], v[108:111], v[96:99], v[48:63]
    v_mfma_f32_32x32x16_bf16 v[64:79], v[108:111], v[100:103], v[64:79]
    s_waitcnt lgkmcnt(0)
    v_mfma_f32_32x32x16_bf16 v[16:31], v[112:115], v[80:83], v[16:31]
    v_mfma_f32_32x32x16_bf16 v[32:47], v[112:115], v[84:87], v[32:47]
    v_mfma_f32_32x32x16_bf16 v[48:63], v[116:119], v[80:83], v[48:63]
    v_mfma_f32_32x32x16_bf16 v[64:79], v[116:119], v[84:87], v[64:79]
    s_setprio 1
    s_mov_b32 s60, 200000
L_wp:
    ds_read_b128 v[156:159], v147
    s_waitcnt lgkmcnt(0)
    v_min_u32 v156, v156, v157
    v_min3_u32 v156, v156, v158, v159
    s_nop 0
    v_readfirstlane_b32 s50, v156
    s_cmp_ge_u32 s50, 1
    s_cbranch_scc1 L_wd
    s_sleep 8
    s_sub_u32 s60, s60, 1
    s_cbranch_scc0 L_wp
L_wd:
    s_lshl_b32 s51, s44, 17
    s_lshl_b32 s50, s58, 7
    s_add_u32 s51, s51, s50
    s_and_b32 s49, s44, 1
    s_lshl_b32 s49, s49, 14
    s_cmp_ge_u32 s44, 2
    s_cselect_b32 s50, 114688, 0
    s_add_u32 s49, s49, s50
    s_add_u32 m0, s49, 0
    s_add_u32 s50, s51, 0
    buffer_load_dwordx4 v120, s[28:31], s50 offen lds
    buffer_load_dwordx4 v121, s[28:31], s50 offen offset:1024 lds
    s_add_u32 m0, s49, 2048
    s_add_u32 s50, s51, 16384
    buffer_load_dwordx4 v120, s[28:31], s50 offen lds
    buffer_load_dwordx4 v121, s[28:31], s50 offen offset:1024 lds
    s_add_u32 m0, s49, 4096
    s_add_u32 s50, s51, 32768
    buffer_load_dwordx4 v120, s[28:31], s50 offen lds
    buffer_load_dwordx4 v121, s[28:31], s50 offen offset:1024 lds
    s_add_u32 m0, s49, 6144
    s_add_u32 s50, s51, 49152
    buffer_load_dwordx4 v120, s[28:31], s50 offen lds
    buffer_load_dwordx4 v121, s[28:31], s50 offen offset:1024 lds
    s_add_u32 m0, s49, 8192
    s_add_u32 s50, s51, 65536
    buffer_load_dwordx4 v120, s[28:31], s50 offen lds
    buffer_load_dwordx4 v121, s[28:31], s50 offen offset:1024 lds
    s_add_u32 m0, s49, 10240
    s_add_u32 s50, s51, 81920
    buffer_load_dwordx4 v120, s[28:31], s50 offen lds
    buffer_load_dwordx4 v121, s[28:31], s50 offen offset:1024 lds
    s_add_u32 m0, s49, 12288
    s_add_u32 s50, s51, 98304
    buffer_load_dwordx4 v120, s[28:31], s50 offen lds
    buffer_load_dwordx4 v121, s[28:31], s50 offen offset:1024 lds
    s_add_u32 m0, s49, 14336
    s_add_u32 s50, s51, 114688
    buffer_load_dwordx4 v120, s[28:31], s50 offen lds
    buffer_load_dwordx4 v121, s[28:31], s50 offen offset:1024 lds
    s_barrier
    s_xor_b32 s97, s44, 0
    s_and_b32 s50, s97, 1
    s_mul_i32 s50, s50, 12288
    s_cmp_ge_u32 s97, 2
    s_cselect_b32 s51, 57344, 0
    s_add_u32 s51, s51, s50
    s_add_u32 s51, s51, 32768
    v_add_u32 v146, s51, v2
    ds_write_b128 v146, v[32:35] offset:0
    ds_write_b128 v146, v[36:39] offset:1024
    ds_write_b128 v146, v[40:43] offset:2048
    ds_write_b128 v146, v[44:47] offset:3072
    ds_write_b128 v146, v[48:51] offset:4096
    ds_write_b128 v146, v[52:55] offset:5120
    ds_write_b128 v146, v[56:59] offset:6144
    ds_write_b128 v146, v[60:63] offset:7168
    ds_write_b128 v146, v[64:67] offset:8192
    ds_write_b128 v146, v[68:71] offset:9216
    ds_write_b128 v146, v[72:75] offset:10240
    ds_write_b128 v146, v[76:79] offset:11264
    s_xor_b32 s97, s44, 1
    s_and_b32 s50, s97, 1
    s_mul_i32 s50, s50, 12288
    s_cmp_ge_u32 s97, 2
    s_cselect_b32 s51, 57344, 0
    s_add_u32 s51, s51, s50
    s_add_u32 s51, s51, 32768
    v_add_u32 v148, s51, v2
    s_xor_b32 s97, s44, 2
    s_and_b32 s50, s97, 1
    s_mul_i32 s50, s50, 12288
    s_cmp_ge_u32 s97, 2
    s_cselect_b32 s51, 57344, 0
    s_add_u32 s51, s51, s50
    s_add_u32 s51, s51, 32768
    v_add_u32 v149, s51, v2
    s_xor_b32 s97, s44, 3
    s_and_b32 s50, s97, 1
    s_mul_i32 s50, s50, 12288
    s_cmp_ge_u32 s97, 2
    s_cselect_b32 s51, 57344, 0
    s_add_u32 s51, s51, s50
    s_add_u32 s51, s51, 32768
    v_add_u32 v150, s51, v2
    v_add_u32 v144, 114688, v125
    s_and_b32 s50, s44, 1
    s_lshl_b32 s51, s50, 15
    s_add_u32 s51, s51, 32768
    v_add_u32 v145, s51, v2
    v_lshlrev_b32 v80, 16, v128
    v_and_b32 v81, 0xffff0000, v128
    v_lshlrev_b32 v82, 16, v129
    v_and_b32 v83, 0xffff0000, v129
    v_lshlrev_b32 v84, 16, v130
    v_and_b32 v85, 0xffff0000, v130
    v_lshlrev_b32 v86, 16, v131
    v_and_b32 v87, 0xffff0000, v131
    v_lshlrev_b32 v88, 16, v132
    v_and_b32 v89, 0xffff0000, v132
    v_lshlrev_b32 v90, 16, v133
    v_and_b32 v91, 0xffff0000, v133
    v_lshlrev_b32 v92, 16, v134
    v_and_b32 v93, 0xffff0000, v134
    v_lshlrev_b32 v94, 16, v135
    v_and_b32 v95, 0xffff0000, v135
    v_pk_add_f32 v[16:17], v[16:17], v[80:81]
    v_pk_add_f32 v[18:19], v[18:19], v[82:83]
    v_pk_add_f32 v[20:21], v[20:21], v[84:85]
    v_pk_add_f32 v[22:23], v[22:23], v[86:87]
    v_pk_add_f32 v[24:25], v[24:25], v[88:89]
    v_pk_add_f32 v[26:27], v[26:27], v[90:91]
    v_pk_add_f32 v[28:29], v[28:29], v[92:93]
    v_pk_add_f32 v[30:31], v[30:31], v[94:95]
    s_waitcnt lgkmcnt(0)
    s_barrier
    ds_read_b128 v[32:35], v148 offset:0
    ds_read_b128 v[36:39], v148 offset:1024
    ds_read_b128 v[40:43], v148 offset:2048
    ds_read_b128 v[44:47], v148 offset:3072
    ds_read_b128 v[48:51], v149 offset:4096
    ds_read_b128 v[52:55], v149 offset:5120
    ds_read_b128 v[56:59], v149 offset:6144
    ds_read_b128 v[60:63], v149 offset:7168
    ds_read_b128 v[64:67], v150 offset:8192
    ds_read_b128 v[68:71], v150 offset:9216
    ds_read_b128 v[72:75], v150 offset:10240
    ds_read_b128 v[76:79], v150 offset:11264
    s_waitcnt lgkmcnt(8)
    v_pk_add_f32 v[16:17], v[16:17], v[32:33]
    v_pk_add_f32 v[18:19], v[18:19], v[34:35]
    v_pk_add_f32 v[20:21], v[20:21], v[36:37]
    v_pk_add_f32 v[22:23], v[22:23], v[38:39]
    v_pk_add_f32 v[24:25], v[24:25], v[40:41]
    v_pk_add_f32 v[26:27], v[26:27], v[42:43]
    v_pk_add_f32 v[28:29], v[28:29], v[44:45]
    v_pk_add_f32 v[30:31], v[30:31], v[46:47]
    s_waitcnt lgkmcnt(4)
    v_pk_add_f32 v[16:17], v[16:17], v[48:49]
    v_pk_add_f32 v[18:19], v[18:19], v[50:51]
    v_pk_add_f32 v[20:21], v[20:21], v[52:53]
    v_pk_add_f32 v[22:23], v[22:23], v[54:55]
    v_pk_add_f32 v[24:25], v[24:25], v[56:57]
    v_pk_add_f32 v[26:27], v[26:27], v[58:59]
    v_pk_add_f32 v[28:29], v[28:29], v[60:61]
    v_pk_add_f32 v[30:31], v[30:31], v[62:63]
    s_waitcnt lgkmcnt(0)
    v_pk_add_f32 v[16:17], v[16:17], v[64:65]
    v_pk_add_f32 v[18:19], v[18:19], v[66:67]
    v_pk_add_f32 v[20:21], v[20:21], v[68:69]
    v_pk_add_f32 v[22:23], v[22:23], v[70:71]
    v_pk_add_f32 v[24:25], v[24:25], v[72:73]
    v_pk_add_f32 v[26:27], v[26:27], v[74:75]
    v_pk_add_f32 v[28:29], v[28:29], v[76:77]
    v_pk_add_f32 v[30:31], v[30:31], v[78:79]
    s_barrier
    s_lshl_b32 s51, s57, 16
    s_lshl_b32 s52, s3, 10
    s_add_u32 s51, s51, s52
    s_add_u32 s51, s51, 6291456
    s_add_u32 m0, s52, 32768
    s_add_u32 s50, s51, 0
    buffer_load_dwordx4 v2, s[20:23], s50 offen sc1 lds
    s_add_u32 m0, s52, 65536
    s_add_u32 s50, s51, 32768
    buffer_load_dwordx4 v2, s[20:23], s50 offen sc1 lds
    s_add_u32 m0, s52, 40960
    s_add_u32 s50, s51, 8192
    buffer_load_dwordx4 v2, s[20:23], s50 offen sc1 lds
    s_add_u32 m0, s52, 73728
    s_add_u32 s50, s51, 40960
    buffer_load_dwordx4 v2, s[20:23], s50 offen sc1 lds
    s_add_u32 m0, s52, 49152
    s_add_u32 s50, s51, 16384
    buffer_load_dwordx4 v2, s[20:23], s50 offen sc1 lds
    s_add_u32 m0, s52, 81920
    s_add_u32 s50, s51, 49152
    buffer_load_dwordx4 v2, s[20:23], s50 offen sc1 lds
    s_add_u32 m0, s52, 57344
    s_add_u32 s50, s51, 24576
    buffer_load_dwordx4 v2, s[20:23], s50 offen sc1 lds
    s_add_u32 m0, s52, 90112
    s_add_u32 s50, s51, 57344
    buffer_load_dwordx4 v2, s[20:23], s50 offen sc1 lds
    v_mul_f32 v80, 0xbfb8aa3b, v16
    v_mul_f32 v81, 0xbfb8aa3b, v17
    v_mul_f32 v82, 0xbfb8aa3b, v18
    v_mul_f32 v83, 0xbfb8aa3b, v19
    v_mul_f32 v84, 0xbfb8aa3b, v20
    v_mul_f32 v85, 0xbfb8aa3b, v21
    v_mul_f32 v86, 0xbfb8aa3b, v22
    v_mul_f32 v87, 0xbfb8aa3b, v23
    v_mul_f32 v88, 0xbfb8aa3b, v24
    v_mul_f32 v89, 0xbfb8aa3b, v25
    v_mul_f32 v90, 0xbfb8aa3b, v26
    v_mul_f32 v91, 0xbfb8aa3b, v27
    v_mul_f32 v92, 0xbfb8aa3b, v28
    v_mul_f32 v93, 0xbfb8aa3b, v29
    v_mul_f32 v94, 0xbfb8aa3b, v30
    v_mul_f32 v95, 0xbfb8aa3b, v31
    v_exp_f32 v80, v80
    v_exp_f32 v81, v81
    v_exp_f32 v82, v82
    v_exp_f32 v83, v83
    v_exp_f32 v84, v84
    v_exp_f32 v85, v85
    v_exp_f32 v86, v86
    v_exp_f32 v87, v87
    v_exp_f32 v88, v88
    v_exp_f32 v89, v89
    v_exp_f32 v90, v90
    v_exp_f32 v91, v91
    v_exp_f32 v92, v92
    v_exp_f32 v93, v93
    v_exp_f32 v94, v94
    v_exp_f32 v95, v95
    v_add_f32 v80, 1.0, v80
    v_add_f32 v81, 1.0, v81
    v_add_f32 v82, 1.0, v82
    v_add_f32 v83, 1.0, v83
    v_add_f32 v84, 1.0, v84
    v_add_f32 v85, 1.0, v85
    v_add_f32 v86, 1.0, v86
    v_add_f32 v87, 1.0, v87
    v_add_f32 v88, 1.0, v88
    v_add_f32 v89, 1.0, v89
    v_add_f32 v90, 1.0, v90
    v_add_f32 v91, 1.0, v91
    v_add_f32 v92, 1.0, v92
    v_add_f32 v93, 1.0, v93
    v_add_f32 v94, 1.0, v94
    v_add_f32 v95, 1.0, v95
    v_rcp_f32 v80, v80
    v_rcp_f32 v81, v81
    v_rcp_f32 v82, v82
    v_rcp_f32 v83, v83
    v_rcp_f32 v84, v84
    v_rcp_f32 v85, v85
    v_rcp_f32 v86, v86
    v_rcp_f32 v87, v87
    v_rcp_f32 v88, v88
    v_rcp_f32 v89, v89
    v_rcp_f32 v90, v90
    v_rcp_f32 v91, v91
    v_rcp_f32 v92, v92
    v_rcp_f32 v93, v93
    v_rcp_f32 v94, v94
    v_rcp_f32 v95, v95
    v_pk_mul_f32 v[16:17], v[16:17], v[80:81]
    v_pk_mul_f32 v[18:19], v[18:19], v[82:83]
    v_pk_mul_f32 v[20:21], v[20:21], v[84:85]
    v_pk_mul_f32 v[22:23], v[22:23], v[86:87]
    v_pk_mul_f32 v[24:25], v[24:25], v[88:89]
    v_pk_mul_f32 v[26:27], v[26:27], v[90:91]
    v_pk_mul_f32 v[28:29], v[28:29], v[92:93]
    v_pk_mul_f32 v[30:31], v[30:31], v[94:95]
    v_lshlrev_b32 v80, 16, v136
    v_and_b32 v81, 0xffff0000, v136
    v_lshlrev_b32 v82, 16, v137
    v_and_b32 v83, 0xffff0000, v137
    v_lshlrev_b32 v84, 16, v138
    v_and_b32 v85, 0xffff0000, v138
    v_lshlrev_b32 v86, 16, v139
    v_and_b32 v87, 0xffff0000, v139
    v_lshlrev_b32 v88, 16, v140
    v_and_b32 v89, 0xffff0000, v140
    v_lshlrev_b32 v90, 16, v141
    v_and_b32 v91, 0xffff0000, v141
    v_lshlrev_b32 v92, 16, v142
    v_and_b32 v93, 0xffff0000, v142
    v_lshlrev_b32 v94, 16, v143
    v_and_b32 v95, 0xffff0000, v143
    s_waitcnt vmcnt(6)
    s_barrier
    ds_read_b128 v[64:67], v145 offset:0
    ds_read_b64_tr_b16 v[48:49], v125 offset:0
    ds_read_b64_tr_b16 v[50:51], v125 offset:1024
    ds_read_b128 v[68:71], v145 offset:1024
    ds_read_b64_tr_b16 v[52:53], v125 offset:2048
    ds_read_b64_tr_b16 v[54:55], v125 offset:3072
    ds_read_b128 v[72:75], v145 offset:2048
    ds_read_b64_tr_b16 v[56:57], v125 offset:4096
    ds_read_b64_tr_b16 v[58:59], v125 offset:5120
    ds_read_b128 v[76:79], v145 offset:3072
    ds_read_b64_tr_b16 v[60:61], v125 offset:6144
    ds_read_b64_tr_b16 v[62:63], v125 offset:7168
    s_waitcnt lgkmcnt(9)
    v_mfma_f32_32x32x16_bf16 v[32:47], v[48:51], v[64:67], 0
    ds_read_b128 v[64:67], v145 offset:4096
    ds_read_b64_tr_b16 v[48:49], v125 offset:8192
    ds_read_b64_tr_b16 v[50:51], v125 offset:9216
    s_waitcnt lgkmcnt(9)
    v_mfma_f32_32x32x16_bf16 v[32:47], v[52:55], v[68:71], v[32:47]
    ds_read_b128 v[68:71], v145 offset:5120
    ds_read_b64_tr_b16 v[52:53], v125 offset:10240
    ds_read_b64_tr_b16 v[54:55], v125 offset:11264
    s_waitcnt lgkmcnt(9)
    v_mfma_f32_32x32x16_bf16 v[32:47], v[56:59], v[72:75], v[32:47]
    ds_read_b128 v[72:75], v145 offset:6144
    ds_read_b64_tr_b16 v[56:57], v125 offset:12288
    ds_read_b64_tr_b16 v[58:59], v125 offset:13312
    s_waitcnt lgkmcnt(9)
    v_mfma_f32_32x32x16_bf16 v[32:47], v[60:63], v[76:79], v[32:47]
    ds_read_b128 v[76:79], v145 offset:7168
    ds_read_b64_tr_b16 v[60:61], v125 offset:14336
    ds_read_b64_tr_b16 v[62:63], v125 offset:15360
    s_waitcnt lgkmcnt(9)
    v_mfma_f32_32x32x16_bf16 v[32:47], v[48:51], v[64:67], v[32:47]
    s_waitcnt vmcnt(4)
    s_barrier
    ds_read_b128 v[64:67], v145 offset:8192
    ds_read_b64_tr_b16 v[48:49], v125 offset:16384
    ds_read_b64_tr_b16 v[50:51], v125 offset:17408
    s_waitcnt lgkmcnt(9)
    v_mfma_f32_32x32x16_bf16 v[32:47], v[52:55], v[68:71], v[32:47]
    ds_read_b128 v[68:71], v145 offset:9216
    ds_read_b64_tr_b16 v[52:53], v125 offset:18432
    ds_read_b64_tr_b16 v[54:55], v125 offset:19456
    s_waitcnt lgkmcnt(9)
    v_mfma_f32_32x32x16_bf16 v[32:47], v[56:59], v[72:75], v[32:47]
    ds_read_b128 v[72:75], v145 offset:10240
    ds_read_b64_tr_b16 v[56:57], v125 offset:20480
    ds_read_b64_tr_b16 v[58:59], v125 offset:21504
    s_waitcnt lgkmcnt(9)
    v_mfma_f32_32x32x16_bf16 v[32:47], v[60:63], v[76:79], v[32:47]
    ds_read_b128 v[76:79], v145 offset:11264
    ds_read_b64_tr_b16 v[60:61], v125 offset:22528
    ds_read_b64_tr_b16 v[62:63], v125 offset:23552
    s_waitcnt lgkmcnt(9)
    v_mfma_f32_32x32x16_bf16 v[32:47], v[48:51], v[64:67], v[32:47]
    ds_read_b128 v[64:67], v145 offset:12288
    ds_read_b64_tr_b16 v[48:49], v125 offset:24576
    ds_read_b64_tr_b16 v[50:51], v125 offset:25600
    s_waitcnt lgkmcnt(9)
    v_mfma_f32_32x32x16_bf16 v[32:47], v[52:55], v[68:71], v[32:47]
    ds_read_b128 v[68:71], v145 offset:13312
    ds_read_b64_tr_b16 v[52:53], v125 offset:26624
    ds_read_b64_tr_b16 v[54:55], v125 offset:27648
    s_waitcnt lgkmcnt(9)
    v_mfma_f32_32x32x16_bf16 v[32:47], v[56:59], v[72:75], v[32:47]
    ds_read_b128 v[72:75], v145 offset:14336
    ds_read_b64_tr_b16 v[56:57], v125 offset:28672
    ds_read_b64_tr_b16 v[58:59], v125 offset:29696
    s_waitcnt lgkmcnt(9)
    v_mfma_f32_32x32x16_bf16 v[32:47], v[60:63], v[76:79], v[32:47]
    ds_read_b128 v[76:79], v145 offset:15360
    ds_read_b64_tr_b16 v[60:61], v125 offset:30720
    ds_read_b64_tr_b16 v[62:63], v125 offset:31744
    s_waitcnt lgkmcnt(9)
    v_mfma_f32_32x32x16_bf16 v[32:47], v[48:51], v[64:67], v[32:47]
    s_waitcnt vmcnt(2)
    s_barrier
    ds_read_b128 v[64:67], v145 offset:16384
    ds_read_b64_tr_b16 v[48:49], v144 offset:0
    ds_read_b64_tr_b16 v[50:51], v144 offset:1024
    s_waitcnt lgkmcnt(9)
    v_mfma_f32_32x32x16_bf16 v[32:47], v[52:55], v[68:71], v[32:47]
    ds_read_b128 v[68:71], v145 offset:17408
    ds_read_b64_tr_b16 v[52:53], v144 offset:2048
    ds_read_b64_tr_b16 v[54:55], v144 offset:3072
    s_waitcnt lgkmcnt(9)
    v_mfma_f32_32x32x16_bf16 v[32:47], v[56:59], v[72:75], v[32:47]
    ds_read_b128 v[72:75], v145 offset:18432
    ds_read_b64_tr_b16 v[56:57], v144 offset:4096
    ds_read_b64_tr_b16 v[58:59], v144 offset:5120
    s_waitcnt lgkmcnt(9)
    v_mfma_f32_32x32x16_bf16 v[32:47], v[60:63], v[76:79], v[32:47]
    ds_read_b128 v[76:79], v145 offset:19456
    ds_read_b64_tr_b16 v[60:61], v144 offset:6144
    ds_read_b64_tr_b16 v[62:63], v144 offset:7168
    s_waitcnt lgkmcnt(9)
    v_mfma_f32_32x32x16_bf16 v[32:47], v[48:51], v[64:67], v[32:47]
    ds_read_b128 v[64:67], v145 offset:20480
    ds_read_b64_tr_b16 v[48:49], v144 offset:8192
    ds_read_b64_tr_b16 v[50:51], v144 offset:9216
    s_waitcnt lgkmcnt(9)
    v_mfma_f32_32x32x16_bf16 v[32:47], v[52:55], v[68:71], v[32:47]
    ds_read_b128 v[68:71], v145 offset:21504
    ds_read_b64_tr_b16 v[52:53], v144 offset:10240
    ds_read_b64_tr_b16 v[54:55], v144 offset:11264
    s_waitcnt lgkmcnt(9)
    v_mfma_f32_32x32x16_bf16 v[32:47], v[56:59], v[72:75], v[32:47]
    ds_read_b128 v[72:75], v145 offset:22528
    ds_read_b64_tr_b16 v[56:57], v144 offset:12288
    ds_read_b64_tr_b16 v[58:59], v144 offset:13312
    s_waitcnt lgkmcnt(9)
    v_mfma_f32_32x32x16_bf16 v[32:47], v[60:63], v[76:79], v[32:47]
    ds_read_b128 v[76:79], v145 offset:23552
    ds_read_b64_tr_b16 v[60:61], v144 offset:14336
    ds_read_b64_tr_b16 v[62:63], v144 offset:15360
    s_waitcnt lgkmcnt(9)
    v_mfma_f32_32x32x16_bf16 v[32:47], v[48:51], v[64:67], v[32:47]
    s_waitcnt vmcnt(0)
    s_barrier
    ds_read_b128 v[64:67], v145 offset:24576
    ds_read_b64_tr_b16 v[48:49], v144 offset:16384
    ds_read_b64_tr_b16 v[50:51], v144 offset:17408
    s_waitcnt lgkmcnt(9)
    v_mfma_f32_32x32x16_bf16 v[32:47], v[52:55], v[68:71], v[32:47]
    ds_read_b128 v[68:71], v145 offset:25600
    ds_read_b64_tr_b16 v[52:53], v144 offset:18432
    ds_read_b64_tr_b16 v[54:55], v144 offset:19456
    s_waitcnt lgkmcnt(9)
    v_mfma_f32_32x32x16_bf16 v[32:47], v[56:59], v[72:75], v[32:47]
    ds_read_b128 v[72:75], v145 offset:26624
    ds_read_b64_tr_b16 v[56:57], v144 offset:20480
    ds_read_b64_tr_b16 v[58:59], v144 offset:21504
    s_waitcnt lgkmcnt(9)
    v_mfma_f32_32x32x16_bf16 v[32:47], v[60:63], v[76:79], v[32:47]
    ds_read_b128 v[76:79], v145 offset:27648
    ds_read_b64_tr_b16 v[60:61], v144 offset:22528
    ds_read_b64_tr_b16 v[62:63], v144 offset:23552
    s_waitcnt lgkmcnt(9)
    v_mfma_f32_32x32x16_bf16 v[32:47], v[48:51], v[64:67], v[32:47]
    ds_read_b128 v[64:67], v145 offset:28672
    ds_read_b64_tr_b16 v[48:49], v144 offset:24576
    ds_read_b64_tr_b16 v[50:51], v144 offset:25600
    s_waitcnt lgkmcnt(9)
    v_mfma_f32_32x32x16_bf16 v[32:47], v[52:55], v[68:71], v[32:47]
    ds_read_b128 v[68:71], v145 offset:29696
    ds_read_b64_tr_b16 v[52:53], v144 offset:26624
    ds_read_b64_tr_b16 v[54:55], v144 offset:27648
    s_waitcnt lgkmcnt(9)
    v_mfma_f32_32x32x16_bf16 v[32:47], v[56:59], v[72:75], v[32:47]
    ds_read_b128 v[72:75], v145 offset:30720
    ds_read_b64_tr_b16 v[56:57], v144 offset:28672
    ds_read_b64_tr_b16 v[58:59], v144 offset:29696
    s_waitcnt lgkmcnt(9)
    v_mfma_f32_32x32x16_bf16 v[32:47], v[60:63], v[76:79], v[32:47]
    ds_read_b128 v[76:79], v145 offset:31744
    ds_read_b64_tr_b16 v[60:61], v144 offset:30720
    ds_read_b64_tr_b16 v[62:63], v144 offset:31744
    s_waitcnt lgkmcnt(9)
    v_mfma_f32_32x32x16_bf16 v[32:47], v[48:51], v[64:67], v[32:47]
    s_waitcnt lgkmcnt(6)
    v_mfma_f32_32x32x16_bf16 v[32:47], v[52:55], v[68:71], v[32:47]
    s_waitcnt lgkmcnt(3)
    v_mfma_f32_32x32x16_bf16 v[32:47], v[56:59], v[72:75], v[32:47]
    s_waitcnt lgkmcnt(0)
    v_mfma_f32_32x32x16_bf16 v[32:47], v[60:63], v[76:79], v[32:47]
    s_nop 7
    s_nop 3
    v_pk_fma_f32 v[32:33], v[32:33], v[16:17], v[80:81]
    v_pk_fma_f32 v[34:35], v[34:35], v[18:19], v[82:83]
    v_pk_fma_f32 v[36:37], v[36:37], v[20:21], v[84:85]
    v_pk_fma_f32 v[38:39], v[38:39], v[22:23], v[86:87]
    v_pk_fma_f32 v[40:41], v[40:41], v[24:25], v[88:89]
    v_pk_fma_f32 v[42:43], v[42:43], v[26:27], v[90:91]
    v_pk_fma_f32 v[44:45], v[44:45], v[28:29], v[92:93]
    v_pk_fma_f32 v[46:47], v[46:47], v[30:31], v[94:95]
    v_cvt_pk_bf16_f32 v32, v32, v33
    v_cvt_pk_bf16_f32 v33, v34, v35
    v_cvt_pk_bf16_f32 v34, v36, v37
    v_cvt_pk_bf16_f32 v35, v38, v39
    v_cvt_pk_bf16_f32 v36, v40, v41
    v_cvt_pk_bf16_f32 v37, v42, v43
    v_cvt_pk_bf16_f32 v38, v44, v45
    v_cvt_pk_bf16_f32 v39, v46, v47
    buffer_store_dwordx4 v[32:35], v126, s[32:35], s55 offen
    buffer_store_dwordx4 v[36:39], v126, s[32:35], s55 offen offset:32
L_fin:
L_end:
    s_endpgm
.section .rodata,"a"
.p2align 6
.amdhsa_kernel recurrent_scan__mha_block__mixer_channel_mlp__prompt_kernel
  .amdhsa_next_free_vgpr 256
  .amdhsa_next_free_sgpr 102
  .amdhsa_accum_offset 256
  .amdhsa_group_segment_fixed_size 0
  .amdhsa_kernarg_size 88
  .amdhsa_user_sgpr_count 2
  .amdhsa_user_sgpr_kernarg_segment_ptr 1
  .amdhsa_system_sgpr_workgroup_id_x 1
  .amdhsa_float_denorm_mode_32 3
.end_amdhsa_kernel
```
